```python
import torch

def _softmax(x, axis=-1):
    return torch.softmax(x, dim=axis)

def _gelu(x):
    return torch.nn.functional.gelu(x, approximate='tanh')

def _silu(x):
    return torch.nn.functional.silu(x)

def _sigmoid(x):
    return torch.sigmoid(x)

def _layernorm(x, axis=-1, eps=1e-05):
    m = x.mean(dim=axis, keepdim=True)
    v = x.var(dim=axis, keepdim=True, unbiased=False)
    return (x - m) / torch.sqrt(v + eps)

def _scatter_add(tgt, idx, src, axis=0):
    return tgt.clone().index_add_(axis, idx, src)

def _segment_sum(src, seg, n):
    out = torch.zeros((n,) + src.shape[1:], dtype=src.dtype)
    return out.index_add_(0, seg, src)

def _pad(x, pw):
    flat = tuple((v for pair in reversed(pw) for v in pair))
    return torch.nn.functional.pad(x, flat)
kernel_name = 'standalone__autoregressive_conv_wavenet__speech'

def setup_inputs():

    _w = lambda a: (lambda t: t.to(torch.bfloat16) if t.is_floating_point() else t)(torch.as_tensor(a))
    B, T, D, K = (2, 4000, 512, 15)
    return {'x': _w((lambda *s: torch.randn(*s, dtype=torch.bfloat16) * 0.1)(B, T, D)), 'w': _w((lambda *s: torch.randn(*s, dtype=torch.bfloat16) * 0.1)(K, D, 2 * D)), 'w_o': _w((lambda *s: torch.randn(*s, dtype=torch.bfloat16) * 0.05)(D, D))}

def reference(x, w, w_o):
    B, T, D = x.shape
    K = w.shape[0]
    dil = 2
    pad = (K - 1) * dil
    xp = _pad(x, ((0, 0), (pad, 0), (0, 0)))
    h = torch.einsum('btc,cd->btd', xp[:, pad:pad + T, :], w[0])
    for i in range(1, K):
        off = pad - i * dil
        h = h + torch.einsum('btc,cd->btd', xp[:, off:off + T, :], w[i])
    f = h[..., :D].clone()
    g = h[..., D:].clone()
    z = torch.tanh(f) * _sigmoid(g)
    return z @ w_o
```

```asm
; @launch grid=(256,1,1) block=(512,1,1) lds=160608
.amdgcn_target "amdgcn-amd-amdhsa--gfx950"
.text
.globl standalone__autoregressive_conv_wavenet__speech_kernel
.p2align 8
.type standalone__autoregressive_conv_wavenet__speech_kernel,@function
standalone__autoregressive_conv_wavenet__speech_kernel:
s_cmp_ge_u32 s2, 256
s_cbranch_scc1 L_end
s_load_dwordx8 s[4:11], s[0:1], 0
s_load_dwordx4 s[12:15], s[0:1], 32
v_lshrrev_b32 v2, 6, v0
v_and_b32 v1, 63, v0
s_and_b32 s33, s2, 7
v_readfirstlane_b32 s32, v2
s_lshr_b32 s34, s2, 3
s_cmp_lg_u32 s34, 23
s_cbranch_scc1 L_noi
s_getpc_b64 s[44:45]
L_pci:
v_lshlrev_b32 v250, 7, v0
v_min_u32 v250, L_end-L_pci, v250
v_mov_b32 v251, s45
v_add_co_u32 v250, vcc, s44, v250
s_nop 1
v_addc_co_u32 v251, vcc, 0, v251, vcc
global_load_dword v254, v[250:251], off
L_noi:
v_and_b32 v2, 15, v1
v_lshrrev_b32 v3, 4, v1
s_cmp_ge_u32 s32, 4
s_cbranch_scc1 L_B
s_cmp_ge_u32 s2, 160
s_cbranch_scc1 L_aux
s_and_b32 s48, s33, 1
s_xor_b32 s48, s48, 1
s_lshl_b32 s48, s48, 2
s_and_b32 s40, s34, 3
s_add_u32 s48, s48, s40
s_lshr_b32 s49, s33, 2
s_bfe_u32 s40, s33, 0x10001
s_mul_i32 s40, s40, 5
s_lshr_b32 s41, s34, 2
s_add_u32 s50, s40, s41
s_bitcmp0_b32 s33, 0
s_cbranch_scc1 L_xm
s_mul_i32 s41, s34, 43
s_lshr_b32 s41, s41, 7
s_mul_i32 s48, s41, 3
s_sub_u32 s48, s34, s48
s_cmp_ge_u32 s34, 15
s_cselect_b32 s48, 3, s48
s_sub_u32 s42, s34, 15
s_cselect_b32 s41, s41, s42
s_add_u32 s50, s40, s41
L_xm:
s_lshl_b32 s40, s32, 1
v_lshrrev_b32 v4, 5, v1
v_add_u32 v4, s40, v4
v_and_b32 v4, 3, v4
v_lshlrev_b32 v4, 1, v4
v_and_b32 v5, 7, v1
v_xor_b32 v4, v4, v5
v_lshlrev_b32 v4, 4, v4
v_lshrrev_b32 v5, 3, v1
v_lshl_add_u32 v4, v5, 10, v4
s_mul_i32 s40, s50, 400
s_lshl_b32 s41, s32, 3
s_add_u32 s40, s40, s41
s_sub_u32 s40, s40, 28
s_lshl_b32 s40, s40, 10
s_lshl_b32 s41, s48, 7
s_add_u32 s40, s40, s41
v_add_u32 v4, s40, v4
s_mul_i32 s40, s49, 4096000
s_lshl_b32 s42, s32, 10
s_waitcnt lgkmcnt(0)
s_add_u32 s16, s4, s40
s_addc_u32 s17, s5, 0
s_mov_b32 s18, 4096000
s_mov_b32 s19, 0x20000
s_add_u32 m0, s42, 105216
s_nop 0
buffer_load_dwordx4 v4, s[16:19], 0 offen lds
v_add_u32 v4, 0x8000, v4
s_add_u32 m0, s42, 109312
s_nop 0
buffer_load_dwordx4 v4, s[16:19], 0 offen lds
v_add_u32 v4, 0x8000, v4
s_add_u32 m0, s42, 113408
s_nop 0
buffer_load_dwordx4 v4, s[16:19], 0 offen lds
v_add_u32 v4, 0x8000, v4
s_add_u32 m0, s42, 117504
s_nop 0
buffer_load_dwordx4 v4, s[16:19], 0 offen lds
v_add_u32 v4, 0x8000, v4
s_add_u32 m0, s42, 121600
s_nop 0
buffer_load_dwordx4 v4, s[16:19], 0 offen lds
v_add_u32 v4, 0x8000, v4
s_add_u32 m0, s42, 125696
s_nop 0
buffer_load_dwordx4 v4, s[16:19], 0 offen lds
v_add_u32 v4, 0x8000, v4
s_add_u32 m0, s42, 129792
s_nop 0
buffer_load_dwordx4 v4, s[16:19], 0 offen lds
v_add_u32 v4, 0x8000, v4
s_add_u32 m0, s42, 133888
s_nop 0
buffer_load_dwordx4 v4, s[16:19], 0 offen lds
v_add_u32 v4, 0x8000, v4
s_add_u32 m0, s42, 137984
s_nop 0
buffer_load_dwordx4 v4, s[16:19], 0 offen lds
v_add_u32 v4, 0x8000, v4
s_add_u32 m0, s42, 142080
s_nop 0
buffer_load_dwordx4 v4, s[16:19], 0 offen lds
v_add_u32 v4, 0x8000, v4
s_add_u32 m0, s42, 146176
s_nop 0
buffer_load_dwordx4 v4, s[16:19], 0 offen lds
v_add_u32 v4, 0x8000, v4
s_add_u32 m0, s42, 150272
s_nop 0
buffer_load_dwordx4 v4, s[16:19], 0 offen lds
v_add_u32 v4, 0x8000, v4
s_add_u32 m0, s42, 154368
s_nop 0
buffer_load_dwordx4 v4, s[16:19], 0 offen lds
v_add_u32 v4, 0x8000, v4
s_add_u32 m0, s42, 158464
s_cmp_ge_u32 s32, 2
s_cbranch_scc1 L_xskip
buffer_load_dwordx4 v4, s[16:19], 0 offen lds
L_xskip:
s_barrier
s_mov_b32 s20, s14
s_mov_b32 s21, s15
s_mov_b32 s22, 10485760
s_mov_b32 s23, 0x20000
s_add_u32 s24, s14, 62914560
s_addc_u32 s25, s15, 0
s_mov_b32 s26, 211200
s_mov_b32 s27, 0x20000
s_mov_b32 s28, s12
s_mov_b32 s29, s13
s_mov_b32 s30, 256
s_mov_b32 s31, 0x20000
s_and_b32 s40, s33, 1
s_xor_b32 s40, s40, 1
s_lshr_b32 s41, s33, 2
s_lshl_b32 s41, s41, 1
s_add_u32 s37, s40, s41
s_bfe_u32 s40, s33, 0x10001
s_lshl_b32 s40, s40, 3
s_and_b32 s41, s34, 7
s_add_u32 s35, s40, s41
s_lshl_b32 s40, s37, 2
s_lshr_b32 s41, s34, 3
s_add_u32 s36, s40, s41
v_lshrrev_b32 v5, 1, v2
v_lshl_add_u32 v5, v5, 1, 1
v_cvt_f32_u32 v5, v5
v_and_b32 v6, 1, v2
v_cvt_f32_u32 v6, v6
v_mul_f32 v6, 0x3e800000, v6
v_lshlrev_b32 v7, 3, v3
v_cvt_f32_u32 v7, v7
v_add_f32 v8, 0x0, v5
v_mul_f32 v8, 0x3c000000, v8
v_add_f32 v9, 0x0, v7
v_fma_f32 v9, v9, v8, v6
v_cos_f32 v176, v9
v_add_f32 v9, v9, v8
v_cos_f32 v177, v9
v_add_f32 v9, v9, v8
v_cos_f32 v178, v9
v_add_f32 v9, v9, v8
v_cos_f32 v179, v9
v_add_f32 v9, v9, v8
v_cos_f32 v180, v9
v_add_f32 v9, v9, v8
v_cos_f32 v181, v9
v_add_f32 v9, v9, v8
v_cos_f32 v182, v9
v_add_f32 v9, v9, v8
v_cos_f32 v183, v9
s_nop 0
v_cvt_pk_bf16_f32 v16, v176, v177
v_cvt_pk_bf16_f32 v17, v178, v179
v_cvt_pk_bf16_f32 v18, v180, v181
v_cvt_pk_bf16_f32 v19, v182, v183
v_add_f32 v9, 0x42000000, v7
v_fma_f32 v9, v9, v8, v6
v_cos_f32 v176, v9
v_add_f32 v9, v9, v8
v_cos_f32 v177, v9
v_add_f32 v9, v9, v8
v_cos_f32 v178, v9
v_add_f32 v9, v9, v8
v_cos_f32 v179, v9
v_add_f32 v9, v9, v8
v_cos_f32 v180, v9
v_add_f32 v9, v9, v8
v_cos_f32 v181, v9
v_add_f32 v9, v9, v8
v_cos_f32 v182, v9
v_add_f32 v9, v9, v8
v_cos_f32 v183, v9
s_nop 0
v_cvt_pk_bf16_f32 v20, v176, v177
v_cvt_pk_bf16_f32 v21, v178, v179
v_cvt_pk_bf16_f32 v22, v180, v181
v_cvt_pk_bf16_f32 v23, v182, v183
v_add_f32 v8, 0x41800000, v5
v_mul_f32 v8, 0x3c000000, v8
v_add_f32 v9, 0x0, v7
v_fma_f32 v9, v9, v8, v6
v_cos_f32 v176, v9
v_add_f32 v9, v9, v8
v_cos_f32 v177, v9
v_add_f32 v9, v9, v8
v_cos_f32 v178, v9
v_add_f32 v9, v9, v8
v_cos_f32 v179, v9
v_add_f32 v9, v9, v8
v_cos_f32 v180, v9
v_add_f32 v9, v9, v8
v_cos_f32 v181, v9
v_add_f32 v9, v9, v8
v_cos_f32 v182, v9
v_add_f32 v9, v9, v8
v_cos_f32 v183, v9
s_nop 0
v_cvt_pk_bf16_f32 v24, v176, v177
v_cvt_pk_bf16_f32 v25, v178, v179
v_cvt_pk_bf16_f32 v26, v180, v181
v_cvt_pk_bf16_f32 v27, v182, v183
v_add_f32 v9, 0x42000000, v7
v_fma_f32 v9, v9, v8, v6
v_cos_f32 v176, v9
v_add_f32 v9, v9, v8
v_cos_f32 v177, v9
v_add_f32 v9, v9, v8
v_cos_f32 v178, v9
v_add_f32 v9, v9, v8
v_cos_f32 v179, v9
v_add_f32 v9, v9, v8
v_cos_f32 v180, v9
v_add_f32 v9, v9, v8
v_cos_f32 v181, v9
v_add_f32 v9, v9, v8
v_cos_f32 v182, v9
v_add_f32 v9, v9, v8
v_cos_f32 v183, v9
s_nop 0
v_cvt_pk_bf16_f32 v28, v176, v177
v_cvt_pk_bf16_f32 v29, v178, v179
v_cvt_pk_bf16_f32 v30, v180, v181
v_cvt_pk_bf16_f32 v31, v182, v183
v_add_f32 v8, 0x42000000, v5
v_mul_f32 v8, 0x3c000000, v8
v_add_f32 v9, 0x0, v7
v_fma_f32 v9, v9, v8, v6
v_cos_f32 v176, v9
v_add_f32 v9, v9, v8
v_cos_f32 v177, v9
v_add_f32 v9, v9, v8
v_cos_f32 v178, v9
v_add_f32 v9, v9, v8
v_cos_f32 v179, v9
v_add_f32 v9, v9, v8
v_cos_f32 v180, v9
v_add_f32 v9, v9, v8
v_cos_f32 v181, v9
v_add_f32 v9, v9, v8
v_cos_f32 v182, v9
v_add_f32 v9, v9, v8
v_cos_f32 v183, v9
s_nop 0
v_cvt_pk_bf16_f32 v32, v176, v177
v_cvt_pk_bf16_f32 v33, v178, v179
v_cvt_pk_bf16_f32 v34, v180, v181
v_cvt_pk_bf16_f32 v35, v182, v183
v_add_f32 v9, 0x42000000, v7
v_fma_f32 v9, v9, v8, v6
v_cos_f32 v176, v9
v_add_f32 v9, v9, v8
v_cos_f32 v177, v9
v_add_f32 v9, v9, v8
v_cos_f32 v178, v9
v_add_f32 v9, v9, v8
v_cos_f32 v179, v9
v_add_f32 v9, v9, v8
v_cos_f32 v180, v9
v_add_f32 v9, v9, v8
v_cos_f32 v181, v9
v_add_f32 v9, v9, v8
v_cos_f32 v182, v9
v_add_f32 v9, v9, v8
v_cos_f32 v183, v9
s_nop 0
v_cvt_pk_bf16_f32 v36, v176, v177
v_cvt_pk_bf16_f32 v37, v178, v179
v_cvt_pk_bf16_f32 v38, v180, v181
v_cvt_pk_bf16_f32 v39, v182, v183
v_add_f32 v8, 0x42400000, v5
v_mul_f32 v8, 0x3c000000, v8
v_add_f32 v9, 0x0, v7
v_fma_f32 v9, v9, v8, v6
v_cos_f32 v176, v9
v_add_f32 v9, v9, v8
v_cos_f32 v177, v9
v_add_f32 v9, v9, v8
v_cos_f32 v178, v9
v_add_f32 v9, v9, v8
v_cos_f32 v179, v9
v_add_f32 v9, v9, v8
v_cos_f32 v180, v9
v_add_f32 v9, v9, v8
v_cos_f32 v181, v9
v_add_f32 v9, v9, v8
v_cos_f32 v182, v9
v_add_f32 v9, v9, v8
v_cos_f32 v183, v9
s_nop 0
v_cvt_pk_bf16_f32 v40, v176, v177
v_cvt_pk_bf16_f32 v41, v178, v179
v_cvt_pk_bf16_f32 v42, v180, v181
v_cvt_pk_bf16_f32 v43, v182, v183
v_add_f32 v9, 0x42000000, v7
v_fma_f32 v9, v9, v8, v6
v_cos_f32 v176, v9
v_add_f32 v9, v9, v8
v_cos_f32 v177, v9
v_add_f32 v9, v9, v8
v_cos_f32 v178, v9
v_add_f32 v9, v9, v8
v_cos_f32 v179, v9
v_add_f32 v9, v9, v8
v_cos_f32 v180, v9
v_add_f32 v9, v9, v8
v_cos_f32 v181, v9
v_add_f32 v9, v9, v8
v_cos_f32 v182, v9
v_add_f32 v9, v9, v8
v_cos_f32 v183, v9
s_nop 0
v_cvt_pk_bf16_f32 v44, v176, v177
v_cvt_pk_bf16_f32 v45, v178, v179
v_cvt_pk_bf16_f32 v46, v180, v181
v_cvt_pk_bf16_f32 v47, v182, v183
v_bfe_u32 v5, v2, 1, 2
v_and_b32 v6, 1, v2
v_lshrrev_b32 v7, 3, v2
v_mul_u32_u24 v8, 100, v5
v_add_u32 v8, v8, v6
v_lshl_add_u32 v8, v3, 4, v8
v_lshlrev_b32 v8, 7, v8
v_add_u32 v8, 105216, v8
s_lshl_b32 s40, s32, 1
v_add_u32 v9, s40, v7
v_add_u32 v14, 0, v5
v_and_b32 v14, 3, v14
v_lshlrev_b32 v14, 1, v14
v_xor_b32 v14, v14, v9
v_lshl_add_u32 v10, v14, 4, v8
v_add_u32 v14, 1, v5
v_and_b32 v14, 3, v14
v_lshlrev_b32 v14, 1, v14
v_xor_b32 v14, v14, v9
v_lshl_add_u32 v11, v14, 4, v8
v_add_u32 v14, 2, v5
v_and_b32 v14, 3, v14
v_lshlrev_b32 v14, 1, v14
v_xor_b32 v14, v14, v9
v_lshl_add_u32 v12, v14, 4, v8
v_add_u32 v14, 3, v5
v_and_b32 v14, 3, v14
v_lshlrev_b32 v14, 1, v14
v_xor_b32 v14, v14, v9
v_lshl_add_u32 v13, v14, 4, v8
v_mul_u32_u24 v14, 40960, v3
v_lshl_add_u32 v14, v7, 4, v14
v_and_b32 v15, 7, v2
v_add_u32 v14, v14, v15
v_lshlrev_b32 v14, 4, v14
s_mul_i32 s51, s49, 163840
s_lshl_b32 s40, s48, 1
s_lshr_b32 s41, s32, 1
s_add_u32 s40, s40, s41
s_mul_i32 s40, s40, 10240
s_add_u32 s51, s51, s40
s_lshr_b32 s40, s50, 1
s_lshl_b32 s40, s40, 11
s_add_u32 s51, s51, s40
s_and_b32 s40, s32, 1
s_lshl_b32 s40, s40, 9
s_add_u32 s51, s51, s40
s_and_b32 s40, s50, 1
s_lshl_b32 s40, s40, 7
s_add_u32 s51, s51, s40
s_mov_b32 s52, 0x05040100
s_mov_b32 s53, 0x07060302
v_mov_b32 v241, 0
s_waitcnt vmcnt(0)
v_mov_b32 v244, 160524
v_mov_b32 v245, 1
s_mov_b64 exec, 1
ds_add_u32 v244, v245
s_mov_b64 exec, -1
v_mov_b32 v244, 160524
s_mov_b32 s41, 0
L_lwx:
ds_read_b32 v245, v244
s_add_u32 s41, s41, 1
s_waitcnt lgkmcnt(0)
v_readfirstlane_b32 s40, v245
s_cmp_gt_u32 s41, 0x100000
s_cbranch_scc1 L_lwdx
s_cmp_lt_u32 s40, 4
s_cbranch_scc1 L_lwx
L_lwdx:
ds_read_b128 v[48:51], v10 offset:0
ds_read_b128 v[52:55], v10 offset:256
ds_read_b128 v[56:59], v11 offset:512
ds_read_b128 v[60:63], v11 offset:768
ds_read_b128 v[64:67], v12 offset:1024
ds_read_b128 v[68:71], v12 offset:1280
ds_read_b128 v[72:75], v13 offset:1536
ds_read_b128 v[76:79], v13 offset:1792
ds_read_b128 v[80:83], v10 offset:8192
ds_read_b128 v[84:87], v10 offset:8448
ds_read_b128 v[88:91], v11 offset:8704
ds_read_b128 v[92:95], v11 offset:8960
ds_read_b128 v[96:99], v12 offset:9216
ds_read_b128 v[100:103], v12 offset:9472
ds_read_b128 v[104:107], v13 offset:9728
ds_read_b128 v[108:111], v13 offset:9984
s_waitcnt lgkmcnt(14)
v_perm_b32 v112, v52, v48, s52
v_perm_b32 v116, v52, v48, s53
v_perm_b32 v120, v53, v49, s52
v_perm_b32 v124, v53, v49, s53
v_perm_b32 v128, v54, v50, s52
v_perm_b32 v132, v54, v50, s53
v_perm_b32 v136, v55, v51, s52
v_perm_b32 v140, v55, v51, s53
s_waitcnt lgkmcnt(12)
v_perm_b32 v113, v60, v56, s52
v_perm_b32 v117, v60, v56, s53
v_perm_b32 v121, v61, v57, s52
v_perm_b32 v125, v61, v57, s53
v_perm_b32 v129, v62, v58, s52
v_perm_b32 v133, v62, v58, s53
v_perm_b32 v137, v63, v59, s52
v_perm_b32 v141, v63, v59, s53
s_waitcnt lgkmcnt(10)
v_perm_b32 v114, v68, v64, s52
v_perm_b32 v118, v68, v64, s53
v_perm_b32 v122, v69, v65, s52
v_perm_b32 v126, v69, v65, s53
v_perm_b32 v130, v70, v66, s52
v_perm_b32 v134, v70, v66, s53
v_perm_b32 v138, v71, v67, s52
v_perm_b32 v142, v71, v67, s53
s_waitcnt lgkmcnt(8)
v_perm_b32 v115, v76, v72, s52
v_perm_b32 v119, v76, v72, s53
v_perm_b32 v123, v77, v73, s52
v_perm_b32 v127, v77, v73, s53
v_perm_b32 v131, v78, v74, s52
v_perm_b32 v135, v78, v74, s53
v_perm_b32 v139, v79, v75, s52
v_perm_b32 v143, v79, v75, s53
s_waitcnt lgkmcnt(6)
v_perm_b32 v144, v84, v80, s52
v_perm_b32 v148, v84, v80, s53
v_perm_b32 v152, v85, v81, s52
v_perm_b32 v156, v85, v81, s53
v_perm_b32 v160, v86, v82, s52
v_perm_b32 v164, v86, v82, s53
v_perm_b32 v168, v87, v83, s52
v_perm_b32 v172, v87, v83, s53
s_waitcnt lgkmcnt(4)
v_perm_b32 v145, v92, v88, s52
v_perm_b32 v149, v92, v88, s53
v_perm_b32 v153, v93, v89, s52
v_perm_b32 v157, v93, v89, s53
v_perm_b32 v161, v94, v90, s52
v_perm_b32 v165, v94, v90, s53
v_perm_b32 v169, v95, v91, s52
v_perm_b32 v173, v95, v91, s53
s_waitcnt lgkmcnt(2)
v_perm_b32 v146, v100, v96, s52
v_perm_b32 v150, v100, v96, s53
v_perm_b32 v154, v101, v97, s52
v_perm_b32 v158, v101, v97, s53
v_perm_b32 v162, v102, v98, s52
v_perm_b32 v166, v102, v98, s53
v_perm_b32 v170, v103, v99, s52
v_perm_b32 v174, v103, v99, s53
s_waitcnt lgkmcnt(0)
v_perm_b32 v147, v108, v104, s52
v_perm_b32 v151, v108, v104, s53
v_perm_b32 v155, v109, v105, s52
v_perm_b32 v159, v109, v105, s53
v_perm_b32 v163, v110, v106, s52
v_perm_b32 v167, v110, v106, s53
v_perm_b32 v171, v111, v107, s52
v_perm_b32 v175, v111, v107, s53
s_nop 1
v_mfma_f32_16x16x32_bf16 v[176:179], v[16:19], v[112:115], 0
v_mfma_f32_16x16x32_bf16 v[180:183], v[16:19], v[116:119], 0
v_mfma_f32_16x16x32_bf16 v[184:187], v[16:19], v[120:123], 0
v_mfma_f32_16x16x32_bf16 v[188:191], v[16:19], v[124:127], 0
v_mfma_f32_16x16x32_bf16 v[192:195], v[16:19], v[128:131], 0
v_mfma_f32_16x16x32_bf16 v[196:199], v[16:19], v[132:135], 0
v_mfma_f32_16x16x32_bf16 v[200:203], v[16:19], v[136:139], 0
v_mfma_f32_16x16x32_bf16 v[204:207], v[16:19], v[140:143], 0
v_mfma_f32_16x16x32_bf16 v[176:179], v[20:23], v[144:147], v[176:179]
v_mfma_f32_16x16x32_bf16 v[180:183], v[20:23], v[148:151], v[180:183]
v_mfma_f32_16x16x32_bf16 v[184:187], v[20:23], v[152:155], v[184:187]
v_mfma_f32_16x16x32_bf16 v[188:191], v[20:23], v[156:159], v[188:191]
v_mfma_f32_16x16x32_bf16 v[192:195], v[20:23], v[160:163], v[192:195]
v_mfma_f32_16x16x32_bf16 v[196:199], v[20:23], v[164:167], v[196:199]
v_mfma_f32_16x16x32_bf16 v[200:203], v[20:23], v[168:171], v[200:203]
v_mfma_f32_16x16x32_bf16 v[204:207], v[20:23], v[172:175], v[204:207]
v_mfma_f32_16x16x32_bf16 v[208:211], v[24:27], v[112:115], 0
v_mfma_f32_16x16x32_bf16 v[212:215], v[24:27], v[116:119], 0
v_mfma_f32_16x16x32_bf16 v[216:219], v[24:27], v[120:123], 0
v_mfma_f32_16x16x32_bf16 v[220:223], v[24:27], v[124:127], 0
s_nop 3
v_cvt_pk_bf16_f32 v48, v176, v180
v_cvt_pk_bf16_f32 v49, v184, v188
v_mfma_f32_16x16x32_bf16 v[224:227], v[24:27], v[128:131], 0
v_cvt_pk_bf16_f32 v50, v192, v196
v_cvt_pk_bf16_f32 v51, v200, v204
v_mfma_f32_16x16x32_bf16 v[228:231], v[24:27], v[132:135], 0
s_add_u32 s40, s51, 0
buffer_store_dwordx4 v[48:51], v14, s[20:23], s40 offen offset:0 sc1
v_mfma_f32_16x16x32_bf16 v[232:235], v[24:27], v[136:139], 0
v_cvt_pk_bf16_f32 v52, v177, v181
v_cvt_pk_bf16_f32 v53, v185, v189
v_mfma_f32_16x16x32_bf16 v[236:239], v[24:27], v[140:143], 0
v_cvt_pk_bf16_f32 v54, v193, v197
v_cvt_pk_bf16_f32 v55, v201, v205
v_mfma_f32_16x16x32_bf16 v[208:211], v[28:31], v[144:147], v[208:211]
s_add_u32 s40, s51, 0
buffer_store_dwordx4 v[52:55], v14, s[20:23], s40 offen offset:1024 sc1
v_mfma_f32_16x16x32_bf16 v[212:215], v[28:31], v[148:151], v[212:215]
v_cvt_pk_bf16_f32 v56, v178, v182
v_cvt_pk_bf16_f32 v57, v186, v190
v_mfma_f32_16x16x32_bf16 v[216:219], v[28:31], v[152:155], v[216:219]
v_cvt_pk_bf16_f32 v58, v194, v198
v_cvt_pk_bf16_f32 v59, v202, v206
v_mfma_f32_16x16x32_bf16 v[220:223], v[28:31], v[156:159], v[220:223]
s_add_u32 s40, s51, 327680
buffer_store_dwordx4 v[56:59], v14, s[20:23], s40 offen offset:0 sc1
v_mfma_f32_16x16x32_bf16 v[224:227], v[28:31], v[160:163], v[224:227]
v_cvt_pk_bf16_f32 v60, v179, v183
v_cvt_pk_bf16_f32 v61, v187, v191
v_mfma_f32_16x16x32_bf16 v[228:231], v[28:31], v[164:167], v[228:231]
v_cvt_pk_bf16_f32 v62, v195, v199
v_cvt_pk_bf16_f32 v63, v203, v207
v_mfma_f32_16x16x32_bf16 v[232:235], v[28:31], v[168:171], v[232:235]
s_add_u32 s40, s51, 327680
buffer_store_dwordx4 v[60:63], v14, s[20:23], s40 offen offset:1024 sc1
v_mfma_f32_16x16x32_bf16 v[236:239], v[28:31], v[172:175], v[236:239]
v_mfma_f32_16x16x32_bf16 v[176:179], v[32:35], v[112:115], 0
v_mfma_f32_16x16x32_bf16 v[180:183], v[32:35], v[116:119], 0
v_mfma_f32_16x16x32_bf16 v[184:187], v[32:35], v[120:123], 0
v_mfma_f32_16x16x32_bf16 v[188:191], v[32:35], v[124:127], 0
s_nop 3
v_cvt_pk_bf16_f32 v64, v208, v212
v_cvt_pk_bf16_f32 v65, v216, v220
v_mfma_f32_16x16x32_bf16 v[192:195], v[32:35], v[128:131], 0
v_cvt_pk_bf16_f32 v66, v224, v228
v_cvt_pk_bf16_f32 v67, v232, v236
v_mfma_f32_16x16x32_bf16 v[196:199], v[32:35], v[132:135], 0
s_add_u32 s40, s51, 2621440
buffer_store_dwordx4 v[64:67], v14, s[20:23], s40 offen offset:0 sc1
v_mfma_f32_16x16x32_bf16 v[200:203], v[32:35], v[136:139], 0
v_cvt_pk_bf16_f32 v68, v209, v213
v_cvt_pk_bf16_f32 v69, v217, v221
v_mfma_f32_16x16x32_bf16 v[204:207], v[32:35], v[140:143], 0
v_cvt_pk_bf16_f32 v70, v225, v229
v_cvt_pk_bf16_f32 v71, v233, v237
v_mfma_f32_16x16x32_bf16 v[176:179], v[36:39], v[144:147], v[176:179]
s_add_u32 s40, s51, 2621440
buffer_store_dwordx4 v[68:71], v14, s[20:23], s40 offen offset:1024 sc1
v_mfma_f32_16x16x32_bf16 v[180:183], v[36:39], v[148:151], v[180:183]
v_cvt_pk_bf16_f32 v72, v210, v214
v_cvt_pk_bf16_f32 v73, v218, v222
v_mfma_f32_16x16x32_bf16 v[184:187], v[36:39], v[152:155], v[184:187]
v_cvt_pk_bf16_f32 v74, v226, v230
v_cvt_pk_bf16_f32 v75, v234, v238
v_mfma_f32_16x16x32_bf16 v[188:191], v[36:39], v[156:159], v[188:191]
s_add_u32 s40, s51, 2949120
buffer_store_dwordx4 v[72:75], v14, s[20:23], s40 offen offset:0 sc1
v_mfma_f32_16x16x32_bf16 v[192:195], v[36:39], v[160:163], v[192:195]
v_cvt_pk_bf16_f32 v76, v211, v215
v_cvt_pk_bf16_f32 v77, v219, v223
v_mfma_f32_16x16x32_bf16 v[196:199], v[36:39], v[164:167], v[196:199]
v_cvt_pk_bf16_f32 v78, v227, v231
v_cvt_pk_bf16_f32 v79, v235, v239
v_mfma_f32_16x16x32_bf16 v[200:203], v[36:39], v[168:171], v[200:203]
s_add_u32 s40, s51, 2949120
buffer_store_dwordx4 v[76:79], v14, s[20:23], s40 offen offset:1024 sc1
v_mfma_f32_16x16x32_bf16 v[204:207], v[36:39], v[172:175], v[204:207]
v_mfma_f32_16x16x32_bf16 v[208:211], v[40:43], v[112:115], 0
v_mfma_f32_16x16x32_bf16 v[212:215], v[40:43], v[116:119], 0
v_mfma_f32_16x16x32_bf16 v[216:219], v[40:43], v[120:123], 0
v_mfma_f32_16x16x32_bf16 v[220:223], v[40:43], v[124:127], 0
s_nop 3
v_cvt_pk_bf16_f32 v80, v176, v180
v_cvt_pk_bf16_f32 v81, v184, v188
v_mfma_f32_16x16x32_bf16 v[224:227], v[40:43], v[128:131], 0
v_cvt_pk_bf16_f32 v82, v192, v196
v_cvt_pk_bf16_f32 v83, v200, v204
v_mfma_f32_16x16x32_bf16 v[228:231], v[40:43], v[132:135], 0
s_add_u32 s40, s51, 5242880
buffer_store_dwordx4 v[80:83], v14, s[20:23], s40 offen offset:0 sc1
v_mfma_f32_16x16x32_bf16 v[232:235], v[40:43], v[136:139], 0
v_cvt_pk_bf16_f32 v84, v177, v181
v_cvt_pk_bf16_f32 v85, v185, v189
v_mfma_f32_16x16x32_bf16 v[236:239], v[40:43], v[140:143], 0
v_cvt_pk_bf16_f32 v86, v193, v197
v_cvt_pk_bf16_f32 v87, v201, v205
v_mfma_f32_16x16x32_bf16 v[208:211], v[44:47], v[144:147], v[208:211]
s_add_u32 s40, s51, 5242880
buffer_store_dwordx4 v[84:87], v14, s[20:23], s40 offen offset:1024 sc1
v_mfma_f32_16x16x32_bf16 v[212:215], v[44:47], v[148:151], v[212:215]
v_cvt_pk_bf16_f32 v88, v178, v182
v_cvt_pk_bf16_f32 v89, v186, v190
v_mfma_f32_16x16x32_bf16 v[216:219], v[44:47], v[152:155], v[216:219]
v_cvt_pk_bf16_f32 v90, v194, v198
v_cvt_pk_bf16_f32 v91, v202, v206
v_mfma_f32_16x16x32_bf16 v[220:223], v[44:47], v[156:159], v[220:223]
s_add_u32 s40, s51, 5570560
buffer_store_dwordx4 v[88:91], v14, s[20:23], s40 offen offset:0 sc1
v_mfma_f32_16x16x32_bf16 v[224:227], v[44:47], v[160:163], v[224:227]
v_cvt_pk_bf16_f32 v92, v179, v183
v_cvt_pk_bf16_f32 v93, v187, v191
v_mfma_f32_16x16x32_bf16 v[228:231], v[44:47], v[164:167], v[228:231]
v_cvt_pk_bf16_f32 v94, v195, v199
v_cvt_pk_bf16_f32 v95, v203, v207
v_mfma_f32_16x16x32_bf16 v[232:235], v[44:47], v[168:171], v[232:235]
s_add_u32 s40, s51, 5570560
buffer_store_dwordx4 v[92:95], v14, s[20:23], s40 offen offset:1024 sc1
v_mfma_f32_16x16x32_bf16 v[236:239], v[44:47], v[172:175], v[236:239]
buffer_load_dword v240, v241, s[28:31], 0 offen sc1
s_nop 6
v_cvt_pk_bf16_f32 v96, v208, v212
v_cvt_pk_bf16_f32 v97, v216, v220
v_cvt_pk_bf16_f32 v98, v224, v228
v_cvt_pk_bf16_f32 v99, v232, v236
s_add_u32 s40, s51, 7864320
buffer_store_dwordx4 v[96:99], v14, s[20:23], s40 offen offset:0 sc1
v_cvt_pk_bf16_f32 v100, v209, v213
v_cvt_pk_bf16_f32 v101, v217, v221
v_cvt_pk_bf16_f32 v102, v225, v229
v_cvt_pk_bf16_f32 v103, v233, v237
s_add_u32 s40, s51, 7864320
buffer_store_dwordx4 v[100:103], v14, s[20:23], s40 offen offset:1024 sc1
v_cvt_pk_bf16_f32 v104, v210, v214
v_cvt_pk_bf16_f32 v105, v218, v222
v_cvt_pk_bf16_f32 v106, v226, v230
v_cvt_pk_bf16_f32 v107, v234, v238
s_add_u32 s40, s51, 8192000
buffer_store_dwordx4 v[104:107], v14, s[20:23], s40 offen offset:0 sc1
v_cvt_pk_bf16_f32 v108, v211, v215
v_cvt_pk_bf16_f32 v109, v219, v223
v_cvt_pk_bf16_f32 v110, v227, v231
v_cvt_pk_bf16_f32 v111, v235, v239
s_add_u32 s40, s51, 8192000
buffer_store_dwordx4 v[108:111], v14, s[20:23], s40 offen offset:1024 sc1
s_waitcnt vmcnt(0)
s_mov_b32 s41, 0
L_wix:
v_readfirstlane_b32 s40, v240
s_add_u32 s41, s41, 1
s_cmp_lg_u32 s40, 0
s_cbranch_scc1 L_widx
s_cmp_gt_u32 s41, 0x8000
s_cbranch_scc1 L_widx
s_sleep 2
buffer_load_dword v240, v241, s[28:31], 0 offen sc1
s_waitcnt vmcnt(0)
s_branch L_wix
L_widx:
v_mov_b32 v8, 160512
v_mov_b32 v9, 1
s_mov_b64 exec, 1
ds_add_rtn_u32 v10, v8, v9
s_mul_i32 s40, s33, 4224
s_add_u32 s40, s40, 0
v_mov_b32 v8, 0
s_waitcnt lgkmcnt(0)
v_readfirstlane_b32 s41, v10
s_nop 0
s_cmp_lg_u32 s41, 3
s_cbranch_scc1 L_nb1
v_mov_b32 v10, 1
buffer_atomic_add v10, v8, s[24:27], s40 offen sc0 sc1
L_nb1:
s_barrier
s_cmp_lg_u32 s41, 3
s_cbranch_scc1 L_na1
s_add_u32 s40, s40, 33792
s_waitcnt vmcnt(0)
v_readfirstlane_b32 s41, v10
s_nop 0
s_cmp_lg_u32 s41, 19
s_cbranch_scc1 L_na1
buffer_store_dword v9, v8, s[24:27], s40 offen sc1
L_na1:
s_mov_b64 exec, -1
s_branch L_setup
L_aux:
s_and_b32 s40, s33, 1
s_xor_b32 s40, s40, 1
s_lshr_b32 s41, s33, 2
s_lshl_b32 s41, s41, 1
s_add_u32 s37, s40, s41
s_bfe_u32 s40, s33, 0x10001
s_lshl_b32 s40, s40, 3
s_and_b32 s41, s34, 7
s_add_u32 s35, s40, s41
s_lshl_b32 s40, s37, 2
s_lshr_b32 s41, s34, 3
s_add_u32 s36, s40, s41
s_waitcnt lgkmcnt(0)
s_add_u32 s24, s14, 62914560
s_addc_u32 s25, s15, 0
s_mov_b32 s26, 211200
s_mov_b32 s27, 0x20000
s_mov_b32 s28, s12
s_mov_b32 s29, s13
s_mov_b32 s30, 256
s_mov_b32 s31, 0x20000
v_mov_b32 v241, 0
s_cmp_lg_u32 s2, 193
s_cbranch_scc1 L_noinit
s_cmp_lg_u32 s32, 2
s_cbranch_scc1 L_noinit
v_min_u32 v4, 49, v1
v_mul_u32_u24 v4, 4224, v4
v_mov_b32 v5, 1
buffer_store_dword v241, v4, s[24:27], 0 offen sc1
s_waitcnt vmcnt(0)
buffer_store_dword v5, v241, s[28:31], 0 offen sc1
L_noinit:
s_barrier
s_mov_b32 s16, s6
s_mov_b32 s17, s7
s_mov_b32 s18, 15728640
s_mov_b32 s19, 0x20000
v_lshlrev_b32 v242, 7, v1
s_sub_u32 s49, s34, 20
s_lshl_b32 s49, s49, 2
s_lshr_b32 s40, s33, 1
s_add_u32 s49, s49, s40
s_lshl_b32 s49, s49, 2
s_add_u32 s49, s49, s32
s_mov_b32 s50, 0
s_bitcmp0_b32 s37, 0
s_cbranch_scc1 L_late
s_add_u32 s40, s49, 0
s_mul_i32 s41, s40, 8739
s_lshr_b32 s41, s41, 20
s_mul_i32 s42, s41, 120
s_sub_u32 s42, s40, s42
s_add_u32 s41, s41, 1
s_mul_i32 s43, s42, 4370
s_lshr_b32 s43, s43, 16
s_mul_i32 s40, s43, 15
s_sub_u32 s42, s42, s40
s_lshl_b32 s42, s42, 20
s_lshl_b32 s43, s43, 13
s_add_u32 s42, s42, s43
s_lshl_b32 s43, s41, 16
s_add_u32 s42, s42, s43
buffer_load_dword v243, v242, s[16:19], s42 offen
s_add_u32 s40, s49, 256
s_mul_i32 s41, s40, 8739
s_lshr_b32 s41, s41, 20
s_mul_i32 s42, s41, 120
s_sub_u32 s42, s40, s42
s_add_u32 s41, s41, 1
s_mul_i32 s43, s42, 4370
s_lshr_b32 s43, s43, 16
s_mul_i32 s40, s43, 15
s_sub_u32 s42, s42, s40
s_lshl_b32 s42, s42, 20
s_lshl_b32 s43, s43, 13
s_add_u32 s42, s42, s43
s_lshl_b32 s43, s41, 16
s_add_u32 s42, s42, s43
buffer_load_dword v244, v242, s[16:19], s42 offen
s_add_u32 s40, s49, 512
s_mul_i32 s41, s40, 8739
s_lshr_b32 s41, s41, 20
s_mul_i32 s42, s41, 120
s_sub_u32 s42, s40, s42
s_add_u32 s41, s41, 1
s_mul_i32 s43, s42, 4370
s_lshr_b32 s43, s43, 16
s_mul_i32 s40, s43, 15
s_sub_u32 s42, s42, s40
s_lshl_b32 s42, s42, 20
s_lshl_b32 s43, s43, 13
s_add_u32 s42, s42, s43
s_lshl_b32 s43, s41, 16
s_add_u32 s42, s42, s43
buffer_load_dword v245, v242, s[16:19], s42 offen
s_add_u32 s40, s49, 768
s_mul_i32 s41, s40, 8739
s_lshr_b32 s41, s41, 20
s_mul_i32 s42, s41, 120
s_sub_u32 s42, s40, s42
s_add_u32 s41, s41, 1
s_mul_i32 s43, s42, 4370
s_lshr_b32 s43, s43, 16
s_mul_i32 s40, s43, 15
s_sub_u32 s42, s42, s40
s_lshl_b32 s42, s42, 20
s_lshl_b32 s43, s43, 13
s_add_u32 s42, s42, s43
s_lshl_b32 s43, s41, 16
s_add_u32 s42, s42, s43
buffer_load_dword v246, v242, s[16:19], s42 offen
s_add_u32 s40, s49, 1024
s_mul_i32 s41, s40, 8739
s_lshr_b32 s41, s41, 20
s_mul_i32 s42, s41, 120
s_sub_u32 s42, s40, s42
s_add_u32 s41, s41, 1
s_mul_i32 s43, s42, 4370
s_lshr_b32 s43, s43, 16
s_mul_i32 s40, s43, 15
s_sub_u32 s42, s42, s40
s_lshl_b32 s42, s42, 20
s_lshl_b32 s43, s43, 13
s_add_u32 s42, s42, s43
s_lshl_b32 s43, s41, 16
s_add_u32 s42, s42, s43
buffer_load_dword v247, v242, s[16:19], s42 offen
s_branch L_auxd
L_late:
s_cmp_ge_u32 s34, 24
s_cbranch_scc1 L_auxd
s_mov_b32 s50, 1
s_add_u32 s40, s49, 192
s_mul_i32 s41, s40, 8739
s_lshr_b32 s41, s41, 20
s_mul_i32 s42, s41, 120
s_sub_u32 s42, s40, s42
s_add_u32 s41, s41, 1
s_mul_i32 s43, s42, 4370
s_lshr_b32 s43, s43, 16
s_mul_i32 s40, s43, 15
s_sub_u32 s42, s42, s40
s_lshl_b32 s42, s42, 20
s_lshl_b32 s43, s43, 13
s_add_u32 s42, s42, s43
s_lshl_b32 s43, s41, 16
s_add_u32 s42, s42, s43
buffer_load_dword v243, v242, s[16:19], s42 offen
s_add_u32 s40, s49, 448
s_mul_i32 s41, s40, 8739
s_lshr_b32 s41, s41, 20
s_mul_i32 s42, s41, 120
s_sub_u32 s42, s40, s42
s_add_u32 s41, s41, 1
s_mul_i32 s43, s42, 4370
s_lshr_b32 s43, s43, 16
s_mul_i32 s40, s43, 15
s_sub_u32 s42, s42, s40
s_lshl_b32 s42, s42, 20
s_lshl_b32 s43, s43, 13
s_add_u32 s42, s42, s43
s_lshl_b32 s43, s41, 16
s_add_u32 s42, s42, s43
buffer_load_dword v244, v242, s[16:19], s42 offen
s_add_u32 s40, s49, 704
s_mul_i32 s41, s40, 8739
s_lshr_b32 s41, s41, 20
s_mul_i32 s42, s41, 120
s_sub_u32 s42, s40, s42
s_add_u32 s41, s41, 1
s_mul_i32 s43, s42, 4370
s_lshr_b32 s43, s43, 16
s_mul_i32 s40, s43, 15
s_sub_u32 s42, s42, s40
s_lshl_b32 s42, s42, 20
s_lshl_b32 s43, s43, 13
s_add_u32 s42, s42, s43
s_lshl_b32 s43, s41, 16
s_add_u32 s42, s42, s43
buffer_load_dword v245, v242, s[16:19], s42 offen
s_add_u32 s40, s49, 960
s_mul_i32 s41, s40, 8739
s_lshr_b32 s41, s41, 20
s_mul_i32 s42, s41, 120
s_sub_u32 s42, s40, s42
s_add_u32 s41, s41, 1
s_mul_i32 s43, s42, 4370
s_lshr_b32 s43, s43, 16
s_mul_i32 s40, s43, 15
s_sub_u32 s42, s42, s40
s_lshl_b32 s42, s42, 20
s_lshl_b32 s43, s43, 13
s_add_u32 s42, s42, s43
s_lshl_b32 s43, s41, 16
s_add_u32 s42, s42, s43
buffer_load_dword v246, v242, s[16:19], s42 offen
s_mov_b32 s16, s8
s_mov_b32 s17, s9
s_mov_b32 s18, 524288
s_mov_b32 s19, 0x20000
s_add_u32 s20, s14, 46137344
s_addc_u32 s21, s15, 0
s_mov_b32 s22, 524288
s_mov_b32 s23, 0x20000
s_lshr_b32 s40, s49, 2
s_and_b32 s41, s49, 3
v_lshlrev_b32 v5, 4, v1
s_and_b32 s42, s40, 12
s_lshr_b32 s42, 0x1302, s42
s_and_b32 s42, s42, 3
s_lshl_b32 s42, s42, 2
s_and_b32 s43, s40, 3
s_add_u32 s42, s42, s43
s_lshl_b32 s42, s42, 15
s_mov_b32 s44, 13
s_mov_b32 s45, 2048
s_lshl_b32 s43, s41, 8
s_add_u32 s42, s42, s43
v_lshlrev_b32 v4, s44, v3
v_lshl_add_u32 v4, v2, 4, v4
buffer_load_dwordx4 v[16:19], v4, s[16:19], s42 offen offset:0
buffer_load_dwordx4 v[20:23], v4, s[16:19], s42 offen offset:1024
s_add_u32 s42, s42, s45
buffer_load_dwordx4 v[24:27], v4, s[16:19], s42 offen offset:0
buffer_load_dwordx4 v[28:31], v4, s[16:19], s42 offen offset:1024
s_add_u32 s42, s42, s45
buffer_load_dwordx4 v[32:35], v4, s[16:19], s42 offen offset:0
buffer_load_dwordx4 v[36:39], v4, s[16:19], s42 offen offset:1024
s_add_u32 s42, s42, s45
buffer_load_dwordx4 v[40:43], v4, s[16:19], s42 offen offset:0
buffer_load_dwordx4 v[44:47], v4, s[16:19], s42 offen offset:1024
s_add_u32 s42, s42, s45
s_mov_b32 s52, 0x05040100
s_mov_b32 s53, 0x07060302
s_lshl_b32 s41, s41, 17
s_lshl_b32 s40, s40, 13
s_add_u32 s44, s40, s41
s_add_u32 s45, s44, 4096
s_waitcnt vmcnt(0)
v_perm_b32 v48, v20, v16, s52
v_perm_b32 v49, v28, v24, s52
v_perm_b32 v50, v36, v32, s52
v_perm_b32 v51, v44, v40, s52
buffer_store_dwordx4 v[48:51], v5, s[20:23], s44 offen offset:0 sc1
v_perm_b32 v52, v20, v16, s53
v_perm_b32 v53, v28, v24, s53
v_perm_b32 v54, v36, v32, s53
v_perm_b32 v55, v44, v40, s53
buffer_store_dwordx4 v[52:55], v5, s[20:23], s44 offen offset:1024 sc1
v_perm_b32 v56, v21, v17, s52
v_perm_b32 v57, v29, v25, s52
v_perm_b32 v58, v37, v33, s52
v_perm_b32 v59, v45, v41, s52
buffer_store_dwordx4 v[56:59], v5, s[20:23], s44 offen offset:2048 sc1
v_perm_b32 v60, v21, v17, s53
v_perm_b32 v61, v29, v25, s53
v_perm_b32 v62, v37, v33, s53
v_perm_b32 v63, v45, v41, s53
buffer_store_dwordx4 v[60:63], v5, s[20:23], s44 offen offset:3072 sc1
v_perm_b32 v64, v22, v18, s52
v_perm_b32 v65, v30, v26, s52
v_perm_b32 v66, v38, v34, s52
v_perm_b32 v67, v46, v42, s52
buffer_store_dwordx4 v[64:67], v5, s[20:23], s45 offen offset:0 sc1
v_perm_b32 v68, v22, v18, s53
v_perm_b32 v69, v30, v26, s53
v_perm_b32 v70, v38, v34, s53
v_perm_b32 v71, v46, v42, s53
buffer_store_dwordx4 v[68:71], v5, s[20:23], s45 offen offset:1024 sc1
v_perm_b32 v72, v23, v19, s52
v_perm_b32 v73, v31, v27, s52
v_perm_b32 v74, v39, v35, s52
v_perm_b32 v75, v47, v43, s52
buffer_store_dwordx4 v[72:75], v5, s[20:23], s45 offen offset:2048 sc1
v_perm_b32 v76, v23, v19, s53
v_perm_b32 v77, v31, v27, s53
v_perm_b32 v78, v39, v35, s53
v_perm_b32 v79, v47, v43, s53
buffer_store_dwordx4 v[76:79], v5, s[20:23], s45 offen offset:3072 sc1
L_auxd:
buffer_load_dword v240, v241, s[28:31], 0 offen sc1
s_barrier
s_waitcnt vmcnt(0)
s_mov_b32 s41, 0
L_wia:
v_readfirstlane_b32 s40, v240
s_add_u32 s41, s41, 1
s_cmp_lg_u32 s40, 0
s_cbranch_scc1 L_wida
s_cmp_gt_u32 s41, 0x8000
s_cbranch_scc1 L_wida
s_sleep 2
buffer_load_dword v240, v241, s[28:31], 0 offen sc1
s_waitcnt vmcnt(0)
s_branch L_wia
L_wida:
s_cmp_eq_u32 s50, 0
s_cbranch_scc1 L_setup
v_mov_b32 v8, 160512
v_mov_b32 v9, 1
s_mov_b64 exec, 1
ds_add_rtn_u32 v10, v8, v9
s_mov_b32 s40, 135168
v_mov_b32 v8, 0
s_waitcnt lgkmcnt(0)
v_readfirstlane_b32 s41, v10
s_nop 0
s_cmp_lg_u32 s41, 3
s_cbranch_scc1 L_nbj
v_mov_b32 v10, 1
buffer_atomic_add v10, v8, s[24:27], s40 offen sc0 sc1
L_nbj:
s_cmp_lg_u32 s41, 3
s_cbranch_scc1 L_naj
s_add_u32 s40, s40, 4224
s_waitcnt vmcnt(0)
v_readfirstlane_b32 s41, v10
s_nop 0
s_cmp_lg_u32 s41, 15
s_cbranch_scc1 L_naj
buffer_store_dword v9, v8, s[24:27], s40 offen sc1
L_naj:
s_mov_b64 exec, -1
L_setup:
s_mov_b32 s38, s2
s_and_b32 s48, s32, 1
s_lshr_b32 s49, s32, 1
s_lshl_b32 s50, s35, 1
s_add_u32 s50, s50, s48
s_lshl_b32 s40, s50, 1
s_add_u32 s40, s40, s49
s_mul_i32 s40, s40, 163840
s_add_u32 s16, s14, s40
s_addc_u32 s17, s15, 0
s_mov_b32 s18, 163840
s_mov_b32 s19, 0x20000
s_add_u32 s20, s14, 16777216
s_addc_u32 s21, s15, 0
s_mov_b32 s22, 20992000
s_mov_b32 s23, 0x20000
v_lshlrev_b32 v4, 4, v1
s_mul_i32 s54, s48, 8192
s_add_u32 s54, s54, 0
v_add_u32 v5, s54, v4
v_mul_u32_u24 v6, 32800, v3
v_add_u32 v6, v6, v2
v_lshlrev_b32 v6, 4, v6
s_mul_i32 s55, s49, 10496000
s_mul_i32 s41, s50, 4096
s_add_u32 s55, s55, s41
s_lshl_b32 s41, s36, 8
s_add_u32 s55, s55, s41
v_mov_b32 v96, 0
v_mov_b32 v97, 0
v_mov_b32 v98, 0
v_mov_b32 v99, 0
v_mov_b32 v100, 0
v_mov_b32 v101, 0
v_mov_b32 v102, 0
v_mov_b32 v103, 0
v_mov_b32 v104, 0
v_mov_b32 v105, 0
v_mov_b32 v106, 0
v_mov_b32 v107, 0
v_mov_b32 v108, 0
v_mov_b32 v109, 0
v_mov_b32 v110, 0
v_mov_b32 v111, 0
v_mov_b32 v112, 0
v_mov_b32 v113, 0
v_mov_b32 v114, 0
v_mov_b32 v115, 0
v_mov_b32 v116, 0
v_mov_b32 v117, 0
v_mov_b32 v118, 0
v_mov_b32 v119, 0
v_mov_b32 v120, 0
v_mov_b32 v121, 0
v_mov_b32 v122, 0
v_mov_b32 v123, 0
v_mov_b32 v124, 0
v_mov_b32 v125, 0
v_mov_b32 v126, 0
v_mov_b32 v127, 0
v_mov_b32 v128, 0
v_mov_b32 v129, 0
v_mov_b32 v130, 0
v_mov_b32 v131, 0
v_mov_b32 v132, 0
v_mov_b32 v133, 0
v_mov_b32 v134, 0
v_mov_b32 v135, 0
v_mov_b32 v136, 0
v_mov_b32 v137, 0
v_mov_b32 v138, 0
v_mov_b32 v139, 0
v_mov_b32 v140, 0
v_mov_b32 v141, 0
v_mov_b32 v142, 0
v_mov_b32 v143, 0
v_mov_b32 v144, 0
v_mov_b32 v145, 0
v_mov_b32 v146, 0
v_mov_b32 v147, 0
v_mov_b32 v148, 0
v_mov_b32 v149, 0
v_mov_b32 v150, 0
v_mov_b32 v151, 0
v_mov_b32 v152, 0
v_mov_b32 v153, 0
v_mov_b32 v154, 0
v_mov_b32 v155, 0
v_mov_b32 v156, 0
v_mov_b32 v157, 0
v_mov_b32 v158, 0
v_mov_b32 v159, 0
v_mov_b32 v160, 0
v_mov_b32 v161, 0
v_mov_b32 v162, 0
v_mov_b32 v163, 0
v_mov_b32 v164, 0
v_mov_b32 v165, 0
v_mov_b32 v166, 0
v_mov_b32 v167, 0
v_mov_b32 v168, 0
v_mov_b32 v169, 0
v_mov_b32 v170, 0
v_mov_b32 v171, 0
v_mov_b32 v172, 0
v_mov_b32 v173, 0
v_mov_b32 v174, 0
v_mov_b32 v175, 0
v_mov_b32 v176, 0
v_mov_b32 v177, 0
v_mov_b32 v178, 0
v_mov_b32 v179, 0
v_mov_b32 v180, 0
v_mov_b32 v181, 0
v_mov_b32 v182, 0
v_mov_b32 v183, 0
v_mov_b32 v184, 0
v_mov_b32 v185, 0
v_mov_b32 v186, 0
v_mov_b32 v187, 0
v_mov_b32 v188, 0
v_mov_b32 v189, 0
v_mov_b32 v190, 0
v_mov_b32 v191, 0
v_mov_b32 v192, 0
v_mov_b32 v193, 0
v_mov_b32 v194, 0
v_mov_b32 v195, 0
v_mov_b32 v196, 0
v_mov_b32 v197, 0
v_mov_b32 v198, 0
v_mov_b32 v199, 0
v_mov_b32 v200, 0
v_mov_b32 v201, 0
v_mov_b32 v202, 0
v_mov_b32 v203, 0
v_mov_b32 v204, 0
v_mov_b32 v205, 0
v_mov_b32 v206, 0
v_mov_b32 v207, 0
v_mov_b32 v208, 0
v_mov_b32 v209, 0
v_mov_b32 v210, 0
v_mov_b32 v211, 0
v_mov_b32 v212, 0
v_mov_b32 v213, 0
v_mov_b32 v214, 0
v_mov_b32 v215, 0
v_mov_b32 v216, 0
v_mov_b32 v217, 0
v_mov_b32 v218, 0
v_mov_b32 v219, 0
v_mov_b32 v220, 0
v_mov_b32 v221, 0
v_mov_b32 v222, 0
v_mov_b32 v223, 0
v_mov_b32 v224, 0
v_mov_b32 v225, 0
v_mov_b32 v226, 0
v_mov_b32 v227, 0
v_mov_b32 v228, 0
v_mov_b32 v229, 0
v_mov_b32 v230, 0
v_mov_b32 v231, 0
v_mov_b32 v232, 0
v_mov_b32 v233, 0
v_mov_b32 v234, 0
v_mov_b32 v235, 0
v_mov_b32 v236, 0
v_mov_b32 v237, 0
v_mov_b32 v238, 0
v_mov_b32 v239, 0
v_mov_b32 v240, 0
v_mov_b32 v241, 0
v_mov_b32 v242, 0
v_mov_b32 v243, 0
v_mov_b32 v244, 0
v_mov_b32 v245, 0
v_mov_b32 v246, 0
v_mov_b32 v247, 0
v_mov_b32 v248, 0
v_mov_b32 v249, 0
v_mov_b32 v250, 0
v_mov_b32 v251, 0
v_mov_b32 v252, 0
v_mov_b32 v253, 0
v_mov_b32 v254, 0
v_mov_b32 v255, 0
s_mov_b32 s51, 0
s_mov_b32 s52, 0x80008000
s_mov_b32 s53, 15
s_cmp_lg_u32 s32, 0
s_cbranch_scc1 L_pd1
v_and_b32 v8, 7, v1
v_mul_u32_u24 v8, 4224, v8
s_mov_b32 s42, 33792
s_mov_b32 s41, 0
s_mov_b64 exec, 0xff
L_pl1:
buffer_load_dword v9, v8, s[24:27], s42 offen sc1
s_add_u32 s41, s41, 1
s_cmp_gt_u32 s41, 0x8000
s_cbranch_scc1 L_px1
s_waitcnt vmcnt(0)
v_cmp_ne_u32 vcc, 1, v9
s_nop 1
s_cbranch_vccz L_px1
s_sleep 1
s_branch L_pl1
L_px1:
s_mov_b64 exec, -1
v_mov_b32 v8, 160540
v_mov_b32 v9, 1
s_mov_b64 exec, 1
ds_add_u32 v8, v9
s_mov_b64 exec, -1
L_pd1:
v_mov_b32 v8, 160540
s_mov_b32 s41, 0
L_lwi:
ds_read_b32 v9, v8
s_add_u32 s41, s41, 1
s_waitcnt lgkmcnt(0)
v_readfirstlane_b32 s40, v9
s_cmp_gt_u32 s41, 0x100000
s_cbranch_scc1 L_lwdi
s_cmp_lt_u32 s40, 1
s_cbranch_scc1 L_lwi
L_lwdi:
buffer_load_dwordx4 v[56:59], v4, s[16:19], s51 offen offset:0 sc1
buffer_load_dwordx4 v[60:63], v4, s[16:19], s51 offen offset:1024 sc1
s_add_u32 s51, s51, 2048
buffer_load_dwordx4 v[64:67], v4, s[16:19], s51 offen offset:0 sc1
buffer_load_dwordx4 v[68:71], v4, s[16:19], s51 offen offset:1024 sc1
s_add_u32 s51, s51, 2048
buffer_load_dwordx4 v[72:75], v4, s[16:19], s51 offen offset:0 sc1
buffer_load_dwordx4 v[76:79], v4, s[16:19], s51 offen offset:1024 sc1
s_add_u32 s51, s51, 2048
buffer_load_dwordx4 v[80:83], v4, s[16:19], s51 offen offset:0 sc1
buffer_load_dwordx4 v[84:87], v4, s[16:19], s51 offen offset:1024 sc1
s_add_u32 s51, s51, 2048
buffer_load_dwordx4 v[88:91], v4, s[16:19], s51 offen offset:0 sc1
buffer_load_dwordx4 v[92:95], v4, s[16:19], s51 offen offset:1024 sc1
s_add_u32 s51, s51, 2048
s_sub_u32 s51, s51, 4096
s_lshl_b32 s40, s32, 2
s_add_u32 s40, s40, 160544
v_mov_b32 v0, s40
v_mov_b32 v7, 1
s_mov_b32 s56, 0x01010101
s_mov_b32 s41, 0
L_w0:
ds_read_b32 v3, v0 offset:16
s_add_u32 s41, s41, 1
s_waitcnt lgkmcnt(0)
v_readfirstlane_b32 s57, v3
s_cmp_gt_u32 s41, 0x100000
s_cbranch_scc1 L_w0d
s_sub_u32 s57, s57, s56
s_and_b32 s57, s57, 0x80808080
s_cbranch_scc1 L_w0
L_w0d:
s_mov_b32 s56, 0x02020202
ds_read_b128 v[8:11], v5 offset:0
ds_read_b128 v[24:27], v5 offset:4096
ds_read_b128 v[12:15], v5 offset:1024
ds_read_b128 v[28:31], v5 offset:5120
ds_read_b128 v[16:19], v5 offset:2048
ds_read_b128 v[32:35], v5 offset:6144
ds_read_b128 v[20:23], v5 offset:3072
ds_read_b128 v[36:39], v5 offset:7168
s_setprio 1
.p2align 6
L_gl:
s_waitcnt vmcnt(8) lgkmcnt(6)
v_mfma_f32_16x16x32_bf16 v[100:103], v[56:59], v[24:27], v[100:103]
v_xor_b32 v40, s52, v24
v_mfma_f32_16x16x32_bf16 v[100:103], v[60:63], v[8:11], v[100:103]
v_xor_b32 v41, s52, v25
v_mfma_f32_16x16x32_bf16 v[96:99], v[56:59], v[8:11], v[96:99]
v_xor_b32 v42, s52, v26
s_waitcnt lgkmcnt(4)
v_mfma_f32_16x16x32_bf16 v[108:111], v[56:59], v[28:31], v[108:111]
v_xor_b32 v43, s52, v27
v_xor_b32 v44, s52, v28
v_mfma_f32_16x16x32_bf16 v[108:111], v[60:63], v[12:15], v[108:111]
v_xor_b32 v45, s52, v29
v_mfma_f32_16x16x32_bf16 v[104:107], v[56:59], v[12:15], v[104:107]
v_xor_b32 v46, s52, v30
s_waitcnt lgkmcnt(2)
v_mfma_f32_16x16x32_bf16 v[116:119], v[56:59], v[32:35], v[116:119]
v_xor_b32 v47, s52, v31
v_xor_b32 v48, s52, v32
v_mfma_f32_16x16x32_bf16 v[116:119], v[60:63], v[16:19], v[116:119]
v_xor_b32 v49, s52, v33
v_mfma_f32_16x16x32_bf16 v[112:115], v[56:59], v[16:19], v[112:115]
v_xor_b32 v50, s52, v34
s_add_u32 s51, s51, 4096
s_waitcnt lgkmcnt(0)
v_mfma_f32_16x16x32_bf16 v[124:127], v[56:59], v[36:39], v[124:127]
v_xor_b32 v51, s52, v35
v_xor_b32 v52, s52, v36
v_mfma_f32_16x16x32_bf16 v[124:127], v[60:63], v[20:23], v[124:127]
v_xor_b32 v53, s52, v37
v_mfma_f32_16x16x32_bf16 v[120:123], v[56:59], v[20:23], v[120:123]
v_xor_b32 v54, s52, v38
buffer_load_dwordx4 v[56:59], v4, s[16:19], s51 offen offset:0 sc1
v_mfma_f32_16x16x32_bf16 v[96:99], v[60:63], v[40:43], v[96:99]
v_xor_b32 v55, s52, v39
v_mfma_f32_16x16x32_bf16 v[104:107], v[60:63], v[44:47], v[104:107]
ds_write_b32 v0, v7
v_mfma_f32_16x16x32_bf16 v[112:115], v[60:63], v[48:51], v[112:115]
v_mfma_f32_16x16x32_bf16 v[120:123], v[60:63], v[52:55], v[120:123]
buffer_load_dwordx4 v[60:63], v4, s[16:19], s51 offen offset:1024 sc1
s_waitcnt vmcnt(8)
v_mfma_f32_16x16x32_bf16 v[132:135], v[64:67], v[24:27], v[132:135]
v_mfma_f32_16x16x32_bf16 v[132:135], v[68:71], v[8:11], v[132:135]
s_add_u32 s51, s51, 2048
v_mfma_f32_16x16x32_bf16 v[128:131], v[64:67], v[8:11], v[128:131]
v_mfma_f32_16x16x32_bf16 v[128:131], v[68:71], v[40:43], v[128:131]
v_mfma_f32_16x16x32_bf16 v[140:143], v[64:67], v[28:31], v[140:143]
v_add_u32 v7, 1, v7
v_mfma_f32_16x16x32_bf16 v[140:143], v[68:71], v[12:15], v[140:143]
v_mfma_f32_16x16x32_bf16 v[136:139], v[64:67], v[12:15], v[136:139]
v_mfma_f32_16x16x32_bf16 v[136:139], v[68:71], v[44:47], v[136:139]
v_mfma_f32_16x16x32_bf16 v[148:151], v[64:67], v[32:35], v[148:151]
v_mfma_f32_16x16x32_bf16 v[148:151], v[68:71], v[16:19], v[148:151]
v_mfma_f32_16x16x32_bf16 v[144:147], v[64:67], v[16:19], v[144:147]
v_mfma_f32_16x16x32_bf16 v[144:147], v[68:71], v[48:51], v[144:147]
v_mfma_f32_16x16x32_bf16 v[156:159], v[64:67], v[36:39], v[156:159]
v_mfma_f32_16x16x32_bf16 v[156:159], v[68:71], v[20:23], v[156:159]
v_mfma_f32_16x16x32_bf16 v[152:155], v[64:67], v[20:23], v[152:155]
buffer_load_dwordx4 v[64:67], v4, s[16:19], s51 offen offset:0 sc1
v_mfma_f32_16x16x32_bf16 v[152:155], v[68:71], v[52:55], v[152:155]
buffer_load_dwordx4 v[68:71], v4, s[16:19], s51 offen offset:1024 sc1
s_waitcnt vmcnt(8)
v_mfma_f32_16x16x32_bf16 v[164:167], v[72:75], v[24:27], v[164:167]
v_mfma_f32_16x16x32_bf16 v[164:167], v[76:79], v[8:11], v[164:167]
v_mfma_f32_16x16x32_bf16 v[160:163], v[72:75], v[8:11], v[160:163]
v_mfma_f32_16x16x32_bf16 v[160:163], v[76:79], v[40:43], v[160:163]
s_add_u32 s54, s54, 16384
v_mfma_f32_16x16x32_bf16 v[172:175], v[72:75], v[28:31], v[172:175]
v_mfma_f32_16x16x32_bf16 v[172:175], v[76:79], v[12:15], v[172:175]
s_and_b32 s54, s54, 0x1ffff
v_mfma_f32_16x16x32_bf16 v[168:171], v[72:75], v[12:15], v[168:171]
v_mfma_f32_16x16x32_bf16 v[168:171], v[76:79], v[44:47], v[168:171]
v_add_u32 v5, s54, v4
v_mfma_f32_16x16x32_bf16 v[180:183], v[72:75], v[32:35], v[180:183]
v_mfma_f32_16x16x32_bf16 v[180:183], v[76:79], v[16:19], v[180:183]
v_mfma_f32_16x16x32_bf16 v[176:179], v[72:75], v[16:19], v[176:179]
v_mfma_f32_16x16x32_bf16 v[176:179], v[76:79], v[48:51], v[176:179]
v_mfma_f32_16x16x32_bf16 v[188:191], v[72:75], v[36:39], v[188:191]
v_mfma_f32_16x16x32_bf16 v[188:191], v[76:79], v[20:23], v[188:191]
v_mfma_f32_16x16x32_bf16 v[184:187], v[72:75], v[20:23], v[184:187]
buffer_load_dwordx4 v[72:75], v4, s[16:19], s51 offen offset:2048 sc1
v_mfma_f32_16x16x32_bf16 v[184:187], v[76:79], v[52:55], v[184:187]
buffer_load_dwordx4 v[76:79], v4, s[16:19], s51 offen offset:3072 sc1
s_waitcnt vmcnt(8)
v_mfma_f32_16x16x32_bf16 v[196:199], v[80:83], v[24:27], v[196:199]
v_mfma_f32_16x16x32_bf16 v[196:199], v[84:87], v[8:11], v[196:199]
s_add_u32 s51, s51, 4096
ds_read_b32 v3, v0 offset:16
v_mfma_f32_16x16x32_bf16 v[192:195], v[80:83], v[8:11], v[192:195]
v_mfma_f32_16x16x32_bf16 v[192:195], v[84:87], v[40:43], v[192:195]
v_mfma_f32_16x16x32_bf16 v[204:207], v[80:83], v[28:31], v[204:207]
v_mfma_f32_16x16x32_bf16 v[204:207], v[84:87], v[12:15], v[204:207]
v_mfma_f32_16x16x32_bf16 v[200:203], v[80:83], v[12:15], v[200:203]
v_mfma_f32_16x16x32_bf16 v[200:203], v[84:87], v[44:47], v[200:203]
v_mfma_f32_16x16x32_bf16 v[212:215], v[80:83], v[32:35], v[212:215]
v_mfma_f32_16x16x32_bf16 v[212:215], v[84:87], v[16:19], v[212:215]
v_mfma_f32_16x16x32_bf16 v[208:211], v[80:83], v[16:19], v[208:211]
v_mfma_f32_16x16x32_bf16 v[208:211], v[84:87], v[48:51], v[208:211]
s_waitcnt lgkmcnt(0)
v_readfirstlane_b32 s57, v3
v_mfma_f32_16x16x32_bf16 v[220:223], v[80:83], v[36:39], v[220:223]
s_sub_u32 s57, s57, s56
v_mfma_f32_16x16x32_bf16 v[220:223], v[84:87], v[20:23], v[220:223]
s_and_b32 s57, s57, 0x80808080
s_cbranch_scc1 L_slow
L_fast:
v_mfma_f32_16x16x32_bf16 v[216:219], v[80:83], v[20:23], v[216:219]
buffer_load_dwordx4 v[80:83], v4, s[16:19], s51 offen offset:0 sc1
v_mfma_f32_16x16x32_bf16 v[216:219], v[84:87], v[52:55], v[216:219]
buffer_load_dwordx4 v[84:87], v4, s[16:19], s51 offen offset:1024 sc1
s_waitcnt vmcnt(8)
v_mfma_f32_16x16x32_bf16 v[228:231], v[88:91], v[24:27], v[228:231]
s_add_u32 s56, s56, 0x01010101
v_mfma_f32_16x16x32_bf16 v[228:231], v[92:95], v[8:11], v[228:231]
s_sub_u32 s53, s53, 1
v_mfma_f32_16x16x32_bf16 v[224:227], v[88:91], v[8:11], v[224:227]
ds_read_b128 v[8:11], v5 offset:0
v_mfma_f32_16x16x32_bf16 v[236:239], v[88:91], v[28:31], v[236:239]
ds_read_b128 v[24:27], v5 offset:4096
v_mfma_f32_16x16x32_bf16 v[236:239], v[92:95], v[12:15], v[236:239]
v_mfma_f32_16x16x32_bf16 v[232:235], v[88:91], v[12:15], v[232:235]
ds_read_b128 v[12:15], v5 offset:1024
v_mfma_f32_16x16x32_bf16 v[244:247], v[88:91], v[32:35], v[244:247]
ds_read_b128 v[28:31], v5 offset:5120
v_mfma_f32_16x16x32_bf16 v[244:247], v[92:95], v[16:19], v[244:247]
v_mfma_f32_16x16x32_bf16 v[240:243], v[88:91], v[16:19], v[240:243]
ds_read_b128 v[16:19], v5 offset:2048
v_mfma_f32_16x16x32_bf16 v[252:255], v[88:91], v[36:39], v[252:255]
ds_read_b128 v[32:35], v5 offset:6144
v_mfma_f32_16x16x32_bf16 v[252:255], v[92:95], v[20:23], v[252:255]
v_mfma_f32_16x16x32_bf16 v[248:251], v[88:91], v[20:23], v[248:251]
buffer_load_dwordx4 v[88:91], v4, s[16:19], s51 offen offset:2048 sc1
ds_read_b128 v[20:23], v5 offset:3072
v_mfma_f32_16x16x32_bf16 v[224:227], v[92:95], v[40:43], v[224:227]
ds_read_b128 v[36:39], v5 offset:7168
v_mfma_f32_16x16x32_bf16 v[232:235], v[92:95], v[44:47], v[232:235]
s_cmp_lg_u32 s53, 0
v_mfma_f32_16x16x32_bf16 v[240:243], v[92:95], v[48:51], v[240:243]
v_mfma_f32_16x16x32_bf16 v[248:251], v[92:95], v[52:55], v[248:251]
buffer_load_dwordx4 v[92:95], v4, s[16:19], s51 offen offset:3072 sc1
s_cbranch_scc1 L_gl
L_epi:
s_waitcnt vmcnt(8) lgkmcnt(6)
v_mfma_f32_16x16x32_bf16 v[100:103], v[56:59], v[24:27], v[100:103]
v_xor_b32 v40, s52, v24
v_mfma_f32_16x16x32_bf16 v[100:103], v[60:63], v[8:11], v[100:103]
v_xor_b32 v41, s52, v25
v_mfma_f32_16x16x32_bf16 v[96:99], v[56:59], v[8:11], v[96:99]
v_xor_b32 v42, s52, v26
s_waitcnt lgkmcnt(4)
v_mfma_f32_16x16x32_bf16 v[108:111], v[56:59], v[28:31], v[108:111]
v_xor_b32 v43, s52, v27
v_xor_b32 v44, s52, v28
v_mfma_f32_16x16x32_bf16 v[108:111], v[60:63], v[12:15], v[108:111]
v_xor_b32 v45, s52, v29
v_mfma_f32_16x16x32_bf16 v[104:107], v[56:59], v[12:15], v[104:107]
v_xor_b32 v46, s52, v30
s_waitcnt lgkmcnt(2)
v_mfma_f32_16x16x32_bf16 v[116:119], v[56:59], v[32:35], v[116:119]
v_xor_b32 v47, s52, v31
v_xor_b32 v48, s52, v32
v_mfma_f32_16x16x32_bf16 v[116:119], v[60:63], v[16:19], v[116:119]
v_xor_b32 v49, s52, v33
v_mfma_f32_16x16x32_bf16 v[112:115], v[56:59], v[16:19], v[112:115]
v_xor_b32 v50, s52, v34
s_waitcnt lgkmcnt(0)
v_mfma_f32_16x16x32_bf16 v[124:127], v[56:59], v[36:39], v[124:127]
v_xor_b32 v51, s52, v35
v_xor_b32 v52, s52, v36
v_mfma_f32_16x16x32_bf16 v[124:127], v[60:63], v[20:23], v[124:127]
v_xor_b32 v53, s52, v37
v_mfma_f32_16x16x32_bf16 v[120:123], v[56:59], v[20:23], v[120:123]
v_xor_b32 v54, s52, v38
v_mfma_f32_16x16x32_bf16 v[96:99], v[60:63], v[40:43], v[96:99]
v_xor_b32 v55, s52, v39
v_mfma_f32_16x16x32_bf16 v[104:107], v[60:63], v[44:47], v[104:107]
v_mfma_f32_16x16x32_bf16 v[112:115], v[60:63], v[48:51], v[112:115]
v_mfma_f32_16x16x32_bf16 v[120:123], v[60:63], v[52:55], v[120:123]
s_waitcnt vmcnt(6)
v_mfma_f32_16x16x32_bf16 v[132:135], v[64:67], v[24:27], v[132:135]
v_mfma_f32_16x16x32_bf16 v[132:135], v[68:71], v[8:11], v[132:135]
v_mfma_f32_16x16x32_bf16 v[128:131], v[64:67], v[8:11], v[128:131]
v_mfma_f32_16x16x32_bf16 v[128:131], v[68:71], v[40:43], v[128:131]
v_mfma_f32_16x16x32_bf16 v[140:143], v[64:67], v[28:31], v[140:143]
v_mfma_f32_16x16x32_bf16 v[140:143], v[68:71], v[12:15], v[140:143]
v_mfma_f32_16x16x32_bf16 v[136:139], v[64:67], v[12:15], v[136:139]
v_mfma_f32_16x16x32_bf16 v[136:139], v[68:71], v[44:47], v[136:139]
v_cvt_pk_bf16_f32 v56, v96, v100
v_cvt_pk_bf16_f32 v57, v104, v108
v_cvt_pk_bf16_f32 v58, v112, v116
v_mfma_f32_16x16x32_bf16 v[148:151], v[64:67], v[32:35], v[148:151]
v_cvt_pk_bf16_f32 v59, v120, v124
s_add_u32 s41, s55, 0
buffer_store_dwordx4 v[56:59], v6, s[20:23], s41 offen sc1
v_mfma_f32_16x16x32_bf16 v[148:151], v[68:71], v[16:19], v[148:151]
v_cvt_pk_bf16_f32 v60, v97, v101
v_cvt_pk_bf16_f32 v61, v105, v109
v_cvt_pk_bf16_f32 v62, v113, v117
v_mfma_f32_16x16x32_bf16 v[144:147], v[64:67], v[16:19], v[144:147]
v_cvt_pk_bf16_f32 v63, v121, v125
s_add_u32 s41, s55, 131200
buffer_store_dwordx4 v[60:63], v6, s[20:23], s41 offen sc1
v_mfma_f32_16x16x32_bf16 v[144:147], v[68:71], v[48:51], v[144:147]
v_cvt_pk_bf16_f32 v56, v98, v102
v_cvt_pk_bf16_f32 v57, v106, v110
v_cvt_pk_bf16_f32 v58, v114, v118
v_mfma_f32_16x16x32_bf16 v[156:159], v[64:67], v[36:39], v[156:159]
v_cvt_pk_bf16_f32 v59, v122, v126
s_add_u32 s41, s55, 262400
buffer_store_dwordx4 v[56:59], v6, s[20:23], s41 offen sc1
v_mfma_f32_16x16x32_bf16 v[156:159], v[68:71], v[20:23], v[156:159]
v_cvt_pk_bf16_f32 v60, v99, v103
v_cvt_pk_bf16_f32 v61, v107, v111
v_cvt_pk_bf16_f32 v62, v115, v119
v_mfma_f32_16x16x32_bf16 v[152:155], v[64:67], v[20:23], v[152:155]
v_cvt_pk_bf16_f32 v63, v123, v127
s_add_u32 s41, s55, 393600
buffer_store_dwordx4 v[60:63], v6, s[20:23], s41 offen sc1
v_mfma_f32_16x16x32_bf16 v[152:155], v[68:71], v[52:55], v[152:155]
s_waitcnt vmcnt(8)
v_mfma_f32_16x16x32_bf16 v[164:167], v[72:75], v[24:27], v[164:167]
v_mfma_f32_16x16x32_bf16 v[164:167], v[76:79], v[8:11], v[164:167]
v_mfma_f32_16x16x32_bf16 v[160:163], v[72:75], v[8:11], v[160:163]
v_mfma_f32_16x16x32_bf16 v[160:163], v[76:79], v[40:43], v[160:163]
v_mfma_f32_16x16x32_bf16 v[172:175], v[72:75], v[28:31], v[172:175]
v_mfma_f32_16x16x32_bf16 v[172:175], v[76:79], v[12:15], v[172:175]
v_mfma_f32_16x16x32_bf16 v[168:171], v[72:75], v[12:15], v[168:171]
v_mfma_f32_16x16x32_bf16 v[168:171], v[76:79], v[44:47], v[168:171]
v_cvt_pk_bf16_f32 v64, v128, v132
v_cvt_pk_bf16_f32 v65, v136, v140
v_cvt_pk_bf16_f32 v66, v144, v148
v_mfma_f32_16x16x32_bf16 v[180:183], v[72:75], v[32:35], v[180:183]
v_cvt_pk_bf16_f32 v67, v152, v156
s_add_u32 s41, s55, 2099200
buffer_store_dwordx4 v[64:67], v6, s[20:23], s41 offen sc1
v_mfma_f32_16x16x32_bf16 v[180:183], v[76:79], v[16:19], v[180:183]
v_cvt_pk_bf16_f32 v68, v129, v133
v_cvt_pk_bf16_f32 v69, v137, v141
v_cvt_pk_bf16_f32 v70, v145, v149
v_mfma_f32_16x16x32_bf16 v[176:179], v[72:75], v[16:19], v[176:179]
v_cvt_pk_bf16_f32 v71, v153, v157
s_add_u32 s41, s55, 2230400
buffer_store_dwordx4 v[68:71], v6, s[20:23], s41 offen sc1
v_mfma_f32_16x16x32_bf16 v[176:179], v[76:79], v[48:51], v[176:179]
v_cvt_pk_bf16_f32 v64, v130, v134
v_cvt_pk_bf16_f32 v65, v138, v142
v_cvt_pk_bf16_f32 v66, v146, v150
v_mfma_f32_16x16x32_bf16 v[188:191], v[72:75], v[36:39], v[188:191]
v_cvt_pk_bf16_f32 v67, v154, v158
s_add_u32 s41, s55, 2361600
buffer_store_dwordx4 v[64:67], v6, s[20:23], s41 offen sc1
v_mfma_f32_16x16x32_bf16 v[188:191], v[76:79], v[20:23], v[188:191]
v_cvt_pk_bf16_f32 v68, v131, v135
v_cvt_pk_bf16_f32 v69, v139, v143
v_cvt_pk_bf16_f32 v70, v147, v151
v_mfma_f32_16x16x32_bf16 v[184:187], v[72:75], v[20:23], v[184:187]
v_cvt_pk_bf16_f32 v71, v155, v159
s_add_u32 s41, s55, 2492800
buffer_store_dwordx4 v[68:71], v6, s[20:23], s41 offen sc1
v_mfma_f32_16x16x32_bf16 v[184:187], v[76:79], v[52:55], v[184:187]
s_waitcnt vmcnt(10)
v_mfma_f32_16x16x32_bf16 v[196:199], v[80:83], v[24:27], v[196:199]
v_mfma_f32_16x16x32_bf16 v[196:199], v[84:87], v[8:11], v[196:199]
v_mfma_f32_16x16x32_bf16 v[192:195], v[80:83], v[8:11], v[192:195]
v_mfma_f32_16x16x32_bf16 v[192:195], v[84:87], v[40:43], v[192:195]
v_mfma_f32_16x16x32_bf16 v[204:207], v[80:83], v[28:31], v[204:207]
v_mfma_f32_16x16x32_bf16 v[204:207], v[84:87], v[12:15], v[204:207]
v_mfma_f32_16x16x32_bf16 v[200:203], v[80:83], v[12:15], v[200:203]
v_mfma_f32_16x16x32_bf16 v[200:203], v[84:87], v[44:47], v[200:203]
v_cvt_pk_bf16_f32 v72, v160, v164
v_cvt_pk_bf16_f32 v73, v168, v172
v_cvt_pk_bf16_f32 v74, v176, v180
v_mfma_f32_16x16x32_bf16 v[212:215], v[80:83], v[32:35], v[212:215]
v_cvt_pk_bf16_f32 v75, v184, v188
s_add_u32 s41, s55, 4198400
buffer_store_dwordx4 v[72:75], v6, s[20:23], s41 offen sc1
v_mfma_f32_16x16x32_bf16 v[212:215], v[84:87], v[16:19], v[212:215]
v_cvt_pk_bf16_f32 v76, v161, v165
v_cvt_pk_bf16_f32 v77, v169, v173
v_cvt_pk_bf16_f32 v78, v177, v181
v_mfma_f32_16x16x32_bf16 v[208:211], v[80:83], v[16:19], v[208:211]
v_cvt_pk_bf16_f32 v79, v185, v189
s_add_u32 s41, s55, 4329600
buffer_store_dwordx4 v[76:79], v6, s[20:23], s41 offen sc1
v_mfma_f32_16x16x32_bf16 v[208:211], v[84:87], v[48:51], v[208:211]
v_cvt_pk_bf16_f32 v72, v162, v166
v_cvt_pk_bf16_f32 v73, v170, v174
v_cvt_pk_bf16_f32 v74, v178, v182
v_mfma_f32_16x16x32_bf16 v[220:223], v[80:83], v[36:39], v[220:223]
v_cvt_pk_bf16_f32 v75, v186, v190
s_add_u32 s41, s55, 4460800
buffer_store_dwordx4 v[72:75], v6, s[20:23], s41 offen sc1
v_mfma_f32_16x16x32_bf16 v[220:223], v[84:87], v[20:23], v[220:223]
v_cvt_pk_bf16_f32 v76, v163, v167
v_cvt_pk_bf16_f32 v77, v171, v175
v_cvt_pk_bf16_f32 v78, v179, v183
v_mfma_f32_16x16x32_bf16 v[216:219], v[80:83], v[20:23], v[216:219]
v_cvt_pk_bf16_f32 v79, v187, v191
s_add_u32 s41, s55, 4592000
buffer_store_dwordx4 v[76:79], v6, s[20:23], s41 offen sc1
v_mfma_f32_16x16x32_bf16 v[216:219], v[84:87], v[52:55], v[216:219]
s_waitcnt vmcnt(12)
v_mfma_f32_16x16x32_bf16 v[228:231], v[88:91], v[24:27], v[228:231]
v_mfma_f32_16x16x32_bf16 v[228:231], v[92:95], v[8:11], v[228:231]
v_mfma_f32_16x16x32_bf16 v[224:227], v[88:91], v[8:11], v[224:227]
v_mfma_f32_16x16x32_bf16 v[236:239], v[88:91], v[28:31], v[236:239]
v_mfma_f32_16x16x32_bf16 v[236:239], v[92:95], v[12:15], v[236:239]
v_mfma_f32_16x16x32_bf16 v[232:235], v[88:91], v[12:15], v[232:235]
v_mfma_f32_16x16x32_bf16 v[244:247], v[88:91], v[32:35], v[244:247]
v_mfma_f32_16x16x32_bf16 v[244:247], v[92:95], v[16:19], v[244:247]
v_cvt_pk_bf16_f32 v80, v192, v196
v_cvt_pk_bf16_f32 v81, v200, v204
v_cvt_pk_bf16_f32 v82, v208, v212
v_mfma_f32_16x16x32_bf16 v[240:243], v[88:91], v[16:19], v[240:243]
v_cvt_pk_bf16_f32 v83, v216, v220
s_add_u32 s41, s55, 6297600
buffer_store_dwordx4 v[80:83], v6, s[20:23], s41 offen sc1
v_mfma_f32_16x16x32_bf16 v[252:255], v[88:91], v[36:39], v[252:255]
v_cvt_pk_bf16_f32 v84, v193, v197
v_cvt_pk_bf16_f32 v85, v201, v205
v_cvt_pk_bf16_f32 v86, v209, v213
v_mfma_f32_16x16x32_bf16 v[252:255], v[92:95], v[20:23], v[252:255]
v_cvt_pk_bf16_f32 v87, v217, v221
s_add_u32 s41, s55, 6428800
buffer_store_dwordx4 v[84:87], v6, s[20:23], s41 offen sc1
v_mfma_f32_16x16x32_bf16 v[248:251], v[88:91], v[20:23], v[248:251]
v_cvt_pk_bf16_f32 v80, v194, v198
v_cvt_pk_bf16_f32 v81, v202, v206
v_cvt_pk_bf16_f32 v82, v210, v214
v_mfma_f32_16x16x32_bf16 v[224:227], v[92:95], v[40:43], v[224:227]
v_cvt_pk_bf16_f32 v83, v218, v222
s_add_u32 s41, s55, 6560000
buffer_store_dwordx4 v[80:83], v6, s[20:23], s41 offen sc1
v_mfma_f32_16x16x32_bf16 v[232:235], v[92:95], v[44:47], v[232:235]
v_cvt_pk_bf16_f32 v84, v195, v199
v_cvt_pk_bf16_f32 v85, v203, v207
v_cvt_pk_bf16_f32 v86, v211, v215
v_mfma_f32_16x16x32_bf16 v[240:243], v[92:95], v[48:51], v[240:243]
v_cvt_pk_bf16_f32 v87, v219, v223
s_add_u32 s41, s55, 6691200
buffer_store_dwordx4 v[84:87], v6, s[20:23], s41 offen sc1
v_mfma_f32_16x16x32_bf16 v[248:251], v[92:95], v[52:55], v[248:251]
L_upd:
s_nop 7
v_cvt_pk_bf16_f32 v8, v224, v228
v_cvt_pk_bf16_f32 v9, v232, v236
v_cvt_pk_bf16_f32 v10, v240, v244
v_cvt_pk_bf16_f32 v11, v248, v252
s_add_u32 s41, s55, 8396800
buffer_store_dwordx4 v[8:11], v6, s[20:23], s41 offen sc1
v_cvt_pk_bf16_f32 v12, v225, v229
v_cvt_pk_bf16_f32 v13, v233, v237
v_cvt_pk_bf16_f32 v14, v241, v245
v_cvt_pk_bf16_f32 v15, v249, v253
s_add_u32 s41, s55, 8528000
buffer_store_dwordx4 v[12:15], v6, s[20:23], s41 offen sc1
v_cvt_pk_bf16_f32 v16, v226, v230
v_cvt_pk_bf16_f32 v17, v234, v238
v_cvt_pk_bf16_f32 v18, v242, v246
v_cvt_pk_bf16_f32 v19, v250, v254
s_add_u32 s41, s55, 8659200
buffer_store_dwordx4 v[16:19], v6, s[20:23], s41 offen sc1
v_cvt_pk_bf16_f32 v20, v227, v231
v_cvt_pk_bf16_f32 v21, v235, v239
v_cvt_pk_bf16_f32 v22, v243, v247
v_cvt_pk_bf16_f32 v23, v251, v255
s_add_u32 s41, s55, 8790400
buffer_store_dwordx4 v[20:23], v6, s[20:23], s41 offen sc1
v_mov_b32 v244, 160528
v_mov_b32 v245, 1
s_mov_b64 exec, 1
ds_add_u32 v244, v245
s_mov_b64 exec, -1
v_lshrrev_b32 v3, 4, v1
v_mov_b32 v246, 160536
ds_read_b32 v247, v246
s_waitcnt lgkmcnt(0)
v_readfirstlane_b32 s49, v247
s_nop 0
s_cmp_lg_u32 s49, 0
s_cbranch_scc1 L_l2
s_waitcnt vmcnt(0)
v_mov_b32 v248, 160516
v_mov_b32 v249, 1
s_mov_b64 exec, 1
ds_add_rtn_u32 v250, v248, v249
s_mul_i32 s40, s33, 4224
s_add_u32 s40, s40, 67584
s_lshr_b32 s41, s34, 4
s_mul_i32 s41, s41, 76032
s_add_u32 s40, s40, s41
v_mov_b32 v248, 0
s_waitcnt lgkmcnt(0)
v_readfirstlane_b32 s41, v250
s_nop 0
s_cmp_lg_u32 s41, 3
s_cbranch_scc1 L_nb2
v_mov_b32 v250, 1
buffer_atomic_add v250, v248, s[24:27], s40 offen sc0 sc1
L_nb2:
s_cmp_lg_u32 s41, 3
s_cbranch_scc1 L_na2
s_add_u32 s40, s40, 33792
s_cmp_ge_u32 s38, 160
s_cbranch_scc1 L_nz
s_cmp_lt_u32 s34, 16
s_cbranch_scc1 L_nz
s_mov_b32 s49, 2
s_mov_b32 s50, s40
s_branch L_na2
L_nz:
s_waitcnt vmcnt(0)
v_readfirstlane_b32 s41, v250
s_nop 0
s_cmp_lg_u32 s41, 15
s_cbranch_scc1 L_na2
buffer_store_dword v249, v248, s[24:27], s40 offen sc1
L_na2:
s_mov_b64 exec, -1
s_cmp_ge_u32 s38, 160
s_cbranch_scc1 L_fin
L_l2:
v_mov_b32 v244, 160532
s_mov_b32 s41, 0
L_lwt:
ds_read_b32 v245, v244
s_add_u32 s41, s41, 1
s_waitcnt lgkmcnt(0)
v_readfirstlane_b32 s40, v245
s_cmp_gt_u32 s41, 0x100000
s_cbranch_scc1 L_lwdt
s_cmp_lt_u32 s40, 4
s_cbranch_scc1 L_lwt
L_lwdt:
v_add_u32 v7, 65536, v4
ds_read_b128 v[200:203], v7 offset:0
ds_read_b128 v[204:207], v7 offset:1024
ds_read_b128 v[208:211], v7 offset:2048
ds_read_b128 v[212:215], v7 offset:3072
ds_read_b128 v[216:219], v7 offset:4096
ds_read_b128 v[220:223], v7 offset:5120
ds_read_b128 v[224:227], v7 offset:6144
ds_read_b128 v[228:231], v7 offset:7168
ds_read_b128 v[232:235], v7 offset:8192
ds_read_b128 v[236:239], v7 offset:9216
s_mul_i32 s40, s38, 131200
s_add_u32 s40, s40, 16777216
s_add_u32 s16, s14, s40
s_addc_u32 s17, s15, 0
s_mov_b32 s18, 131072
s_mov_b32 s19, 0x20000
v_mul_u32_u24 v5, 16384, v3
v_lshl_add_u32 v0, v2, 4, v5
v_lshl_add_u32 v5, v2, 3, v5
s_lshl_b32 s40, s32, 7
v_add_u32 v5, s40, v5
s_lshl_b32 s40, s32, 8
v_add_u32 v0, s40, v0
s_lshl_b32 s40, s32, 12
v_add_u32 v6, s40, v4
v_lshrrev_b32 v242, 2, v2
v_lshlrev_b32 v242, 8, v242
v_and_b32 v243, 3, v2
v_lshl_add_u32 v242, v243, 2, v242
v_and_b32 v243, 1, v3
v_lshl_add_u32 v242, v243, 6, v242
v_and_b32 v243, 2, v3
v_add_u32 v242, v242, v243
s_waitcnt lgkmcnt(0)
v_add_u32 v7, s40, v242
s_mov_b32 s48, 0x42700000
s_mov_b32 s52, 0x3a800000
s_mov_b32 s53, 0xbf317218
s_mov_b32 s56, 0
s_mov_b32 s57, 4096
s_mov_b32 s58, 8192
s_mov_b32 s59, 12288
s_mov_b32 s60, 65536
s_mov_b32 s61, 69632
s_mov_b32 s62, 73728
s_mov_b32 s63, 77824
s_setprio 1
s_lshl_b32 s40, s32, 3
s_lshl_b32 s40, 1, s40
v_mov_b32 v241, s40
v_mov_b32 v240, 160576
v_lshrrev_b32 v242, 3, v1
v_and_b32 v243, 3, v242
v_lshrrev_b32 v242, 2, v242
v_lshl_add_u32 v242, v243, 1, v242
v_mul_u32_u24 v242, 8192, v242
v_and_b32 v243, 7, v1
v_lshl_add_u32 v242, v243, 4, v242
s_lshl_b32 s40, s32, 7
v_add_u32 v0, s40, v242
s_lshl_b32 s51, s32, 13
s_add_u32 s51, s51, 75776
v_lshlrev_b32 v242, 3, v1
v_add_u32 v242, s51, v242
v_mov_b32 v244, 160536
s_mov_b32 s41, 0
L_lwa:
ds_read_b32 v245, v244
s_add_u32 s41, s41, 1
s_waitcnt lgkmcnt(0)
v_readfirstlane_b32 s40, v245
s_cmp_gt_u32 s41, 0x100000
s_cbranch_scc1 L_lwda
s_cmp_lt_u32 s40, 1
s_cbranch_scc1 L_lwa
L_lwda:
buffer_load_dwordx2 v[8:9], v5, s[16:19], s56 offen offset:1024 sc1
buffer_load_dwordx2 v[10:11], v5, s[16:19], s58 offen offset:1024 sc1
buffer_load_dwordx2 v[12:13], v5, s[16:19], s57 offen offset:1024 sc1
buffer_load_dwordx2 v[14:15], v5, s[16:19], s59 offen offset:1024 sc1
buffer_load_dwordx2 v[24:25], v5, s[16:19], s56 offen offset:3072 sc1
buffer_load_dwordx2 v[26:27], v5, s[16:19], s58 offen offset:3072 sc1
buffer_load_dwordx2 v[28:29], v5, s[16:19], s57 offen offset:3072 sc1
buffer_load_dwordx2 v[30:31], v5, s[16:19], s59 offen offset:3072 sc1
buffer_load_dwordx2 v[16:17], v5, s[16:19], s60 offen offset:1024 sc1
buffer_load_dwordx2 v[18:19], v5, s[16:19], s62 offen offset:1024 sc1
buffer_load_dwordx2 v[20:21], v5, s[16:19], s61 offen offset:1024 sc1
buffer_load_dwordx2 v[22:23], v5, s[16:19], s63 offen offset:1024 sc1
buffer_load_dwordx2 v[32:33], v5, s[16:19], s60 offen offset:3072 sc1
buffer_load_dwordx2 v[34:35], v5, s[16:19], s62 offen offset:3072 sc1
buffer_load_dwordx2 v[36:37], v5, s[16:19], s61 offen offset:3072 sc1
buffer_load_dwordx2 v[38:39], v5, s[16:19], s63 offen offset:3072 sc1
s_cmp_eq_u32 s49, 0
s_cbranch_scc1 L_e3
s_waitcnt vmcnt(16)
s_cmp_lg_u32 s49, 2
s_cbranch_scc1 L_e4
v_readfirstlane_b32 s41, v250
s_nop 0
s_cmp_lg_u32 s41, 15
s_cbranch_scc1 L_e3
s_mov_b64 exec, 1
buffer_store_dword v249, v248, s[24:27], s50 offen sc1
s_mov_b64 exec, -1
s_waitcnt vmcnt(1)
s_branch L_e3
L_e4:
s_waitcnt vmcnt(0)
v_mov_b32 v244, 160516
v_mov_b32 v245, 1
s_mov_b64 exec, 1
ds_add_rtn_u32 v246, v244, v245
s_mul_i32 s40, s33, 4224
s_add_u32 s40, s40, 67584
s_lshr_b32 s41, s34, 4
s_mul_i32 s41, s41, 76032
s_add_u32 s40, s40, s41
v_mov_b32 v244, 0
s_waitcnt lgkmcnt(0)
v_readfirstlane_b32 s41, v246
s_nop 0
s_cmp_lg_u32 s41, 3
s_cbranch_scc1 L_nb3
v_mov_b32 v246, 1
buffer_atomic_add v246, v244, s[24:27], s40 offen sc0 sc1
L_nb3:
s_cmp_lg_u32 s41, 3
s_cbranch_scc1 L_na3
s_add_u32 s40, s40, 33792
s_waitcnt vmcnt(0)
v_readfirstlane_b32 s41, v246
s_nop 0
s_cmp_lg_u32 s41, 15
s_cbranch_scc1 L_na3
buffer_store_dword v245, v244, s[24:27], s40 offen sc1
L_na3:
s_mov_b64 exec, -1
L_e3:
v_mov_b32 v244, 160528
s_mov_b32 s41, 0
L_lwu:
ds_read_b32 v245, v244
s_add_u32 s41, s41, 1
s_waitcnt lgkmcnt(0)
v_readfirstlane_b32 s40, v245
s_cmp_gt_u32 s41, 0x100000
s_cbranch_scc1 L_lwdu
s_cmp_lt_u32 s40, 4
s_cbranch_scc1 L_lwu
L_lwdu:
s_waitcnt vmcnt(8)
v_swap_b32 v9, v12
v_swap_b32 v11, v14
v_swap_b32 v25, v28
v_swap_b32 v27, v30
s_nop 1
v_mfma_f32_16x16x32_bf16 v[136:139], v[8:11], v[200:203], 0
v_mfma_f32_16x16x32_bf16 v[140:143], v[12:15], v[200:203], 0
v_mfma_f32_16x16x32_bf16 v[144:147], v[24:27], v[200:203], 0
v_mfma_f32_16x16x32_bf16 v[148:151], v[28:31], v[200:203], 0
s_waitcnt vmcnt(0)
v_swap_b32 v17, v20
v_swap_b32 v19, v22
v_swap_b32 v33, v36
v_swap_b32 v35, v38
s_nop 1
v_mfma_f32_16x16x32_bf16 v[136:139], v[16:19], v[204:207], v[136:139]
v_mfma_f32_16x16x32_bf16 v[140:143], v[20:23], v[204:207], v[140:143]
v_mfma_f32_16x16x32_bf16 v[144:147], v[32:35], v[204:207], v[144:147]
v_mfma_f32_16x16x32_bf16 v[148:151], v[36:39], v[204:207], v[148:151]
s_nop 7
v_cmp_lt_f32 vcc, abs(v136), s52
s_nop 1
s_cmp_eq_u64 vcc, -1
s_cbranch_scc1 L_tiny
v_min_f32 v136, s48, v136
v_min_f32 v137, s48, v137
s_add_u32 m0, s51, 0
s_nop 0
buffer_load_dwordx4 v0, s[16:19], s56 offen offset:0 sc1 lds
v_min_f32 v138, s48, v138
v_min_f32 v139, s48, v139
v_mfma_f32_16x16x32_bf16 v[152:155], v[8:11], v[208:211], 0
v_min_f32 v140, s48, v140
v_min_f32 v141, s48, v141
v_min_f32 v142, s48, v142
v_min_f32 v143, s48, v143
v_mfma_f32_16x16x32_bf16 v[156:159], v[12:15], v[208:211], 0
v_exp_f32 v144, v144
s_add_u32 m0, s51, 1024
s_nop 0
buffer_load_dwordx4 v0, s[16:19], s57 offen offset:0 sc1 lds
v_exp_f32 v145, v145
v_exp_f32 v146, v146
v_exp_f32 v147, v147
v_mfma_f32_16x16x32_bf16 v[160:163], v[24:27], v[208:211], 0
v_exp_f32 v148, v148
v_exp_f32 v149, v149
v_exp_f32 v150, v150
v_exp_f32 v151, v151
v_mfma_f32_16x16x32_bf16 v[164:167], v[28:31], v[208:211], 0
s_add_u32 m0, s51, 0
s_nop 0
buffer_load_dwordx4 v0, s[16:19], s56 offen offset:2048 sc1 lds
v_exp_f32 v136, v136
v_exp_f32 v137, v137
v_exp_f32 v138, v138
v_exp_f32 v139, v139
v_mfma_f32_16x16x32_bf16 v[152:155], v[16:19], v[212:215], v[152:155]
v_exp_f32 v140, v140
v_exp_f32 v141, v141
v_exp_f32 v142, v142
s_add_u32 m0, s51, 1024
s_nop 0
buffer_load_dwordx4 v0, s[16:19], s57 offen offset:2048 sc1 lds
v_exp_f32 v143, v143
v_mfma_f32_16x16x32_bf16 v[156:159], v[20:23], v[212:215], v[156:159]
v_add_f32 v168, 1.0, v136
v_add_f32 v169, 1.0, v137
v_add_f32 v170, 1.0, v138
v_add_f32 v171, 1.0, v139
v_mfma_f32_16x16x32_bf16 v[160:163], v[32:35], v[212:215], v[160:163]
v_add_f32 v172, 1.0, v140
v_add_f32 v173, 1.0, v141
s_add_u32 m0, s51, 4096
s_nop 0
buffer_load_dwordx4 v0, s[16:19], s60 offen offset:0 sc1 lds
v_add_f32 v174, 1.0, v142
v_add_f32 v175, 1.0, v143
v_mfma_f32_16x16x32_bf16 v[164:167], v[36:39], v[212:215], v[164:167]
v_fma_f32 v144, v168, v144, v168
v_fma_f32 v145, v169, v145, v169
v_fma_f32 v146, v170, v146, v170
v_fma_f32 v147, v171, v147, v171
v_mfma_f32_16x16x32_bf16 v[188:191], v[224:227], v[8:11], 0
v_fma_f32 v148, v172, v148, v172
s_add_u32 m0, s51, 5120
s_nop 0
buffer_load_dwordx4 v0, s[16:19], s61 offen offset:0 sc1 lds
v_fma_f32 v149, v173, v149, v173
v_fma_f32 v150, v174, v150, v174
v_fma_f32 v151, v175, v151, v175
v_mfma_f32_16x16x32_bf16 v[192:195], v[224:227], v[24:27], 0
v_rcp_f32 v144, v144
v_rcp_f32 v145, v145
v_rcp_f32 v146, v146
v_rcp_f32 v147, v147
v_mfma_f32_16x16x32_bf16 v[188:191], v[232:235], v[12:15], v[188:191]
s_add_u32 m0, s51, 4096
s_nop 0
buffer_load_dwordx4 v0, s[16:19], s60 offen offset:2048 sc1 lds
v_rcp_f32 v148, v148
v_rcp_f32 v149, v149
v_rcp_f32 v150, v150
v_rcp_f32 v151, v151
v_mfma_f32_16x16x32_bf16 v[192:195], v[232:235], v[28:31], v[192:195]
v_fma_f32 v136, -v136, v144, v144
v_fma_f32 v137, -v137, v145, v145
v_fma_f32 v138, -v138, v146, v146
s_add_u32 m0, s51, 5120
s_nop 0
buffer_load_dwordx4 v0, s[16:19], s61 offen offset:2048 sc1 lds
v_fma_f32 v139, -v139, v147, v147
v_fma_f32 v140, -v140, v148, v148
v_fma_f32 v141, -v141, v149, v149
v_fma_f32 v142, -v142, v150, v150
v_fma_f32 v143, -v143, v151, v151
v_cvt_pk_bf16_f32 v180, v136, v140
v_cvt_pk_bf16_f32 v181, v137, v141
v_cvt_pk_bf16_f32 v182, v138, v142
v_cvt_pk_bf16_f32 v183, v139, v143
ds_write_b128 v6, v[180:183] offset:0
v_min_f32 v152, s48, v152
v_min_f32 v153, s48, v153
v_min_f32 v154, s48, v154
v_min_f32 v155, s48, v155
v_mfma_f32_16x16x32_bf16 v[136:139], v[8:11], v[216:219], 0
v_min_f32 v156, s48, v156
v_min_f32 v157, s48, v157
v_min_f32 v158, s48, v158
v_min_f32 v159, s48, v159
v_mfma_f32_16x16x32_bf16 v[140:143], v[12:15], v[216:219], 0
v_exp_f32 v160, v160
v_exp_f32 v161, v161
v_exp_f32 v162, v162
v_exp_f32 v163, v163
v_mfma_f32_16x16x32_bf16 v[144:147], v[24:27], v[216:219], 0
v_exp_f32 v164, v164
v_exp_f32 v165, v165
v_exp_f32 v166, v166
v_exp_f32 v167, v167
v_mfma_f32_16x16x32_bf16 v[148:151], v[28:31], v[216:219], 0
v_exp_f32 v152, v152
v_exp_f32 v153, v153
v_exp_f32 v154, v154
v_exp_f32 v155, v155
v_mfma_f32_16x16x32_bf16 v[136:139], v[16:19], v[220:223], v[136:139]
v_exp_f32 v156, v156
v_exp_f32 v157, v157
v_exp_f32 v158, v158
v_exp_f32 v159, v159
v_mfma_f32_16x16x32_bf16 v[140:143], v[20:23], v[220:223], v[140:143]
v_add_f32 v168, 1.0, v152
v_add_f32 v169, 1.0, v153
v_add_f32 v170, 1.0, v154
v_add_f32 v171, 1.0, v155
v_mfma_f32_16x16x32_bf16 v[144:147], v[32:35], v[220:223], v[144:147]
v_add_f32 v172, 1.0, v156
v_add_f32 v173, 1.0, v157
v_add_f32 v174, 1.0, v158
v_add_f32 v175, 1.0, v159
v_mfma_f32_16x16x32_bf16 v[148:151], v[36:39], v[220:223], v[148:151]
v_fma_f32 v160, v168, v160, v168
v_fma_f32 v161, v169, v161, v169
v_fma_f32 v162, v170, v162, v170
v_fma_f32 v163, v171, v163, v171
v_mfma_f32_16x16x32_bf16 v[188:191], v[228:231], v[16:19], v[188:191]
v_fma_f32 v164, v172, v164, v172
v_fma_f32 v165, v173, v165, v173
v_fma_f32 v166, v174, v166, v174
v_fma_f32 v167, v175, v167, v175
v_mfma_f32_16x16x32_bf16 v[192:195], v[228:231], v[32:35], v[192:195]
v_rcp_f32 v160, v160
v_rcp_f32 v161, v161
v_rcp_f32 v162, v162
v_rcp_f32 v163, v163
v_mfma_f32_16x16x32_bf16 v[188:191], v[236:239], v[20:23], v[188:191]
v_rcp_f32 v164, v164
v_rcp_f32 v165, v165
v_rcp_f32 v166, v166
v_rcp_f32 v167, v167
v_mfma_f32_16x16x32_bf16 v[192:195], v[236:239], v[36:39], v[192:195]
v_fma_f32 v152, -v152, v160, v160
v_fma_f32 v153, -v153, v161, v161
v_fma_f32 v154, -v154, v162, v162
v_fma_f32 v155, -v155, v163, v163
v_fma_f32 v156, -v156, v164, v164
v_fma_f32 v157, -v157, v165, v165
v_fma_f32 v158, -v158, v166, v166
v_fma_f32 v159, -v159, v167, v167
v_cvt_pk_bf16_f32 v184, v152, v156
v_cvt_pk_bf16_f32 v185, v153, v157
v_cvt_pk_bf16_f32 v186, v154, v158
v_cvt_pk_bf16_f32 v187, v155, v159
ds_write_b128 v6, v[184:187] offset:1024
v_min_f32 v188, s48, v188
v_min_f32 v136, s48, v136
v_min_f32 v137, s48, v137
v_min_f32 v138, s48, v138
v_min_f32 v139, s48, v139
v_min_f32 v140, s48, v140
v_min_f32 v141, s48, v141
v_min_f32 v142, s48, v142
v_min_f32 v143, s48, v143
v_exp_f32 v192, v192
v_exp_f32 v144, v144
v_exp_f32 v145, v145
v_exp_f32 v146, v146
v_exp_f32 v147, v147
v_exp_f32 v148, v148
v_exp_f32 v149, v149
v_exp_f32 v150, v150
v_exp_f32 v151, v151
v_exp_f32 v188, v188
v_exp_f32 v136, v136
v_exp_f32 v137, v137
v_exp_f32 v138, v138
v_exp_f32 v139, v139
v_exp_f32 v140, v140
v_exp_f32 v141, v141
v_exp_f32 v142, v142
v_exp_f32 v143, v143
v_add_f32 v168, 1.0, v188
v_add_f32 v169, 1.0, v136
v_add_f32 v170, 1.0, v137
v_add_f32 v171, 1.0, v138
v_add_f32 v172, 1.0, v139
v_add_f32 v173, 1.0, v140
v_add_f32 v174, 1.0, v141
v_add_f32 v175, 1.0, v142
v_add_f32 v176, 1.0, v143
v_fma_f32 v192, v168, v192, v168
v_fma_f32 v144, v169, v144, v169
v_fma_f32 v145, v170, v145, v170
v_fma_f32 v146, v171, v146, v171
v_fma_f32 v147, v172, v147, v172
v_fma_f32 v148, v173, v148, v173
v_fma_f32 v149, v174, v149, v174
v_fma_f32 v150, v175, v150, v175
v_fma_f32 v151, v176, v151, v176
v_rcp_f32 v192, v192
v_rcp_f32 v144, v144
v_rcp_f32 v145, v145
v_rcp_f32 v146, v146
v_rcp_f32 v147, v147
v_rcp_f32 v148, v148
v_rcp_f32 v149, v149
v_rcp_f32 v150, v150
v_rcp_f32 v151, v151
v_fma_f32 v188, -v188, v192, v192
v_fma_f32 v136, -v136, v144, v144
v_fma_f32 v137, -v137, v145, v145
v_fma_f32 v138, -v138, v146, v146
v_fma_f32 v139, -v139, v147, v147
v_fma_f32 v140, -v140, v148, v148
v_fma_f32 v141, -v141, v149, v149
v_fma_f32 v142, -v142, v150, v150
v_fma_f32 v143, -v143, v151, v151
v_cvt_pk_bf16_f32 v168, v188, v188
ds_write_b16 v7, v168 offset:3072
v_cvt_pk_bf16_f32 v180, v136, v140
v_cvt_pk_bf16_f32 v181, v137, v141
v_cvt_pk_bf16_f32 v182, v138, v142
v_cvt_pk_bf16_f32 v183, v139, v143
ds_write_b128 v6, v[180:183] offset:2048
s_mov_b64 exec, 1
ds_add_u32 v240, v241
s_mov_b64 exec, -1
s_waitcnt vmcnt(0)
ds_read_b64 v[40:41], v242 offset:0
ds_read_b64 v[42:43], v242 offset:512
ds_read_b64 v[44:45], v242 offset:1024
ds_read_b64 v[46:47], v242 offset:1536
ds_read_b64 v[56:57], v242 offset:2048
ds_read_b64 v[58:59], v242 offset:2560
ds_read_b64 v[60:61], v242 offset:3072
ds_read_b64 v[62:63], v242 offset:3584
ds_read_b64 v[48:49], v242 offset:4096
ds_read_b64 v[50:51], v242 offset:4608
ds_read_b64 v[52:53], v242 offset:5120
ds_read_b64 v[54:55], v242 offset:5632
ds_read_b64 v[64:65], v242 offset:6144
ds_read_b64 v[66:67], v242 offset:6656
ds_read_b64 v[68:69], v242 offset:7168
ds_read_b64 v[70:71], v242 offset:7680
s_waitcnt lgkmcnt(12)
v_swap_b32 v41, v44
v_swap_b32 v43, v46
s_waitcnt lgkmcnt(8)
v_swap_b32 v57, v60
v_swap_b32 v59, v62
s_waitcnt lgkmcnt(4)
v_swap_b32 v49, v52
v_swap_b32 v51, v54
s_waitcnt lgkmcnt(0)
v_swap_b32 v65, v68
v_swap_b32 v67, v70
s_nop 1
v_mfma_f32_16x16x32_bf16 v[152:155], v[40:43], v[200:203], 0
v_mfma_f32_16x16x32_bf16 v[156:159], v[44:47], v[200:203], 0
v_mfma_f32_16x16x32_bf16 v[160:163], v[56:59], v[200:203], 0
v_mfma_f32_16x16x32_bf16 v[164:167], v[60:63], v[200:203], 0
v_mfma_f32_16x16x32_bf16 v[152:155], v[48:51], v[204:207], v[152:155]
v_mfma_f32_16x16x32_bf16 v[156:159], v[52:55], v[204:207], v[156:159]
v_mfma_f32_16x16x32_bf16 v[160:163], v[64:67], v[204:207], v[160:163]
v_mfma_f32_16x16x32_bf16 v[164:167], v[68:71], v[204:207], v[164:167]
s_nop 7
v_and_b32 v244, 7, v1
v_mul_u32_u24 v244, 4224, v244
s_mov_b32 s42, 177408
s_mov_b64 exec, 0xff
buffer_load_dword v245, v244, s[24:27], s42 offen sc1
s_mov_b64 exec, -1
v_min_f32 v152, s48, v152
v_min_f32 v153, s48, v153
v_min_f32 v154, s48, v154
v_min_f32 v155, s48, v155
v_mfma_f32_16x16x32_bf16 v[136:139], v[40:43], v[208:211], 0
v_min_f32 v156, s48, v156
v_min_f32 v157, s48, v157
v_min_f32 v158, s48, v158
v_min_f32 v159, s48, v159
v_mfma_f32_16x16x32_bf16 v[140:143], v[44:47], v[208:211], 0
v_exp_f32 v160, v160
v_exp_f32 v161, v161
v_exp_f32 v162, v162
v_exp_f32 v163, v163
v_mfma_f32_16x16x32_bf16 v[144:147], v[56:59], v[208:211], 0
v_exp_f32 v164, v164
v_exp_f32 v165, v165
v_exp_f32 v166, v166
v_exp_f32 v167, v167
v_mfma_f32_16x16x32_bf16 v[148:151], v[60:63], v[208:211], 0
v_exp_f32 v152, v152
v_exp_f32 v153, v153
v_exp_f32 v154, v154
v_exp_f32 v155, v155
v_mfma_f32_16x16x32_bf16 v[136:139], v[48:51], v[212:215], v[136:139]
v_exp_f32 v156, v156
v_exp_f32 v157, v157
v_exp_f32 v158, v158
v_exp_f32 v159, v159
v_mfma_f32_16x16x32_bf16 v[140:143], v[52:55], v[212:215], v[140:143]
v_add_f32 v168, 1.0, v152
v_add_f32 v169, 1.0, v153
v_add_f32 v170, 1.0, v154
v_add_f32 v171, 1.0, v155
v_mfma_f32_16x16x32_bf16 v[144:147], v[64:67], v[212:215], v[144:147]
v_add_f32 v172, 1.0, v156
v_add_f32 v173, 1.0, v157
v_add_f32 v174, 1.0, v158
v_add_f32 v175, 1.0, v159
v_mfma_f32_16x16x32_bf16 v[148:151], v[68:71], v[212:215], v[148:151]
v_fma_f32 v160, v168, v160, v168
v_fma_f32 v161, v169, v161, v169
v_fma_f32 v162, v170, v162, v170
v_fma_f32 v163, v171, v163, v171
v_mfma_f32_16x16x32_bf16 v[188:191], v[224:227], v[40:43], 0
v_fma_f32 v164, v172, v164, v172
v_fma_f32 v165, v173, v165, v173
v_fma_f32 v166, v174, v166, v174
v_fma_f32 v167, v175, v167, v175
v_mfma_f32_16x16x32_bf16 v[192:195], v[224:227], v[56:59], 0
v_rcp_f32 v160, v160
v_rcp_f32 v161, v161
v_rcp_f32 v162, v162
v_rcp_f32 v163, v163
v_mfma_f32_16x16x32_bf16 v[188:191], v[232:235], v[44:47], v[188:191]
v_rcp_f32 v164, v164
v_rcp_f32 v165, v165
v_rcp_f32 v166, v166
v_rcp_f32 v167, v167
v_mfma_f32_16x16x32_bf16 v[192:195], v[232:235], v[60:63], v[192:195]
v_fma_f32 v152, -v152, v160, v160
v_fma_f32 v153, -v153, v161, v161
v_fma_f32 v154, -v154, v162, v162
v_fma_f32 v155, -v155, v163, v163
v_fma_f32 v156, -v156, v164, v164
v_fma_f32 v157, -v157, v165, v165
v_fma_f32 v158, -v158, v166, v166
v_fma_f32 v159, -v159, v167, v167
v_cvt_pk_bf16_f32 v184, v152, v156
v_cvt_pk_bf16_f32 v185, v153, v157
v_cvt_pk_bf16_f32 v186, v154, v158
v_cvt_pk_bf16_f32 v187, v155, v159
ds_write_b128 v6, v[184:187] offset:16384
s_waitcnt vmcnt(0)
s_mov_b64 exec, 0xff
v_cmp_ne_u32 vcc, 1, v245
s_mov_b64 exec, -1
s_nop 0
s_and_b32 s54, vcc_lo, 0xaa
s_and_b32 s40, vcc_lo, 0x55
s_cbranch_scc0 L_pd4
v_and_b32 v244, 7, v1
v_mul_u32_u24 v244, 4224, v244
s_mov_b32 s42, 177408
s_mov_b32 s41, 0
s_mov_b64 exec, 0x55
L_pl4:
buffer_load_dword v245, v244, s[24:27], s42 offen sc1
s_add_u32 s41, s41, 1
s_cmp_gt_u32 s41, 0x8000
s_cbranch_scc1 L_px4
s_waitcnt vmcnt(0)
v_cmp_ne_u32 vcc, 1, v245
s_nop 1
s_cbranch_vccz L_px4
s_sleep 1
s_branch L_pl4
L_px4:
s_mov_b64 exec, -1
L_pd4:
v_min_f32 v136, s48, v136
v_min_f32 v137, s48, v137
s_add_u32 m0, s51, 31232
s_nop 0
buffer_load_dwordx4 v0, s[16:19], s56 offen offset:1536 sc1 lds
v_min_f32 v138, s48, v138
v_min_f32 v139, s48, v139
v_mfma_f32_16x16x32_bf16 v[152:155], v[40:43], v[216:219], 0
v_min_f32 v140, s48, v140
v_min_f32 v141, s48, v141
v_min_f32 v142, s48, v142
v_min_f32 v143, s48, v143
v_mfma_f32_16x16x32_bf16 v[156:159], v[44:47], v[216:219], 0
v_exp_f32 v144, v144
v_exp_f32 v145, v145
v_exp_f32 v146, v146
v_exp_f32 v147, v147
v_mfma_f32_16x16x32_bf16 v[160:163], v[56:59], v[216:219], 0
v_exp_f32 v148, v148
v_exp_f32 v149, v149
s_add_u32 m0, s51, 32256
s_nop 0
buffer_load_dwordx4 v0, s[16:19], s57 offen offset:1536 sc1 lds
v_exp_f32 v150, v150
v_exp_f32 v151, v151
v_mfma_f32_16x16x32_bf16 v[164:167], v[60:63], v[216:219], 0
v_exp_f32 v136, v136
v_exp_f32 v137, v137
v_exp_f32 v138, v138
v_exp_f32 v139, v139
v_mfma_f32_16x16x32_bf16 v[152:155], v[48:51], v[220:223], v[152:155]
v_exp_f32 v140, v140
v_exp_f32 v141, v141
v_exp_f32 v142, v142
v_exp_f32 v143, v143
v_mfma_f32_16x16x32_bf16 v[156:159], v[52:55], v[220:223], v[156:159]
v_add_f32 v168, 1.0, v136
v_add_f32 v169, 1.0, v137
s_add_u32 m0, s51, 31232
s_nop 0
buffer_load_dwordx4 v0, s[16:19], s56 offen offset:3584 sc1 lds
v_add_f32 v170, 1.0, v138
v_add_f32 v171, 1.0, v139
v_mfma_f32_16x16x32_bf16 v[160:163], v[64:67], v[220:223], v[160:163]
v_add_f32 v172, 1.0, v140
v_add_f32 v173, 1.0, v141
v_add_f32 v174, 1.0, v142
v_add_f32 v175, 1.0, v143
v_mfma_f32_16x16x32_bf16 v[164:167], v[68:71], v[220:223], v[164:167]
v_fma_f32 v144, v168, v144, v168
v_fma_f32 v145, v169, v145, v169
v_fma_f32 v146, v170, v146, v170
v_fma_f32 v147, v171, v147, v171
v_mfma_f32_16x16x32_bf16 v[188:191], v[228:231], v[48:51], v[188:191]
v_fma_f32 v148, v172, v148, v172
v_fma_f32 v149, v173, v149, v173
s_add_u32 m0, s51, 32256
s_nop 0
buffer_load_dwordx4 v0, s[16:19], s57 offen offset:3584 sc1 lds
v_fma_f32 v150, v174, v150, v174
v_fma_f32 v151, v175, v151, v175
v_mfma_f32_16x16x32_bf16 v[192:195], v[228:231], v[64:67], v[192:195]
v_rcp_f32 v144, v144
v_rcp_f32 v145, v145
v_rcp_f32 v146, v146
v_rcp_f32 v147, v147
v_mfma_f32_16x16x32_bf16 v[188:191], v[236:239], v[52:55], v[188:191]
v_rcp_f32 v148, v148
v_rcp_f32 v149, v149
v_rcp_f32 v150, v150
v_rcp_f32 v151, v151
v_mfma_f32_16x16x32_bf16 v[192:195], v[236:239], v[68:71], v[192:195]
v_fma_f32 v136, -v136, v144, v144
v_fma_f32 v137, -v137, v145, v145
s_add_u32 m0, s51, 35328
s_nop 0
buffer_load_dwordx4 v0, s[16:19], s60 offen offset:1536 sc1 lds
v_fma_f32 v138, -v138, v146, v146
v_fma_f32 v139, -v139, v147, v147
v_fma_f32 v140, -v140, v148, v148
v_fma_f32 v141, -v141, v149, v149
v_fma_f32 v142, -v142, v150, v150
v_fma_f32 v143, -v143, v151, v151
v_cvt_pk_bf16_f32 v180, v136, v140
v_cvt_pk_bf16_f32 v181, v137, v141
v_cvt_pk_bf16_f32 v182, v138, v142
v_cvt_pk_bf16_f32 v183, v139, v143
ds_write_b128 v6, v[180:183] offset:17408
v_min_f32 v188, s48, v188
v_min_f32 v152, s48, v152
s_add_u32 m0, s51, 36352
s_nop 0
buffer_load_dwordx4 v0, s[16:19], s61 offen offset:1536 sc1 lds
v_min_f32 v153, s48, v153
v_min_f32 v154, s48, v154
v_min_f32 v155, s48, v155
v_min_f32 v156, s48, v156
v_min_f32 v157, s48, v157
v_min_f32 v158, s48, v158
v_min_f32 v159, s48, v159
v_exp_f32 v192, v192
v_exp_f32 v160, v160
v_exp_f32 v161, v161
v_exp_f32 v162, v162
v_exp_f32 v163, v163
s_add_u32 m0, s51, 35328
s_nop 0
buffer_load_dwordx4 v0, s[16:19], s60 offen offset:3584 sc1 lds
v_exp_f32 v164, v164
v_exp_f32 v165, v165
v_exp_f32 v166, v166
v_exp_f32 v167, v167
v_exp_f32 v188, v188
v_exp_f32 v152, v152
v_exp_f32 v153, v153
v_exp_f32 v154, v154
v_exp_f32 v155, v155
v_exp_f32 v156, v156
v_exp_f32 v157, v157
v_exp_f32 v158, v158
s_add_u32 m0, s51, 36352
s_nop 0
buffer_load_dwordx4 v0, s[16:19], s61 offen offset:3584 sc1 lds
v_exp_f32 v159, v159
v_add_f32 v168, 1.0, v188
v_add_f32 v169, 1.0, v152
v_add_f32 v170, 1.0, v153
v_add_f32 v171, 1.0, v154
v_add_f32 v172, 1.0, v155
v_add_f32 v173, 1.0, v156
v_add_f32 v174, 1.0, v157
v_add_f32 v175, 1.0, v158
v_add_f32 v176, 1.0, v159
v_fma_f32 v192, v168, v192, v168
v_fma_f32 v160, v169, v160, v169
v_fma_f32 v161, v170, v161, v170
v_fma_f32 v162, v171, v162, v171
v_fma_f32 v163, v172, v163, v172
v_fma_f32 v164, v173, v164, v173
v_fma_f32 v165, v174, v165, v174
v_fma_f32 v166, v175, v166, v175
v_fma_f32 v167, v176, v167, v176
v_rcp_f32 v192, v192
v_rcp_f32 v160, v160
v_rcp_f32 v161, v161
v_rcp_f32 v162, v162
v_rcp_f32 v163, v163
v_rcp_f32 v164, v164
v_rcp_f32 v165, v165
v_rcp_f32 v166, v166
v_rcp_f32 v167, v167
v_fma_f32 v188, -v188, v192, v192
v_fma_f32 v152, -v152, v160, v160
v_fma_f32 v153, -v153, v161, v161
v_fma_f32 v154, -v154, v162, v162
v_fma_f32 v155, -v155, v163, v163
v_fma_f32 v156, -v156, v164, v164
v_fma_f32 v157, -v157, v165, v165
v_fma_f32 v158, -v158, v166, v166
v_fma_f32 v159, -v159, v167, v167
v_cvt_pk_bf16_f32 v168, v188, v188
ds_write_b16 v7, v168 offset:19456
v_cvt_pk_bf16_f32 v184, v152, v156
v_cvt_pk_bf16_f32 v185, v153, v157
v_cvt_pk_bf16_f32 v186, v154, v158
v_cvt_pk_bf16_f32 v187, v155, v159
ds_write_b128 v6, v[184:187] offset:18432
s_mov_b64 exec, 1
ds_add_u32 v240, v241
s_mov_b64 exec, -1
s_waitcnt vmcnt(0)
ds_read_b64 v[72:73], v242 offset:32768
ds_read_b64 v[74:75], v242 offset:33280
ds_read_b64 v[76:77], v242 offset:33792
ds_read_b64 v[78:79], v242 offset:34304
ds_read_b64 v[88:89], v242 offset:34816
ds_read_b64 v[90:91], v242 offset:35328
ds_read_b64 v[92:93], v242 offset:35840
ds_read_b64 v[94:95], v242 offset:36352
ds_read_b64 v[80:81], v242 offset:36864
ds_read_b64 v[82:83], v242 offset:37376
ds_read_b64 v[84:85], v242 offset:37888
ds_read_b64 v[86:87], v242 offset:38400
ds_read_b64 v[96:97], v242 offset:38912
ds_read_b64 v[98:99], v242 offset:39424
ds_read_b64 v[100:101], v242 offset:39936
ds_read_b64 v[102:103], v242 offset:40448
s_waitcnt lgkmcnt(12)
v_swap_b32 v73, v76
v_swap_b32 v75, v78
s_waitcnt lgkmcnt(8)
v_swap_b32 v89, v92
v_swap_b32 v91, v94
s_waitcnt lgkmcnt(4)
v_swap_b32 v81, v84
v_swap_b32 v83, v86
s_waitcnt lgkmcnt(0)
v_swap_b32 v97, v100
v_swap_b32 v99, v102
s_nop 1
v_mfma_f32_16x16x32_bf16 v[136:139], v[72:75], v[200:203], 0
v_mfma_f32_16x16x32_bf16 v[140:143], v[76:79], v[200:203], 0
v_mfma_f32_16x16x32_bf16 v[144:147], v[88:91], v[200:203], 0
v_mfma_f32_16x16x32_bf16 v[148:151], v[92:95], v[200:203], 0
v_mfma_f32_16x16x32_bf16 v[136:139], v[80:83], v[204:207], v[136:139]
v_mfma_f32_16x16x32_bf16 v[140:143], v[84:87], v[204:207], v[140:143]
v_mfma_f32_16x16x32_bf16 v[144:147], v[96:99], v[204:207], v[144:147]
v_mfma_f32_16x16x32_bf16 v[148:151], v[100:103], v[204:207], v[148:151]
s_nop 7
v_min_f32 v136, s48, v136
v_min_f32 v137, s48, v137
s_cmp_eq_u32 s54, 0
s_cbranch_scc1 L_pd9
v_and_b32 v244, 7, v1
v_mul_u32_u24 v244, 4224, v244
s_mov_b32 s42, 177408
s_mov_b32 s41, 0
s_mov_b64 exec, 0xaa
L_pl9:
buffer_load_dword v245, v244, s[24:27], s42 offen sc1
s_add_u32 s41, s41, 1
s_cmp_gt_u32 s41, 0x8000
s_cbranch_scc1 L_px9
s_waitcnt vmcnt(0)
v_cmp_ne_u32 vcc, 1, v245
s_nop 1
s_cbranch_vccz L_px9
s_sleep 1
s_branch L_pl9
L_px9:
s_mov_b64 exec, -1
L_pd9:
s_add_u32 m0, s51, -512
s_nop 0
buffer_load_dwordx4 v0, s[16:19], s56 offen offset:512 sc1 lds
v_min_f32 v138, s48, v138
v_min_f32 v139, s48, v139
v_mfma_f32_16x16x32_bf16 v[152:155], v[72:75], v[208:211], 0
v_min_f32 v140, s48, v140
v_min_f32 v141, s48, v141
v_min_f32 v142, s48, v142
v_min_f32 v143, s48, v143
v_mfma_f32_16x16x32_bf16 v[156:159], v[76:79], v[208:211], 0
v_exp_f32 v144, v144
v_exp_f32 v145, v145
v_exp_f32 v146, v146
v_exp_f32 v147, v147
v_mfma_f32_16x16x32_bf16 v[160:163], v[88:91], v[208:211], 0
v_exp_f32 v148, v148
v_exp_f32 v149, v149
v_exp_f32 v150, v150
v_exp_f32 v151, v151
v_mfma_f32_16x16x32_bf16 v[164:167], v[92:95], v[208:211], 0
v_exp_f32 v136, v136
v_exp_f32 v137, v137
v_exp_f32 v138, v138
v_exp_f32 v139, v139
v_mfma_f32_16x16x32_bf16 v[152:155], v[80:83], v[212:215], v[152:155]
v_exp_f32 v140, v140
v_exp_f32 v141, v141
s_add_u32 m0, s51, 512
s_nop 0
buffer_load_dwordx4 v0, s[16:19], s57 offen offset:512 sc1 lds
v_exp_f32 v142, v142
v_exp_f32 v143, v143
v_mfma_f32_16x16x32_bf16 v[156:159], v[84:87], v[212:215], v[156:159]
v_add_f32 v168, 1.0, v136
v_add_f32 v169, 1.0, v137
v_add_f32 v170, 1.0, v138
v_add_f32 v171, 1.0, v139
v_mfma_f32_16x16x32_bf16 v[160:163], v[96:99], v[212:215], v[160:163]
v_add_f32 v172, 1.0, v140
v_add_f32 v173, 1.0, v141
v_add_f32 v174, 1.0, v142
v_add_f32 v175, 1.0, v143
v_mfma_f32_16x16x32_bf16 v[164:167], v[100:103], v[212:215], v[164:167]
v_fma_f32 v144, v168, v144, v168
v_fma_f32 v145, v169, v145, v169
v_fma_f32 v146, v170, v146, v170
v_fma_f32 v147, v171, v147, v171
v_mfma_f32_16x16x32_bf16 v[188:191], v[224:227], v[72:75], 0
v_fma_f32 v148, v172, v148, v172
v_fma_f32 v149, v173, v149, v173
v_fma_f32 v150, v174, v150, v174
v_fma_f32 v151, v175, v151, v175
v_mfma_f32_16x16x32_bf16 v[192:195], v[224:227], v[88:91], 0
v_rcp_f32 v144, v144
v_rcp_f32 v145, v145
s_add_u32 m0, s51, -512
s_nop 0
buffer_load_dwordx4 v0, s[16:19], s56 offen offset:2560 sc1 lds
v_rcp_f32 v146, v146
v_rcp_f32 v147, v147
v_mfma_f32_16x16x32_bf16 v[188:191], v[232:235], v[76:79], v[188:191]
v_rcp_f32 v148, v148
v_rcp_f32 v149, v149
v_rcp_f32 v150, v150
v_rcp_f32 v151, v151
v_mfma_f32_16x16x32_bf16 v[192:195], v[232:235], v[92:95], v[192:195]
v_fma_f32 v136, -v136, v144, v144
v_fma_f32 v137, -v137, v145, v145
v_fma_f32 v138, -v138, v146, v146
v_fma_f32 v139, -v139, v147, v147
v_fma_f32 v140, -v140, v148, v148
v_fma_f32 v141, -v141, v149, v149
v_fma_f32 v142, -v142, v150, v150
v_fma_f32 v143, -v143, v151, v151
v_cvt_pk_bf16_f32 v180, v136, v140
v_cvt_pk_bf16_f32 v181, v137, v141
v_cvt_pk_bf16_f32 v182, v138, v142
v_cvt_pk_bf16_f32 v183, v139, v143
ds_write_b128 v6, v[180:183] offset:32768
v_min_f32 v152, s48, v152
v_min_f32 v153, s48, v153
s_add_u32 m0, s51, 512
s_nop 0
buffer_load_dwordx4 v0, s[16:19], s57 offen offset:2560 sc1 lds
v_min_f32 v154, s48, v154
v_min_f32 v155, s48, v155
v_mfma_f32_16x16x32_bf16 v[136:139], v[72:75], v[216:219], 0
v_min_f32 v156, s48, v156
v_min_f32 v157, s48, v157
v_min_f32 v158, s48, v158
v_min_f32 v159, s48, v159
v_mfma_f32_16x16x32_bf16 v[140:143], v[76:79], v[216:219], 0
v_exp_f32 v160, v160
v_exp_f32 v161, v161
v_exp_f32 v162, v162
v_exp_f32 v163, v163
v_mfma_f32_16x16x32_bf16 v[144:147], v[88:91], v[216:219], 0
v_exp_f32 v164, v164
v_exp_f32 v165, v165
v_exp_f32 v166, v166
v_exp_f32 v167, v167
v_mfma_f32_16x16x32_bf16 v[148:151], v[92:95], v[216:219], 0
v_exp_f32 v152, v152
v_exp_f32 v153, v153
v_exp_f32 v154, v154
v_exp_f32 v155, v155
v_mfma_f32_16x16x32_bf16 v[136:139], v[80:83], v[220:223], v[136:139]
v_exp_f32 v156, v156
v_exp_f32 v157, v157
s_add_u32 m0, s51, 3584
s_nop 0
buffer_load_dwordx4 v0, s[16:19], s60 offen offset:512 sc1 lds
v_exp_f32 v158, v158
v_exp_f32 v159, v159
v_mfma_f32_16x16x32_bf16 v[140:143], v[84:87], v[220:223], v[140:143]
v_add_f32 v168, 1.0, v152
v_add_f32 v169, 1.0, v153
v_add_f32 v170, 1.0, v154
v_add_f32 v171, 1.0, v155
v_mfma_f32_16x16x32_bf16 v[144:147], v[96:99], v[220:223], v[144:147]
v_add_f32 v172, 1.0, v156
v_add_f32 v173, 1.0, v157
v_add_f32 v174, 1.0, v158
v_add_f32 v175, 1.0, v159
v_mfma_f32_16x16x32_bf16 v[148:151], v[100:103], v[220:223], v[148:151]
v_fma_f32 v160, v168, v160, v168
v_fma_f32 v161, v169, v161, v169
v_fma_f32 v162, v170, v162, v170
v_fma_f32 v163, v171, v163, v171
v_mfma_f32_16x16x32_bf16 v[188:191], v[228:231], v[80:83], v[188:191]
v_fma_f32 v164, v172, v164, v172
v_fma_f32 v165, v173, v165, v173
v_fma_f32 v166, v174, v166, v174
v_fma_f32 v167, v175, v167, v175
v_mfma_f32_16x16x32_bf16 v[192:195], v[228:231], v[96:99], v[192:195]
v_rcp_f32 v160, v160
v_rcp_f32 v161, v161
s_add_u32 m0, s51, 4608
s_nop 0
buffer_load_dwordx4 v0, s[16:19], s61 offen offset:512 sc1 lds
v_rcp_f32 v162, v162
v_rcp_f32 v163, v163
v_mfma_f32_16x16x32_bf16 v[188:191], v[236:239], v[84:87], v[188:191]
v_rcp_f32 v164, v164
v_rcp_f32 v165, v165
v_rcp_f32 v166, v166
v_rcp_f32 v167, v167
v_mfma_f32_16x16x32_bf16 v[192:195], v[236:239], v[100:103], v[192:195]
v_fma_f32 v152, -v152, v160, v160
v_fma_f32 v153, -v153, v161, v161
v_fma_f32 v154, -v154, v162, v162
v_fma_f32 v155, -v155, v163, v163
v_fma_f32 v156, -v156, v164, v164
v_fma_f32 v157, -v157, v165, v165
v_fma_f32 v158, -v158, v166, v166
v_fma_f32 v159, -v159, v167, v167
v_cvt_pk_bf16_f32 v184, v152, v156
v_cvt_pk_bf16_f32 v185, v153, v157
v_cvt_pk_bf16_f32 v186, v154, v158
v_cvt_pk_bf16_f32 v187, v155, v159
ds_write_b128 v6, v[184:187] offset:33792
v_min_f32 v188, s48, v188
v_min_f32 v136, s48, v136
s_add_u32 m0, s51, 3584
s_nop 0
buffer_load_dwordx4 v0, s[16:19], s60 offen offset:2560 sc1 lds
v_min_f32 v137, s48, v137
v_min_f32 v138, s48, v138
v_min_f32 v139, s48, v139
v_min_f32 v140, s48, v140
v_min_f32 v141, s48, v141
v_min_f32 v142, s48, v142
v_min_f32 v143, s48, v143
v_exp_f32 v192, v192
v_exp_f32 v144, v144
v_exp_f32 v145, v145
v_exp_f32 v146, v146
v_exp_f32 v147, v147
v_exp_f32 v148, v148
v_exp_f32 v149, v149
v_exp_f32 v150, v150
v_exp_f32 v151, v151
v_exp_f32 v188, v188
v_exp_f32 v136, v136
v_exp_f32 v137, v137
v_exp_f32 v138, v138
s_add_u32 m0, s51, 4608
s_nop 0
buffer_load_dwordx4 v0, s[16:19], s61 offen offset:2560 sc1 lds
v_exp_f32 v139, v139
v_exp_f32 v140, v140
v_exp_f32 v141, v141
v_exp_f32 v142, v142
v_exp_f32 v143, v143
v_add_f32 v168, 1.0, v188
v_add_f32 v169, 1.0, v136
v_add_f32 v170, 1.0, v137
v_add_f32 v171, 1.0, v138
v_add_f32 v172, 1.0, v139
v_add_f32 v173, 1.0, v140
v_add_f32 v174, 1.0, v141
v_add_f32 v175, 1.0, v142
v_add_f32 v176, 1.0, v143
v_fma_f32 v192, v168, v192, v168
v_fma_f32 v144, v169, v144, v169
v_fma_f32 v145, v170, v145, v170
v_fma_f32 v146, v171, v146, v171
v_fma_f32 v147, v172, v147, v172
v_fma_f32 v148, v173, v148, v173
v_fma_f32 v149, v174, v149, v174
v_fma_f32 v150, v175, v150, v175
v_fma_f32 v151, v176, v151, v176
v_rcp_f32 v192, v192
v_rcp_f32 v144, v144
v_rcp_f32 v145, v145
v_rcp_f32 v146, v146
v_rcp_f32 v147, v147
v_rcp_f32 v148, v148
v_rcp_f32 v149, v149
v_rcp_f32 v150, v150
v_rcp_f32 v151, v151
v_fma_f32 v188, -v188, v192, v192
v_fma_f32 v136, -v136, v144, v144
v_fma_f32 v137, -v137, v145, v145
v_fma_f32 v138, -v138, v146, v146
v_fma_f32 v139, -v139, v147, v147
v_fma_f32 v140, -v140, v148, v148
v_fma_f32 v141, -v141, v149, v149
v_fma_f32 v142, -v142, v150, v150
v_fma_f32 v143, -v143, v151, v151
v_cvt_pk_bf16_f32 v168, v188, v188
ds_write_b16 v7, v168 offset:35840
v_cvt_pk_bf16_f32 v180, v136, v140
v_cvt_pk_bf16_f32 v181, v137, v141
v_cvt_pk_bf16_f32 v182, v138, v142
v_cvt_pk_bf16_f32 v183, v139, v143
ds_write_b128 v6, v[180:183] offset:34816
s_mov_b64 exec, 1
ds_add_u32 v240, v241
s_mov_b64 exec, -1
s_waitcnt vmcnt(0)
ds_read_b64 v[104:105], v242 offset:0
ds_read_b64 v[106:107], v242 offset:512
ds_read_b64 v[108:109], v242 offset:1024
ds_read_b64 v[110:111], v242 offset:1536
ds_read_b64 v[120:121], v242 offset:2048
ds_read_b64 v[122:123], v242 offset:2560
ds_read_b64 v[124:125], v242 offset:3072
ds_read_b64 v[126:127], v242 offset:3584
ds_read_b64 v[112:113], v242 offset:4096
ds_read_b64 v[114:115], v242 offset:4608
ds_read_b64 v[116:117], v242 offset:5120
ds_read_b64 v[118:119], v242 offset:5632
ds_read_b64 v[128:129], v242 offset:6144
ds_read_b64 v[130:131], v242 offset:6656
ds_read_b64 v[132:133], v242 offset:7168
ds_read_b64 v[134:135], v242 offset:7680
s_waitcnt lgkmcnt(12)
v_swap_b32 v105, v108
v_swap_b32 v107, v110
s_waitcnt lgkmcnt(8)
v_swap_b32 v121, v124
v_swap_b32 v123, v126
s_waitcnt lgkmcnt(4)
v_swap_b32 v113, v116
v_swap_b32 v115, v118
s_waitcnt lgkmcnt(0)
v_swap_b32 v129, v132
v_swap_b32 v131, v134
s_nop 1
v_mfma_f32_16x16x32_bf16 v[152:155], v[104:107], v[200:203], 0
v_mfma_f32_16x16x32_bf16 v[156:159], v[108:111], v[200:203], 0
v_mfma_f32_16x16x32_bf16 v[160:163], v[120:123], v[200:203], 0
v_mfma_f32_16x16x32_bf16 v[164:167], v[124:127], v[200:203], 0
v_mfma_f32_16x16x32_bf16 v[152:155], v[112:115], v[204:207], v[152:155]
v_mfma_f32_16x16x32_bf16 v[156:159], v[116:119], v[204:207], v[156:159]
v_mfma_f32_16x16x32_bf16 v[160:163], v[128:131], v[204:207], v[160:163]
v_mfma_f32_16x16x32_bf16 v[164:167], v[132:135], v[204:207], v[164:167]
s_nop 7
v_min_f32 v152, s48, v152
v_min_f32 v153, s48, v153
v_min_f32 v154, s48, v154
v_min_f32 v155, s48, v155
v_mfma_f32_16x16x32_bf16 v[136:139], v[104:107], v[208:211], 0
v_min_f32 v156, s48, v156
v_min_f32 v157, s48, v157
v_min_f32 v158, s48, v158
v_min_f32 v159, s48, v159
v_mfma_f32_16x16x32_bf16 v[140:143], v[108:111], v[208:211], 0
v_exp_f32 v160, v160
v_exp_f32 v161, v161
v_exp_f32 v162, v162
v_exp_f32 v163, v163
v_mfma_f32_16x16x32_bf16 v[144:147], v[120:123], v[208:211], 0
v_exp_f32 v164, v164
v_exp_f32 v165, v165
v_exp_f32 v166, v166
v_exp_f32 v167, v167
v_mfma_f32_16x16x32_bf16 v[148:151], v[124:127], v[208:211], 0
v_exp_f32 v152, v152
v_exp_f32 v153, v153
v_exp_f32 v154, v154
v_exp_f32 v155, v155
v_mfma_f32_16x16x32_bf16 v[136:139], v[112:115], v[212:215], v[136:139]
v_exp_f32 v156, v156
v_exp_f32 v157, v157
v_exp_f32 v158, v158
v_exp_f32 v159, v159
v_mfma_f32_16x16x32_bf16 v[140:143], v[116:119], v[212:215], v[140:143]
v_add_f32 v168, 1.0, v152
v_add_f32 v169, 1.0, v153
v_add_f32 v170, 1.0, v154
v_add_f32 v171, 1.0, v155
v_mfma_f32_16x16x32_bf16 v[144:147], v[128:131], v[212:215], v[144:147]
v_add_f32 v172, 1.0, v156
v_add_f32 v173, 1.0, v157
v_add_f32 v174, 1.0, v158
v_add_f32 v175, 1.0, v159
v_mfma_f32_16x16x32_bf16 v[148:151], v[132:135], v[212:215], v[148:151]
v_fma_f32 v160, v168, v160, v168
v_fma_f32 v161, v169, v161, v169
v_fma_f32 v162, v170, v162, v170
v_fma_f32 v163, v171, v163, v171
v_mfma_f32_16x16x32_bf16 v[188:191], v[224:227], v[104:107], 0
v_fma_f32 v164, v172, v164, v172
v_fma_f32 v165, v173, v165, v173
v_fma_f32 v166, v174, v166, v174
v_fma_f32 v167, v175, v167, v175
v_mfma_f32_16x16x32_bf16 v[192:195], v[224:227], v[120:123], 0
v_rcp_f32 v160, v160
v_rcp_f32 v161, v161
v_rcp_f32 v162, v162
v_rcp_f32 v163, v163
v_mfma_f32_16x16x32_bf16 v[188:191], v[232:235], v[108:111], v[188:191]
v_rcp_f32 v164, v164
v_rcp_f32 v165, v165
v_rcp_f32 v166, v166
v_rcp_f32 v167, v167
v_mfma_f32_16x16x32_bf16 v[192:195], v[232:235], v[124:127], v[192:195]
v_fma_f32 v152, -v152, v160, v160
v_fma_f32 v153, -v153, v161, v161
v_fma_f32 v154, -v154, v162, v162
v_fma_f32 v155, -v155, v163, v163
v_fma_f32 v156, -v156, v164, v164
v_fma_f32 v157, -v157, v165, v165
v_fma_f32 v158, -v158, v166, v166
v_fma_f32 v159, -v159, v167, v167
v_cvt_pk_bf16_f32 v184, v152, v156
v_cvt_pk_bf16_f32 v185, v153, v157
v_cvt_pk_bf16_f32 v186, v154, v158
v_cvt_pk_bf16_f32 v187, v155, v159
ds_write_b128 v6, v[184:187] offset:49152
v_min_f32 v136, s48, v136
v_min_f32 v137, s48, v137
v_min_f32 v138, s48, v138
v_min_f32 v139, s48, v139
v_mfma_f32_16x16x32_bf16 v[152:155], v[104:107], v[216:219], 0
v_min_f32 v140, s48, v140
v_min_f32 v141, s48, v141
v_min_f32 v142, s48, v142
v_min_f32 v143, s48, v143
v_mfma_f32_16x16x32_bf16 v[156:159], v[108:111], v[216:219], 0
v_exp_f32 v144, v144
v_exp_f32 v145, v145
v_exp_f32 v146, v146
v_exp_f32 v147, v147
v_mfma_f32_16x16x32_bf16 v[160:163], v[120:123], v[216:219], 0
v_exp_f32 v148, v148
v_exp_f32 v149, v149
v_exp_f32 v150, v150
v_exp_f32 v151, v151
v_mfma_f32_16x16x32_bf16 v[164:167], v[124:127], v[216:219], 0
v_exp_f32 v136, v136
v_exp_f32 v137, v137
v_exp_f32 v138, v138
v_exp_f32 v139, v139
v_mfma_f32_16x16x32_bf16 v[152:155], v[112:115], v[220:223], v[152:155]
v_exp_f32 v140, v140
v_exp_f32 v141, v141
v_exp_f32 v142, v142
v_exp_f32 v143, v143
v_mfma_f32_16x16x32_bf16 v[156:159], v[116:119], v[220:223], v[156:159]
v_add_f32 v168, 1.0, v136
v_add_f32 v169, 1.0, v137
v_add_f32 v170, 1.0, v138
v_add_f32 v171, 1.0, v139
v_mfma_f32_16x16x32_bf16 v[160:163], v[128:131], v[220:223], v[160:163]
v_add_f32 v172, 1.0, v140
v_add_f32 v173, 1.0, v141
v_add_f32 v174, 1.0, v142
v_add_f32 v175, 1.0, v143
v_mfma_f32_16x16x32_bf16 v[164:167], v[132:135], v[220:223], v[164:167]
v_fma_f32 v144, v168, v144, v168
v_fma_f32 v145, v169, v145, v169
v_fma_f32 v146, v170, v146, v170
v_fma_f32 v147, v171, v147, v171
v_mfma_f32_16x16x32_bf16 v[188:191], v[228:231], v[112:115], v[188:191]
v_fma_f32 v148, v172, v148, v172
v_fma_f32 v149, v173, v149, v173
v_fma_f32 v150, v174, v150, v174
v_fma_f32 v151, v175, v151, v175
v_mfma_f32_16x16x32_bf16 v[192:195], v[228:231], v[128:131], v[192:195]
v_rcp_f32 v144, v144
v_rcp_f32 v145, v145
v_rcp_f32 v146, v146
v_rcp_f32 v147, v147
v_mfma_f32_16x16x32_bf16 v[188:191], v[236:239], v[116:119], v[188:191]
v_rcp_f32 v148, v148
v_rcp_f32 v149, v149
v_rcp_f32 v150, v150
v_rcp_f32 v151, v151
v_mfma_f32_16x16x32_bf16 v[192:195], v[236:239], v[132:135], v[192:195]
v_fma_f32 v136, -v136, v144, v144
v_fma_f32 v137, -v137, v145, v145
v_fma_f32 v138, -v138, v146, v146
v_fma_f32 v139, -v139, v147, v147
v_fma_f32 v140, -v140, v148, v148
v_fma_f32 v141, -v141, v149, v149
v_fma_f32 v142, -v142, v150, v150
v_fma_f32 v143, -v143, v151, v151
v_cvt_pk_bf16_f32 v180, v136, v140
v_cvt_pk_bf16_f32 v181, v137, v141
v_cvt_pk_bf16_f32 v182, v138, v142
v_cvt_pk_bf16_f32 v183, v139, v143
ds_write_b128 v6, v[180:183] offset:50176
v_min_f32 v188, s48, v188
v_min_f32 v152, s48, v152
v_min_f32 v153, s48, v153
v_min_f32 v154, s48, v154
v_min_f32 v155, s48, v155
v_min_f32 v156, s48, v156
v_min_f32 v157, s48, v157
v_min_f32 v158, s48, v158
v_min_f32 v159, s48, v159
v_exp_f32 v192, v192
v_exp_f32 v160, v160
v_exp_f32 v161, v161
v_exp_f32 v162, v162
v_exp_f32 v163, v163
v_exp_f32 v164, v164
v_exp_f32 v165, v165
v_exp_f32 v166, v166
v_exp_f32 v167, v167
v_exp_f32 v188, v188
v_exp_f32 v152, v152
v_exp_f32 v153, v153
v_exp_f32 v154, v154
v_exp_f32 v155, v155
v_exp_f32 v156, v156
v_exp_f32 v157, v157
v_exp_f32 v158, v158
v_exp_f32 v159, v159
v_add_f32 v168, 1.0, v188
v_add_f32 v169, 1.0, v152
v_add_f32 v170, 1.0, v153
v_add_f32 v171, 1.0, v154
v_add_f32 v172, 1.0, v155
v_add_f32 v173, 1.0, v156
v_add_f32 v174, 1.0, v157
v_add_f32 v175, 1.0, v158
v_add_f32 v176, 1.0, v159
v_fma_f32 v192, v168, v192, v168
v_fma_f32 v160, v169, v160, v169
v_fma_f32 v161, v170, v161, v170
v_fma_f32 v162, v171, v162, v171
v_fma_f32 v163, v172, v163, v172
v_fma_f32 v164, v173, v164, v173
v_fma_f32 v165, v174, v165, v174
v_fma_f32 v166, v175, v166, v175
v_fma_f32 v167, v176, v167, v176
v_rcp_f32 v192, v192
v_rcp_f32 v160, v160
v_rcp_f32 v161, v161
v_rcp_f32 v162, v162
v_rcp_f32 v163, v163
v_rcp_f32 v164, v164
v_rcp_f32 v165, v165
v_rcp_f32 v166, v166
v_rcp_f32 v167, v167
v_fma_f32 v188, -v188, v192, v192
v_fma_f32 v152, -v152, v160, v160
v_fma_f32 v153, -v153, v161, v161
v_fma_f32 v154, -v154, v162, v162
v_fma_f32 v155, -v155, v163, v163
v_fma_f32 v156, -v156, v164, v164
v_fma_f32 v157, -v157, v165, v165
v_fma_f32 v158, -v158, v166, v166
v_fma_f32 v159, -v159, v167, v167
v_cvt_pk_bf16_f32 v168, v188, v188
ds_write_b16 v7, v168 offset:52224
v_cvt_pk_bf16_f32 v184, v152, v156
v_cvt_pk_bf16_f32 v185, v153, v157
v_cvt_pk_bf16_f32 v186, v154, v158
v_cvt_pk_bf16_f32 v187, v155, v159
ds_write_b128 v6, v[184:187] offset:51200
s_mov_b64 exec, 1
ds_add_u32 v240, v241
s_mov_b64 exec, -1
L_fin:
s_endpgm
L_slow:
s_mov_b32 s41, 0
L_slow1:
ds_read_b32 v3, v0 offset:16
s_add_u32 s41, s41, 1
s_waitcnt lgkmcnt(0)
v_readfirstlane_b32 s57, v3
s_cmp_gt_u32 s41, 0x100000
s_cbranch_scc1 L_fast
s_sub_u32 s57, s57, s56
s_and_b32 s57, s57, 0x80808080
s_cbranch_scc1 L_slow1
s_branch L_fast
L_B:
s_sub_u32 s32, s32, 4
s_and_b32 s40, s33, 1
s_xor_b32 s40, s40, 1
s_lshr_b32 s41, s33, 2
s_lshl_b32 s41, s41, 1
s_add_u32 s37, s40, s41
s_bfe_u32 s40, s33, 0x10001
s_lshl_b32 s40, s40, 3
s_and_b32 s41, s34, 7
s_add_u32 s35, s40, s41
s_lshl_b32 s40, s37, 2
s_lshr_b32 s41, s34, 3
s_add_u32 s36, s40, s41
v_mov_b32 v4, 160512
v_mov_b32 v6, 0
v_mov_b32 v7, 0
ds_write_b64 v4, v[6:7] offset:0
ds_write_b64 v4, v[6:7] offset:8
ds_write_b64 v4, v[6:7] offset:16
ds_write_b64 v4, v[6:7] offset:24
ds_write_b64 v4, v[6:7] offset:32
ds_write_b64 v4, v[6:7] offset:40
ds_write_b64 v4, v[6:7] offset:48
ds_write_b64 v4, v[6:7] offset:56
ds_write_b64 v4, v[6:7] offset:64
v_bfe_u32 v10, v1, 3, 1
v_and_b32 v11, 7, v1
v_lshlrev_b32 v4, 20, v3
v_lshl_add_u32 v4, v10, 13, v4
v_lshl_add_u32 v4, v11, 4, v4
s_lshl_b32 s40, s36, 7
s_lshl_b32 s41, s32, 14
s_add_u32 s40, s40, s41
v_add_u32 v4, s40, v4
s_mov_b32 s56, 0
s_mov_b32 s57, 4194304
s_mov_b32 s58, 8388608
s_mov_b32 s59, 12582912
s_mov_b32 s60, 4096
s_mov_b32 s61, 4198400
s_mov_b32 s62, 8392704
s_mov_b32 s63, 12587008
s_waitcnt lgkmcnt(0)
s_mov_b32 s16, s6
s_mov_b32 s17, s7
s_mov_b32 s18, 15728640
s_mov_b32 s19, 0x20000
s_barrier
buffer_load_dwordx4 v[32:35], v4, s[16:19], s56 offen offset:0
buffer_load_dwordx4 v[36:39], v4, s[16:19], s57 offen offset:0
buffer_load_dwordx4 v[40:43], v4, s[16:19], s58 offen offset:0
buffer_load_dwordx4 v[44:47], v4, s[16:19], s59 offen offset:0
buffer_load_dwordx4 v[48:51], v4, s[16:19], s56 offen offset:2048
buffer_load_dwordx4 v[52:55], v4, s[16:19], s57 offen offset:2048
buffer_load_dwordx4 v[56:59], v4, s[16:19], s58 offen offset:2048
buffer_load_dwordx4 v[60:63], v4, s[16:19], s59 offen offset:2048
buffer_load_dwordx4 v[64:67], v4, s[16:19], s60 offen offset:0
buffer_load_dwordx4 v[68:71], v4, s[16:19], s61 offen offset:0
buffer_load_dwordx4 v[72:75], v4, s[16:19], s62 offen offset:0
buffer_load_dwordx4 v[76:79], v4, s[16:19], s63 offen offset:0
buffer_load_dwordx4 v[80:83], v4, s[16:19], s60 offen offset:2048
buffer_load_dwordx4 v[84:87], v4, s[16:19], s61 offen offset:2048
buffer_load_dwordx4 v[88:91], v4, s[16:19], s62 offen offset:2048
buffer_load_dwordx4 v[92:95], v4, s[16:19], s63 offen offset:2048
v_add_u32 v4, 0x10000, v4
v_lshrrev_b32 v8, 2, v2
v_and_b32 v9, 3, v2
v_lshrrev_b32 v12, 1, v8
s_lshl_b32 s40, s35, 1
v_add_u32 v12, s40, v12
v_lshl_add_u32 v12, v12, 1, 1
v_and_b32 v13, 1, v8
v_lshlrev_b32 v13, 5, v13
v_lshlrev_b32 v14, 1, v3
s_mov_b32 s41, 1006632960
s_cmp_lt_u32 s36, 8
s_cselect_b32 s42, 2.0, 1.0
v_add_u32 v15, 0, v14
v_mad_u32_u24 v15, v15, v12, v13
v_and_b32 v15, 127, v15
v_cvt_f32_u32 v15, v15
v_mul_f32 v15, s41, v15
v_cos_f32 v15, v15
s_nop 0
v_mul_f32 v15, s42, v15
v_cvt_pk_bf16_f32 v21, v15, v15
v_lshlrev_b32 v21, 16, v21
v_sub_f32 v15, v15, v21
v_cvt_pk_bf16_f32 v16, v21, v15
v_add_u32 v15, 8, v14
v_mad_u32_u24 v15, v15, v12, v13
v_and_b32 v15, 127, v15
v_cvt_f32_u32 v15, v15
v_mul_f32 v15, s41, v15
v_cos_f32 v15, v15
s_nop 0
v_mul_f32 v15, s42, v15
v_cvt_pk_bf16_f32 v21, v15, v15
v_lshlrev_b32 v21, 16, v21
v_sub_f32 v15, v15, v21
v_cvt_pk_bf16_f32 v17, v21, v15
v_add_u32 v15, 1, v14
v_mad_u32_u24 v15, v15, v12, v13
v_and_b32 v15, 127, v15
v_cvt_f32_u32 v15, v15
v_mul_f32 v15, s41, v15
v_cos_f32 v15, v15
s_nop 0
v_mul_f32 v15, s42, v15
v_cvt_pk_bf16_f32 v21, v15, v15
v_lshlrev_b32 v21, 16, v21
v_sub_f32 v15, v15, v21
v_cvt_pk_bf16_f32 v18, v21, v15
v_add_u32 v15, 9, v14
v_mad_u32_u24 v15, v15, v12, v13
v_and_b32 v15, 127, v15
v_cvt_f32_u32 v15, v15
v_mul_f32 v15, s41, v15
v_cos_f32 v15, v15
s_nop 0
v_mul_f32 v15, s42, v15
v_cvt_pk_bf16_f32 v21, v15, v15
v_lshlrev_b32 v21, 16, v21
v_sub_f32 v15, v15, v21
v_cvt_pk_bf16_f32 v19, v21, v15
v_mul_u32_u24 v20, 0x5555, v9
s_mov_b32 s38, s2
s_mov_b32 s20, s6
s_mov_b32 s21, s7
s_mov_b32 s22, 15728640
s_mov_b32 s23, 0x20000
s_add_u32 s24, s14, 62914560
s_addc_u32 s25, s15, 0
s_mov_b32 s26, 211200
s_mov_b32 s27, 0x20000
v_lshlrev_b32 v14, 7, v1
s_lshl_b32 s44, s34, 2
s_lshr_b32 s40, s33, 1
s_add_u32 s44, s44, s40
s_lshl_b32 s44, s44, 2
s_add_u32 s44, s44, s32
s_mov_b32 s45, 4000
s_sub_u32 s40, s34, 16
s_bitcmp0_b32 s37, 0
s_cselect_b32 s40, 63, s40
s_cmp_lt_u32 s40, 16
s_cselect_b32 s45, 960, s45
s_sub_u32 s40, s34, 20
s_bitcmp1_b32 s37, 0
s_cselect_b32 s40, 63, s40
s_cmp_lt_u32 s40, 4
s_cselect_b32 s45, 1152, s45
s_add_u32 s45, s45, s44
s_add_u32 s40, s45, 0
s_mul_i32 s41, s40, 8739
s_lshr_b32 s41, s41, 20
s_mul_i32 s42, s41, 120
s_sub_u32 s42, s40, s42
s_add_u32 s41, s41, 1
s_mul_i32 s43, s42, 4370
s_lshr_b32 s43, s43, 16
s_mul_i32 s40, s43, 15
s_sub_u32 s42, s42, s40
s_lshl_b32 s42, s42, 20
s_lshl_b32 s43, s43, 13
s_add_u32 s42, s42, s43
s_lshl_b32 s43, s41, 16
s_add_u32 s86, s42, s43
s_sub_u32 s41, s41, 4
s_max_i32 s87, s41, 4
s_mov_b32 s45, 4000
s_sub_u32 s40, s34, 20
s_bitcmp1_b32 s37, 0
s_cselect_b32 s40, 63, s40
s_cmp_lt_u32 s40, 4
s_cselect_b32 s45, 1216, s45
s_add_u32 s45, s45, s44
s_add_u32 s40, s45, 0
s_mul_i32 s41, s40, 8739
s_lshr_b32 s41, s41, 20
s_mul_i32 s42, s41, 120
s_sub_u32 s42, s40, s42
s_add_u32 s41, s41, 1
s_mul_i32 s43, s42, 4370
s_lshr_b32 s43, s43, 16
s_mul_i32 s40, s43, 15
s_sub_u32 s42, s42, s40
s_lshl_b32 s42, s42, 20
s_lshl_b32 s43, s43, 13
s_add_u32 s42, s42, s43
s_lshl_b32 s43, s41, 16
s_add_u32 s88, s42, s43
s_sub_u32 s41, s41, 4
s_max_i32 s89, s41, 4
s_lshl_b32 s40, s2, 2
s_add_u32 s40, s40, s32
s_min_u32 s40, s40, 1019
s_mul_i32 s41, s40, 964
s_lshr_b32 s41, s41, 16
s_mul_i32 s42, s41, 68
s_sub_u32 s40, s40, s42
s_mul_i32 s40, s40, 960
s_lshl_b32 s41, s41, 20
s_add_u32 s40, s40, s41
s_add_u32 s40, s40, 918016
s_add_u32 s98, s6, s40
s_addc_u32 s99, s7, 0
v_lshrrev_b32 v5, 1, v3
v_mul_u32_u24 v5, 0, v5
v_lshl_add_u32 v5, v3, 12, v5
v_lshl_add_u32 v5, v11, 5, v5
v_lshl_add_u32 v5, v10, 3, v5
s_lshl_b32 s40, s32, 8
v_add_u32 v5, s40, v5
v_add_u32 v6, 65536, v5
v_add_u32 v7, 65536, v5
s_mov_b32 s52, 0x80008000
s_mov_b32 s54, 0xffff0000
s_mov_b32 s55, 0xffff0000
v_mov_b32 v0, 139392
v_mov_b32 v8, 160544
v_lshl_add_u32 v9, v1, 2, v8
s_lshl_b32 s40, s32, 3
s_lshl_b32 s40, 1, s40
v_mov_b32 v11, s40
v_mov_b64 v[112:113], 0
v_mov_b64 v[114:115], 0
v_mov_b64 v[116:117], 0
v_mov_b64 v[118:119], 0
v_mov_b64 v[120:121], 0
v_mov_b64 v[122:123], 0
v_mov_b64 v[124:125], 0
v_mov_b64 v[126:127], 0
v_mov_b64 v[128:129], 0
v_mov_b64 v[130:131], 0
v_mov_b64 v[132:133], 0
v_mov_b64 v[134:135], 0
v_mov_b64 v[136:137], 0
v_mov_b64 v[138:139], 0
v_mov_b64 v[140:141], 0
v_mov_b64 v[142:143], 0
s_waitcnt vmcnt(12)
v_swap_b32 v34, v40
v_swap_b32 v38, v44
v_swap_b32 v35, v41
v_swap_b32 v39, v45
s_nop 1
v_smfmac_f32_16x16x64_bf16 v[112:115], v[16:19], v[32:39], v20
v_smfmac_f32_16x16x64_bf16 v[116:119], v[16:19], v[40:47], v20
s_waitcnt vmcnt(8)
v_swap_b32 v50, v56
v_swap_b32 v54, v60
v_swap_b32 v51, v57
v_swap_b32 v55, v61
s_nop 1
v_smfmac_f32_16x16x64_bf16 v[120:123], v[16:19], v[48:55], v20
v_smfmac_f32_16x16x64_bf16 v[124:127], v[16:19], v[56:63], v20
s_waitcnt vmcnt(4)
v_swap_b32 v66, v72
v_swap_b32 v70, v76
v_swap_b32 v67, v73
v_swap_b32 v71, v77
s_nop 2
v_cvt_pk_bf16_f32 v144, v112, v120
v_cvt_pk_bf16_f32 v146, v113, v121
v_cvt_pk_bf16_f32 v148, v114, v122
v_cvt_pk_bf16_f32 v150, v115, v123
v_cvt_pk_bf16_f32 v152, v116, v124
v_cvt_pk_bf16_f32 v154, v117, v125
v_cvt_pk_bf16_f32 v156, v118, v126
v_cvt_pk_bf16_f32 v158, v119, v127
v_mov_b64 v[112:113], 0
v_mov_b64 v[114:115], 0
v_mov_b64 v[116:117], 0
v_mov_b64 v[118:119], 0
v_mov_b64 v[120:121], 0
v_mov_b64 v[122:123], 0
v_mov_b64 v[124:125], 0
v_mov_b64 v[126:127], 0
v_smfmac_f32_16x16x64_bf16 v[128:131], v[16:19], v[64:71], v20
v_smfmac_f32_16x16x64_bf16 v[132:135], v[16:19], v[72:79], v20
s_waitcnt vmcnt(0)
v_swap_b32 v82, v88
v_swap_b32 v86, v92
v_swap_b32 v83, v89
v_swap_b32 v87, v93
s_nop 1
v_smfmac_f32_16x16x64_bf16 v[136:139], v[16:19], v[80:87], v20
v_smfmac_f32_16x16x64_bf16 v[140:143], v[16:19], v[88:95], v20
s_nop 7
v_cvt_pk_bf16_f32 v145, v128, v136
v_cvt_pk_bf16_f32 v147, v129, v137
v_cvt_pk_bf16_f32 v149, v130, v138
v_cvt_pk_bf16_f32 v151, v131, v139
v_cvt_pk_bf16_f32 v153, v132, v140
v_cvt_pk_bf16_f32 v155, v133, v141
v_cvt_pk_bf16_f32 v157, v134, v142
v_cvt_pk_bf16_f32 v159, v135, v143
v_mov_b64 v[128:129], 0
v_mov_b64 v[130:131], 0
v_mov_b64 v[132:133], 0
v_mov_b64 v[134:135], 0
v_mov_b64 v[136:137], 0
v_mov_b64 v[138:139], 0
v_mov_b64 v[140:141], 0
v_mov_b64 v[142:143], 0
ds_write_b64 v5, v[144:145] offset:0
ds_write_b64 v5, v[146:147] offset:1024
ds_write_b64 v5, v[148:149] offset:2048
ds_write_b64 v5, v[150:151] offset:3072
ds_write_b64 v5, v[152:153] offset:16
ds_write_b64 v5, v[154:155] offset:1040
ds_write_b64 v5, v[156:157] offset:2064
ds_write_b64 v5, v[158:159] offset:3088
s_mov_b64 exec, 15
ds_add_u32 v9, v11 offset:16
s_mov_b64 exec, -1
s_barrier
s_setprio 1
buffer_load_dwordx4 v[96:99], v4, s[16:19], s56 offen offset:0
buffer_load_dwordx4 v[100:103], v4, s[16:19], s57 offen offset:0
buffer_load_dwordx4 v[104:107], v4, s[16:19], s58 offen offset:0
buffer_load_dwordx4 v[108:111], v4, s[16:19], s59 offen offset:0
buffer_load_dwordx4 v[32:35], v4, s[16:19], s56 offen offset:2048
buffer_load_dwordx4 v[36:39], v4, s[16:19], s57 offen offset:2048
buffer_load_dwordx4 v[40:43], v4, s[16:19], s58 offen offset:2048
buffer_load_dwordx4 v[44:47], v4, s[16:19], s59 offen offset:2048
buffer_load_dwordx4 v[48:51], v4, s[16:19], s60 offen offset:0
buffer_load_dwordx4 v[52:55], v4, s[16:19], s61 offen offset:0
buffer_load_dwordx4 v[56:59], v4, s[16:19], s62 offen offset:0
s_waitcnt vmcnt(10)
buffer_load_dwordx4 v[60:63], v4, s[16:19], s63 offen offset:0
s_waitcnt vmcnt(10)
buffer_load_dwordx4 v[64:67], v4, s[16:19], s60 offen offset:2048
s_waitcnt vmcnt(10)
buffer_load_dwordx4 v[68:71], v4, s[16:19], s61 offen offset:2048
s_waitcnt vmcnt(10)
buffer_load_dwordx4 v[72:75], v4, s[16:19], s62 offen offset:2048
s_setprio 2
v_swap_b32 v98, v104
v_swap_b32 v102, v108
v_swap_b32 v99, v105
v_swap_b32 v103, v109
s_nop 1
v_smfmac_f32_16x16x64_bf16 v[112:115], v[16:19], v[96:103], v20
v_smfmac_f32_16x16x64_bf16 v[116:119], v[16:19], v[104:111], v20
s_setprio 0
s_waitcnt vmcnt(10)
buffer_load_dwordx4 v[76:79], v4, s[16:19], s63 offen offset:2048
v_add_u32 v4, 0x10000, v4
s_waitcnt vmcnt(10)
buffer_load_dwordx4 v[80:83], v4, s[16:19], s56 offen offset:0
s_waitcnt vmcnt(10)
buffer_load_dwordx4 v[84:87], v4, s[16:19], s57 offen offset:0
s_waitcnt vmcnt(10)
buffer_load_dwordx4 v[88:91], v4, s[16:19], s58 offen offset:0
s_setprio 2
v_swap_b32 v34, v40
v_swap_b32 v38, v44
v_swap_b32 v35, v41
v_swap_b32 v39, v45
s_nop 1
v_smfmac_f32_16x16x64_bf16 v[120:123], v[16:19], v[32:39], v20
v_smfmac_f32_16x16x64_bf16 v[124:127], v[16:19], v[40:47], v20
s_setprio 0
s_waitcnt vmcnt(10)
buffer_load_dwordx4 v[92:95], v4, s[16:19], s59 offen offset:0
s_waitcnt vmcnt(10)
buffer_load_dwordx4 v[96:99], v4, s[16:19], s56 offen offset:2048
s_waitcnt vmcnt(10)
buffer_load_dwordx4 v[100:103], v4, s[16:19], s57 offen offset:2048
s_waitcnt vmcnt(10)
buffer_load_dwordx4 v[104:107], v4, s[16:19], s58 offen offset:2048
s_setprio 2
v_swap_b32 v50, v56
v_swap_b32 v54, v60
v_swap_b32 v51, v57
v_swap_b32 v55, v61
v_cvt_pk_bf16_f32 v144, v112, v120
v_cvt_pk_bf16_f32 v146, v113, v121
v_cvt_pk_bf16_f32 v148, v114, v122
v_cvt_pk_bf16_f32 v150, v115, v123
v_cvt_pk_bf16_f32 v152, v116, v124
v_cvt_pk_bf16_f32 v154, v117, v125
v_cvt_pk_bf16_f32 v156, v118, v126
v_cvt_pk_bf16_f32 v158, v119, v127
v_mov_b64 v[112:113], 0
v_mov_b64 v[114:115], 0
v_mov_b64 v[116:117], 0
v_mov_b64 v[118:119], 0
v_mov_b64 v[120:121], 0
v_mov_b64 v[122:123], 0
v_mov_b64 v[124:125], 0
v_mov_b64 v[126:127], 0
v_smfmac_f32_16x16x64_bf16 v[128:131], v[16:19], v[48:55], v20
v_smfmac_f32_16x16x64_bf16 v[132:135], v[16:19], v[56:63], v20
s_setprio 0
s_waitcnt vmcnt(10)
buffer_load_dwordx4 v[108:111], v4, s[16:19], s59 offen offset:2048
s_waitcnt vmcnt(10)
buffer_load_dwordx4 v[32:35], v4, s[16:19], s60 offen offset:0
s_waitcnt vmcnt(10)
buffer_load_dwordx4 v[36:39], v4, s[16:19], s61 offen offset:0
s_waitcnt vmcnt(10)
buffer_load_dwordx4 v[40:43], v4, s[16:19], s62 offen offset:0
s_setprio 2
v_swap_b32 v66, v72
v_swap_b32 v70, v76
v_swap_b32 v67, v73
v_swap_b32 v71, v77
s_nop 1
v_smfmac_f32_16x16x64_bf16 v[136:139], v[16:19], v[64:71], v20
v_smfmac_f32_16x16x64_bf16 v[140:143], v[16:19], v[72:79], v20
s_setprio 0
s_waitcnt vmcnt(10)
buffer_load_dwordx4 v[44:47], v4, s[16:19], s63 offen offset:0
s_waitcnt vmcnt(10)
buffer_load_dwordx4 v[48:51], v4, s[16:19], s60 offen offset:2048
s_waitcnt vmcnt(10)
buffer_load_dwordx4 v[52:55], v4, s[16:19], s61 offen offset:2048
s_waitcnt vmcnt(10)
buffer_load_dwordx4 v[56:59], v4, s[16:19], s62 offen offset:2048
s_setprio 2
v_swap_b32 v82, v88
v_swap_b32 v86, v92
v_swap_b32 v83, v89
v_swap_b32 v87, v93
v_cvt_pk_bf16_f32 v145, v128, v136
v_cvt_pk_bf16_f32 v147, v129, v137
v_cvt_pk_bf16_f32 v149, v130, v138
v_cvt_pk_bf16_f32 v151, v131, v139
v_cvt_pk_bf16_f32 v153, v132, v140
v_cvt_pk_bf16_f32 v155, v133, v141
v_cvt_pk_bf16_f32 v157, v134, v142
v_cvt_pk_bf16_f32 v159, v135, v143
v_mov_b64 v[128:129], 0
v_mov_b64 v[130:131], 0
v_mov_b64 v[132:133], 0
v_mov_b64 v[134:135], 0
v_mov_b64 v[136:137], 0
v_mov_b64 v[138:139], 0
v_mov_b64 v[140:141], 0
v_mov_b64 v[142:143], 0
v_smfmac_f32_16x16x64_bf16 v[112:115], v[16:19], v[80:87], v20
v_smfmac_f32_16x16x64_bf16 v[116:119], v[16:19], v[88:95], v20
ds_write_b64 v5, v[144:145] offset:16384
ds_write_b64 v5, v[146:147] offset:17408
ds_write_b64 v5, v[148:149] offset:18432
ds_write_b64 v5, v[150:151] offset:19456
ds_write_b64 v5, v[152:153] offset:16400
ds_write_b64 v5, v[154:155] offset:17424
ds_write_b64 v5, v[156:157] offset:18448
ds_write_b64 v5, v[158:159] offset:19472
s_mov_b64 exec, 15
ds_add_u32 v9, v11 offset:16
s_mov_b64 exec, -1
s_setprio 0
s_waitcnt vmcnt(10)
buffer_load_dwordx4 v[60:63], v4, s[16:19], s63 offen offset:2048
v_add_u32 v4, 0x10000, v4
s_waitcnt vmcnt(10)
buffer_load_dwordx4 v[64:67], v4, s[16:19], s56 offen offset:0
s_waitcnt vmcnt(10)
buffer_load_dwordx4 v[68:71], v4, s[16:19], s57 offen offset:0
s_waitcnt vmcnt(10)
buffer_load_dwordx4 v[72:75], v4, s[16:19], s58 offen offset:0
s_setprio 2
v_swap_b32 v98, v104
v_swap_b32 v102, v108
v_swap_b32 v99, v105
v_swap_b32 v103, v109
s_nop 1
v_smfmac_f32_16x16x64_bf16 v[120:123], v[16:19], v[96:103], v20
v_smfmac_f32_16x16x64_bf16 v[124:127], v[16:19], v[104:111], v20
s_setprio 0
s_waitcnt vmcnt(10)
buffer_load_dwordx4 v[76:79], v4, s[16:19], s59 offen offset:0
s_waitcnt vmcnt(10)
buffer_load_dwordx4 v[80:83], v4, s[16:19], s56 offen offset:2048
s_waitcnt vmcnt(10)
buffer_load_dwordx4 v[84:87], v4, s[16:19], s57 offen offset:2048
s_waitcnt vmcnt(10)
buffer_load_dwordx4 v[88:91], v4, s[16:19], s58 offen offset:2048
s_setprio 2
v_swap_b32 v34, v40
v_swap_b32 v38, v44
v_swap_b32 v35, v41
v_swap_b32 v39, v45
v_cvt_pk_bf16_f32 v144, v112, v120
v_cvt_pk_bf16_f32 v146, v113, v121
v_cvt_pk_bf16_f32 v148, v114, v122
v_cvt_pk_bf16_f32 v150, v115, v123
v_cvt_pk_bf16_f32 v152, v116, v124
v_cvt_pk_bf16_f32 v154, v117, v125
v_cvt_pk_bf16_f32 v156, v118, v126
v_cvt_pk_bf16_f32 v158, v119, v127
v_mov_b64 v[112:113], 0
v_mov_b64 v[114:115], 0
v_mov_b64 v[116:117], 0
v_mov_b64 v[118:119], 0
v_mov_b64 v[120:121], 0
v_mov_b64 v[122:123], 0
v_mov_b64 v[124:125], 0
v_mov_b64 v[126:127], 0
v_smfmac_f32_16x16x64_bf16 v[128:131], v[16:19], v[32:39], v20
v_smfmac_f32_16x16x64_bf16 v[132:135], v[16:19], v[40:47], v20
s_setprio 0
s_waitcnt vmcnt(10)
buffer_load_dwordx4 v[92:95], v4, s[16:19], s59 offen offset:2048
s_waitcnt vmcnt(10)
buffer_load_dwordx4 v[96:99], v4, s[16:19], s60 offen offset:0
s_waitcnt vmcnt(10)
buffer_load_dwordx4 v[100:103], v4, s[16:19], s61 offen offset:0
s_waitcnt vmcnt(10)
buffer_load_dwordx4 v[104:107], v4, s[16:19], s62 offen offset:0
s_setprio 2
v_swap_b32 v50, v56
v_swap_b32 v54, v60
v_swap_b32 v51, v57
v_swap_b32 v55, v61
s_nop 1
v_smfmac_f32_16x16x64_bf16 v[136:139], v[16:19], v[48:55], v20
v_smfmac_f32_16x16x64_bf16 v[140:143], v[16:19], v[56:63], v20
s_setprio 0
s_waitcnt vmcnt(10)
buffer_load_dwordx4 v[108:111], v4, s[16:19], s63 offen offset:0
s_waitcnt vmcnt(10)
buffer_load_dwordx4 v[32:35], v4, s[16:19], s60 offen offset:2048
s_waitcnt vmcnt(10)
buffer_load_dwordx4 v[36:39], v4, s[16:19], s61 offen offset:2048
s_waitcnt vmcnt(10)
buffer_load_dwordx4 v[40:43], v4, s[16:19], s62 offen offset:2048
s_setprio 2
v_swap_b32 v66, v72
v_swap_b32 v70, v76
v_swap_b32 v67, v73
v_swap_b32 v71, v77
v_cvt_pk_bf16_f32 v145, v128, v136
v_cvt_pk_bf16_f32 v147, v129, v137
v_cvt_pk_bf16_f32 v149, v130, v138
v_cvt_pk_bf16_f32 v151, v131, v139
v_cvt_pk_bf16_f32 v153, v132, v140
v_cvt_pk_bf16_f32 v155, v133, v141
v_cvt_pk_bf16_f32 v157, v134, v142
v_cvt_pk_bf16_f32 v159, v135, v143
v_mov_b64 v[128:129], 0
v_mov_b64 v[130:131], 0
v_mov_b64 v[132:133], 0
v_mov_b64 v[134:135], 0
v_mov_b64 v[136:137], 0
v_mov_b64 v[138:139], 0
v_mov_b64 v[140:141], 0
v_mov_b64 v[142:143], 0
v_smfmac_f32_16x16x64_bf16 v[112:115], v[16:19], v[64:71], v20
v_smfmac_f32_16x16x64_bf16 v[116:119], v[16:19], v[72:79], v20
ds_write_b64 v5, v[144:145] offset:32768
ds_write_b64 v5, v[146:147] offset:33792
ds_write_b64 v5, v[148:149] offset:34816
ds_write_b64 v5, v[150:151] offset:35840
ds_write_b64 v5, v[152:153] offset:32784
ds_write_b64 v5, v[154:155] offset:33808
ds_write_b64 v5, v[156:157] offset:34832
ds_write_b64 v5, v[158:159] offset:35856
s_mov_b64 exec, 15
ds_add_u32 v9, v11 offset:16
s_mov_b64 exec, -1
s_setprio 0
s_waitcnt vmcnt(10)
buffer_load_dwordx4 v[44:47], v4, s[16:19], s63 offen offset:2048
v_add_u32 v4, 0x10000, v4
s_waitcnt vmcnt(10)
buffer_load_dwordx4 v[48:51], v4, s[16:19], s56 offen offset:0
s_waitcnt vmcnt(10)
buffer_load_dwordx4 v[52:55], v4, s[16:19], s57 offen offset:0
s_waitcnt vmcnt(10)
buffer_load_dwordx4 v[56:59], v4, s[16:19], s58 offen offset:0
s_setprio 2
v_swap_b32 v82, v88
v_swap_b32 v86, v92
v_swap_b32 v83, v89
v_swap_b32 v87, v93
s_nop 1
v_smfmac_f32_16x16x64_bf16 v[120:123], v[16:19], v[80:87], v20
v_smfmac_f32_16x16x64_bf16 v[124:127], v[16:19], v[88:95], v20
s_setprio 0
s_waitcnt vmcnt(10)
buffer_load_dwordx4 v[60:63], v4, s[16:19], s59 offen offset:0
s_waitcnt vmcnt(10)
buffer_load_dwordx4 v[64:67], v4, s[16:19], s56 offen offset:2048
s_waitcnt vmcnt(10)
buffer_load_dwordx4 v[68:71], v4, s[16:19], s57 offen offset:2048
s_waitcnt vmcnt(10)
buffer_load_dwordx4 v[72:75], v4, s[16:19], s58 offen offset:2048
s_setprio 2
v_swap_b32 v98, v104
v_swap_b32 v102, v108
v_swap_b32 v99, v105
v_swap_b32 v103, v109
v_cvt_pk_bf16_f32 v144, v112, v120
v_cvt_pk_bf16_f32 v146, v113, v121
v_cvt_pk_bf16_f32 v148, v114, v122
v_cvt_pk_bf16_f32 v150, v115, v123
v_cvt_pk_bf16_f32 v152, v116, v124
v_cvt_pk_bf16_f32 v154, v117, v125
v_cvt_pk_bf16_f32 v156, v118, v126
v_cvt_pk_bf16_f32 v158, v119, v127
v_mov_b64 v[112:113], 0
v_mov_b64 v[114:115], 0
v_mov_b64 v[116:117], 0
v_mov_b64 v[118:119], 0
v_mov_b64 v[120:121], 0
v_mov_b64 v[122:123], 0
v_mov_b64 v[124:125], 0
v_mov_b64 v[126:127], 0
v_smfmac_f32_16x16x64_bf16 v[128:131], v[16:19], v[96:103], v20
v_smfmac_f32_16x16x64_bf16 v[132:135], v[16:19], v[104:111], v20
s_setprio 0
s_waitcnt vmcnt(10)
buffer_load_dwordx4 v[76:79], v4, s[16:19], s59 offen offset:2048
s_waitcnt vmcnt(10)
buffer_load_dwordx4 v[80:83], v4, s[16:19], s60 offen offset:0
s_waitcnt vmcnt(10)
buffer_load_dwordx4 v[84:87], v4, s[16:19], s61 offen offset:0
s_waitcnt vmcnt(10)
buffer_load_dwordx4 v[88:91], v4, s[16:19], s62 offen offset:0
s_setprio 2
v_swap_b32 v34, v40
v_swap_b32 v38, v44
v_swap_b32 v35, v41
v_swap_b32 v39, v45
s_nop 1
v_smfmac_f32_16x16x64_bf16 v[136:139], v[16:19], v[32:39], v20
v_smfmac_f32_16x16x64_bf16 v[140:143], v[16:19], v[40:47], v20
s_setprio 0
s_waitcnt vmcnt(10)
buffer_load_dwordx4 v[92:95], v4, s[16:19], s63 offen offset:0
s_waitcnt vmcnt(10)
buffer_load_dwordx4 v[96:99], v4, s[16:19], s60 offen offset:2048
s_waitcnt vmcnt(10)
buffer_load_dwordx4 v[100:103], v4, s[16:19], s61 offen offset:2048
s_waitcnt vmcnt(10)
buffer_load_dwordx4 v[104:107], v4, s[16:19], s62 offen offset:2048
s_setprio 2
v_swap_b32 v50, v56
v_swap_b32 v54, v60
v_swap_b32 v51, v57
v_swap_b32 v55, v61
v_cvt_pk_bf16_f32 v145, v128, v136
v_cvt_pk_bf16_f32 v147, v129, v137
v_cvt_pk_bf16_f32 v149, v130, v138
v_cvt_pk_bf16_f32 v151, v131, v139
v_cvt_pk_bf16_f32 v153, v132, v140
v_cvt_pk_bf16_f32 v155, v133, v141
v_cvt_pk_bf16_f32 v157, v134, v142
v_cvt_pk_bf16_f32 v159, v135, v143
v_mov_b64 v[128:129], 0
v_mov_b64 v[130:131], 0
v_mov_b64 v[132:133], 0
v_mov_b64 v[134:135], 0
v_mov_b64 v[136:137], 0
v_mov_b64 v[138:139], 0
v_mov_b64 v[140:141], 0
v_mov_b64 v[142:143], 0
v_smfmac_f32_16x16x64_bf16 v[112:115], v[16:19], v[48:55], v20
v_smfmac_f32_16x16x64_bf16 v[116:119], v[16:19], v[56:63], v20
ds_write_b64 v5, v[144:145] offset:49152
ds_write_b64 v5, v[146:147] offset:50176
ds_write_b64 v5, v[148:149] offset:51200
ds_write_b64 v5, v[150:151] offset:52224
ds_write_b64 v5, v[152:153] offset:49168
ds_write_b64 v5, v[154:155] offset:50192
ds_write_b64 v5, v[156:157] offset:51216
ds_write_b64 v5, v[158:159] offset:52240
s_mov_b64 exec, 15
ds_add_u32 v9, v11 offset:16
s_mov_b64 exec, -1
s_setprio 0
s_waitcnt vmcnt(10)
buffer_load_dwordx4 v[108:111], v4, s[16:19], s63 offen offset:2048
v_add_u32 v4, 0x10000, v4
s_waitcnt vmcnt(10)
buffer_load_dwordx4 v[32:35], v4, s[16:19], s56 offen offset:0
s_waitcnt vmcnt(10)
buffer_load_dwordx4 v[36:39], v4, s[16:19], s57 offen offset:0
s_waitcnt vmcnt(10)
buffer_load_dwordx4 v[40:43], v4, s[16:19], s58 offen offset:0
s_setprio 2
v_swap_b32 v66, v72
v_swap_b32 v70, v76
v_swap_b32 v67, v73
v_swap_b32 v71, v77
s_nop 1
v_smfmac_f32_16x16x64_bf16 v[120:123], v[16:19], v[64:71], v20
v_smfmac_f32_16x16x64_bf16 v[124:127], v[16:19], v[72:79], v20
s_setprio 0
s_waitcnt vmcnt(10)
buffer_load_dwordx4 v[44:47], v4, s[16:19], s59 offen offset:0
s_waitcnt vmcnt(10)
buffer_load_dwordx4 v[48:51], v4, s[16:19], s56 offen offset:2048
s_waitcnt vmcnt(10)
buffer_load_dwordx4 v[52:55], v4, s[16:19], s57 offen offset:2048
s_waitcnt vmcnt(10)
buffer_load_dwordx4 v[56:59], v4, s[16:19], s58 offen offset:2048
s_setprio 2
v_swap_b32 v82, v88
v_swap_b32 v86, v92
v_swap_b32 v83, v89
v_swap_b32 v87, v93
v_cvt_pk_bf16_f32 v144, v112, v120
v_cvt_pk_bf16_f32 v146, v113, v121
v_cvt_pk_bf16_f32 v148, v114, v122
v_cvt_pk_bf16_f32 v150, v115, v123
v_cvt_pk_bf16_f32 v152, v116, v124
v_cvt_pk_bf16_f32 v154, v117, v125
v_cvt_pk_bf16_f32 v156, v118, v126
v_cvt_pk_bf16_f32 v158, v119, v127
v_mov_b64 v[112:113], 0
v_mov_b64 v[114:115], 0
v_mov_b64 v[116:117], 0
v_mov_b64 v[118:119], 0
v_mov_b64 v[120:121], 0
v_mov_b64 v[122:123], 0
v_mov_b64 v[124:125], 0
v_mov_b64 v[126:127], 0
v_smfmac_f32_16x16x64_bf16 v[128:131], v[16:19], v[80:87], v20
v_smfmac_f32_16x16x64_bf16 v[132:135], v[16:19], v[88:95], v20
s_setprio 0
s_waitcnt vmcnt(10)
buffer_load_dwordx4 v[60:63], v4, s[16:19], s59 offen offset:2048
s_waitcnt vmcnt(10)
buffer_load_dwordx4 v[64:67], v4, s[16:19], s60 offen offset:0
s_waitcnt vmcnt(10)
buffer_load_dwordx4 v[68:71], v4, s[16:19], s61 offen offset:0
s_waitcnt vmcnt(10)
buffer_load_dwordx4 v[72:75], v4, s[16:19], s62 offen offset:0
s_setprio 2
v_swap_b32 v98, v104
v_swap_b32 v102, v108
v_swap_b32 v99, v105
v_swap_b32 v103, v109
s_nop 1
v_smfmac_f32_16x16x64_bf16 v[136:139], v[16:19], v[96:103], v20
v_smfmac_f32_16x16x64_bf16 v[140:143], v[16:19], v[104:111], v20
s_setprio 0
s_waitcnt vmcnt(10)
buffer_load_dwordx4 v[76:79], v4, s[16:19], s63 offen offset:0
s_waitcnt vmcnt(10)
buffer_load_dwordx4 v[80:83], v4, s[16:19], s60 offen offset:2048
s_waitcnt vmcnt(10)
buffer_load_dwordx4 v[84:87], v4, s[16:19], s61 offen offset:2048
s_waitcnt vmcnt(10)
buffer_load_dwordx4 v[88:91], v4, s[16:19], s62 offen offset:2048
s_setprio 2
v_swap_b32 v34, v40
v_swap_b32 v38, v44
v_swap_b32 v35, v41
v_swap_b32 v39, v45
v_cvt_pk_bf16_f32 v145, v128, v136
v_cvt_pk_bf16_f32 v147, v129, v137
v_cvt_pk_bf16_f32 v149, v130, v138
v_cvt_pk_bf16_f32 v151, v131, v139
v_cvt_pk_bf16_f32 v153, v132, v140
v_cvt_pk_bf16_f32 v155, v133, v141
v_cvt_pk_bf16_f32 v157, v134, v142
v_cvt_pk_bf16_f32 v159, v135, v143
v_mov_b64 v[128:129], 0
v_mov_b64 v[130:131], 0
v_mov_b64 v[132:133], 0
v_mov_b64 v[134:135], 0
v_mov_b64 v[136:137], 0
v_mov_b64 v[138:139], 0
v_mov_b64 v[140:141], 0
v_mov_b64 v[142:143], 0
v_smfmac_f32_16x16x64_bf16 v[112:115], v[16:19], v[32:39], v20
v_smfmac_f32_16x16x64_bf16 v[116:119], v[16:19], v[40:47], v20
ds_write_b64 v6, v[144:145] offset:0
ds_write_b64 v6, v[146:147] offset:1024
ds_write_b64 v6, v[148:149] offset:2048
ds_write_b64 v6, v[150:151] offset:3072
ds_write_b64 v6, v[152:153] offset:16
ds_write_b64 v6, v[154:155] offset:1040
ds_write_b64 v6, v[156:157] offset:2064
ds_write_b64 v6, v[158:159] offset:3088
s_mov_b64 exec, 15
ds_add_u32 v9, v11 offset:16
s_mov_b64 exec, -1
s_setprio 0
s_waitcnt vmcnt(10)
buffer_load_dwordx4 v[92:95], v4, s[16:19], s63 offen offset:2048
v_add_u32 v4, 0x10000, v4
s_waitcnt vmcnt(10)
buffer_load_dwordx4 v[96:99], v4, s[16:19], s56 offen offset:0
s_waitcnt vmcnt(10)
buffer_load_dwordx4 v[100:103], v4, s[16:19], s57 offen offset:0
s_waitcnt vmcnt(10)
buffer_load_dwordx4 v[104:107], v4, s[16:19], s58 offen offset:0
s_setprio 2
v_swap_b32 v50, v56
v_swap_b32 v54, v60
v_swap_b32 v51, v57
v_swap_b32 v55, v61
s_nop 1
v_smfmac_f32_16x16x64_bf16 v[120:123], v[16:19], v[48:55], v20
v_smfmac_f32_16x16x64_bf16 v[124:127], v[16:19], v[56:63], v20
s_setprio 0
s_waitcnt vmcnt(10)
buffer_load_dwordx4 v[108:111], v4, s[16:19], s59 offen offset:0
s_waitcnt vmcnt(10)
buffer_load_dwordx4 v[32:35], v4, s[16:19], s56 offen offset:2048
s_waitcnt vmcnt(10)
buffer_load_dwordx4 v[36:39], v4, s[16:19], s57 offen offset:2048
s_waitcnt vmcnt(10)
buffer_load_dwordx4 v[40:43], v4, s[16:19], s58 offen offset:2048
s_setprio 2
v_swap_b32 v66, v72
v_swap_b32 v70, v76
v_swap_b32 v67, v73
v_swap_b32 v71, v77
v_cvt_pk_bf16_f32 v144, v112, v120
v_cvt_pk_bf16_f32 v146, v113, v121
v_cvt_pk_bf16_f32 v148, v114, v122
v_cvt_pk_bf16_f32 v150, v115, v123
v_cvt_pk_bf16_f32 v152, v116, v124
v_cvt_pk_bf16_f32 v154, v117, v125
v_cvt_pk_bf16_f32 v156, v118, v126
v_cvt_pk_bf16_f32 v158, v119, v127
v_mov_b64 v[112:113], 0
v_mov_b64 v[114:115], 0
v_mov_b64 v[116:117], 0
v_mov_b64 v[118:119], 0
v_mov_b64 v[120:121], 0
v_mov_b64 v[122:123], 0
v_mov_b64 v[124:125], 0
v_mov_b64 v[126:127], 0
v_smfmac_f32_16x16x64_bf16 v[128:131], v[16:19], v[64:71], v20
v_smfmac_f32_16x16x64_bf16 v[132:135], v[16:19], v[72:79], v20
s_setprio 0
s_waitcnt vmcnt(10)
buffer_load_dwordx4 v[44:47], v4, s[16:19], s59 offen offset:2048
s_waitcnt vmcnt(10)
buffer_load_dwordx4 v[48:51], v4, s[16:19], s60 offen offset:0
s_waitcnt vmcnt(10)
buffer_load_dwordx4 v[52:55], v4, s[16:19], s61 offen offset:0
s_waitcnt vmcnt(10)
buffer_load_dwordx4 v[56:59], v4, s[16:19], s62 offen offset:0
s_setprio 2
v_swap_b32 v82, v88
v_swap_b32 v86, v92
v_swap_b32 v83, v89
v_swap_b32 v87, v93
s_nop 1
v_smfmac_f32_16x16x64_bf16 v[136:139], v[16:19], v[80:87], v20
v_smfmac_f32_16x16x64_bf16 v[140:143], v[16:19], v[88:95], v20
s_setprio 0
s_waitcnt vmcnt(10)
buffer_load_dwordx4 v[60:63], v4, s[16:19], s63 offen offset:0
s_waitcnt vmcnt(10)
buffer_load_dwordx4 v[64:67], v4, s[16:19], s60 offen offset:2048
s_waitcnt vmcnt(10)
buffer_load_dwordx4 v[68:71], v4, s[16:19], s61 offen offset:2048
s_waitcnt vmcnt(10)
buffer_load_dwordx4 v[72:75], v4, s[16:19], s62 offen offset:2048
s_setprio 2
v_swap_b32 v98, v104
v_swap_b32 v102, v108
v_swap_b32 v99, v105
v_swap_b32 v103, v109
v_cvt_pk_bf16_f32 v145, v128, v136
v_cvt_pk_bf16_f32 v147, v129, v137
v_cvt_pk_bf16_f32 v149, v130, v138
v_cvt_pk_bf16_f32 v151, v131, v139
v_cvt_pk_bf16_f32 v153, v132, v140
v_cvt_pk_bf16_f32 v155, v133, v141
v_cvt_pk_bf16_f32 v157, v134, v142
v_cvt_pk_bf16_f32 v159, v135, v143
v_mov_b64 v[128:129], 0
v_mov_b64 v[130:131], 0
v_mov_b64 v[132:133], 0
v_mov_b64 v[134:135], 0
v_mov_b64 v[136:137], 0
v_mov_b64 v[138:139], 0
v_mov_b64 v[140:141], 0
v_mov_b64 v[142:143], 0
v_smfmac_f32_16x16x64_bf16 v[112:115], v[16:19], v[96:103], v20
v_smfmac_f32_16x16x64_bf16 v[116:119], v[16:19], v[104:111], v20
s_mov_b32 s41, 0
L_bw1:
ds_read_b128 v[24:27], v8
s_add_u32 s41, s41, 1
s_waitcnt lgkmcnt(0)
v_min3_u32 v24, v24, v25, v26
v_min_u32 v24, v24, v27
s_cmp_gt_u32 s41, 0x100000
v_readfirstlane_b32 s40, v24
s_cbranch_scc1 L_bd1
s_cmp_ge_u32 s40, 1
s_cbranch_scc1 L_bd1
s_sleep 1
s_branch L_bw1
L_bd1:
ds_write_b64 v6, v[144:145] offset:16384
ds_write_b64 v6, v[146:147] offset:17408
ds_write_b64 v6, v[148:149] offset:18432
ds_write_b64 v6, v[150:151] offset:19456
ds_write_b64 v6, v[152:153] offset:16400
ds_write_b64 v6, v[154:155] offset:17424
ds_write_b64 v6, v[156:157] offset:18448
ds_write_b64 v6, v[158:159] offset:19472
s_mov_b64 exec, 15
ds_add_u32 v9, v11 offset:16
s_mov_b64 exec, -1
s_setprio 0
s_waitcnt vmcnt(10)
buffer_load_dwordx4 v[76:79], v4, s[16:19], s63 offen offset:2048
v_add_u32 v4, 0x10000, v4
s_waitcnt vmcnt(10)
buffer_load_dwordx4 v[80:83], v4, s[16:19], s56 offen offset:0
s_waitcnt vmcnt(10)
buffer_load_dwordx4 v[84:87], v4, s[16:19], s57 offen offset:0
s_waitcnt vmcnt(10)
buffer_load_dwordx4 v[88:91], v4, s[16:19], s58 offen offset:0
s_setprio 2
v_swap_b32 v34, v40
v_swap_b32 v38, v44
v_swap_b32 v35, v41
v_swap_b32 v39, v45
s_nop 1
v_smfmac_f32_16x16x64_bf16 v[120:123], v[16:19], v[32:39], v20
v_smfmac_f32_16x16x64_bf16 v[124:127], v[16:19], v[40:47], v20
s_setprio 0
s_waitcnt vmcnt(10)
buffer_load_dwordx4 v[92:95], v4, s[16:19], s59 offen offset:0
s_waitcnt vmcnt(10)
buffer_load_dwordx4 v[96:99], v4, s[16:19], s56 offen offset:2048
s_waitcnt vmcnt(10)
buffer_load_dwordx4 v[100:103], v4, s[16:19], s57 offen offset:2048
s_waitcnt vmcnt(10)
buffer_load_dwordx4 v[104:107], v4, s[16:19], s58 offen offset:2048
s_setprio 2
v_swap_b32 v50, v56
v_swap_b32 v54, v60
v_swap_b32 v51, v57
v_swap_b32 v55, v61
v_cvt_pk_bf16_f32 v144, v112, v120
v_cvt_pk_bf16_f32 v146, v113, v121
v_cvt_pk_bf16_f32 v148, v114, v122
v_cvt_pk_bf16_f32 v150, v115, v123
v_cvt_pk_bf16_f32 v152, v116, v124
v_cvt_pk_bf16_f32 v154, v117, v125
v_cvt_pk_bf16_f32 v156, v118, v126
v_cvt_pk_bf16_f32 v158, v119, v127
v_mov_b64 v[112:113], 0
v_mov_b64 v[114:115], 0
v_mov_b64 v[116:117], 0
v_mov_b64 v[118:119], 0
v_mov_b64 v[120:121], 0
v_mov_b64 v[122:123], 0
v_mov_b64 v[124:125], 0
v_mov_b64 v[126:127], 0
v_smfmac_f32_16x16x64_bf16 v[128:131], v[16:19], v[48:55], v20
v_smfmac_f32_16x16x64_bf16 v[132:135], v[16:19], v[56:63], v20
s_setprio 0
s_waitcnt vmcnt(10)
buffer_load_dwordx4 v[108:111], v4, s[16:19], s59 offen offset:2048
s_waitcnt vmcnt(10)
buffer_load_dwordx4 v[32:35], v4, s[16:19], s60 offen offset:0
s_waitcnt vmcnt(10)
buffer_load_dwordx4 v[36:39], v4, s[16:19], s61 offen offset:0
s_waitcnt vmcnt(10)
buffer_load_dwordx4 v[40:43], v4, s[16:19], s62 offen offset:0
s_setprio 2
v_swap_b32 v66, v72
v_swap_b32 v70, v76
v_swap_b32 v67, v73
v_swap_b32 v71, v77
s_nop 1
v_smfmac_f32_16x16x64_bf16 v[136:139], v[16:19], v[64:71], v20
v_smfmac_f32_16x16x64_bf16 v[140:143], v[16:19], v[72:79], v20
s_setprio 0
s_waitcnt vmcnt(10)
buffer_load_dwordx4 v[44:47], v4, s[16:19], s63 offen offset:0
s_waitcnt vmcnt(10)
buffer_load_dwordx4 v[48:51], v4, s[16:19], s60 offen offset:2048
s_waitcnt vmcnt(10)
buffer_load_dwordx4 v[52:55], v4, s[16:19], s61 offen offset:2048
s_waitcnt vmcnt(10)
buffer_load_dwordx4 v[56:59], v4, s[16:19], s62 offen offset:2048
s_setprio 2
v_swap_b32 v82, v88
v_swap_b32 v86, v92
v_swap_b32 v83, v89
v_swap_b32 v87, v93
v_cvt_pk_bf16_f32 v145, v128, v136
v_cvt_pk_bf16_f32 v147, v129, v137
v_cvt_pk_bf16_f32 v149, v130, v138
v_cvt_pk_bf16_f32 v151, v131, v139
v_cvt_pk_bf16_f32 v153, v132, v140
v_cvt_pk_bf16_f32 v155, v133, v141
v_cvt_pk_bf16_f32 v157, v134, v142
v_cvt_pk_bf16_f32 v159, v135, v143
v_mov_b64 v[128:129], 0
v_mov_b64 v[130:131], 0
v_mov_b64 v[132:133], 0
v_mov_b64 v[134:135], 0
v_mov_b64 v[136:137], 0
v_mov_b64 v[138:139], 0
v_mov_b64 v[140:141], 0
v_mov_b64 v[142:143], 0
v_smfmac_f32_16x16x64_bf16 v[112:115], v[16:19], v[80:87], v20
v_smfmac_f32_16x16x64_bf16 v[116:119], v[16:19], v[88:95], v20
s_mov_b32 s41, 0
L_bw2:
ds_read_b128 v[24:27], v8
s_add_u32 s41, s41, 1
s_waitcnt lgkmcnt(0)
v_min3_u32 v24, v24, v25, v26
v_min_u32 v24, v24, v27
s_cmp_gt_u32 s41, 0x100000
v_readfirstlane_b32 s40, v24
s_cbranch_scc1 L_bd2
s_cmp_ge_u32 s40, 2
s_cbranch_scc1 L_bd2
s_sleep 1
s_branch L_bw2
L_bd2:
ds_write_b64 v6, v[144:145] offset:32768
ds_write_b64 v6, v[146:147] offset:33792
ds_write_b64 v6, v[148:149] offset:34816
ds_write_b64 v6, v[150:151] offset:35840
ds_write_b64 v6, v[152:153] offset:32784
ds_write_b64 v6, v[154:155] offset:33808
ds_write_b64 v6, v[156:157] offset:34832
ds_write_b64 v6, v[158:159] offset:35856
s_mov_b64 exec, 15
ds_add_u32 v9, v11 offset:16
s_mov_b64 exec, -1
s_setprio 0
s_waitcnt vmcnt(10)
buffer_load_dwordx4 v[60:63], v4, s[16:19], s63 offen offset:2048
v_add_u32 v4, 0x10000, v4
s_cmp_eq_u32 s87, 7
s_cselect_b32 s22, 15728640, 0
buffer_load_dword v15, v14, s[20:23], s86 offen
s_waitcnt vmcnt(10)
buffer_load_dwordx4 v[64:67], v4, s[16:19], s56 offen offset:0
s_waitcnt vmcnt(10)
buffer_load_dwordx4 v[68:71], v4, s[16:19], s57 offen offset:0
s_setprio 2
v_swap_b32 v98, v104
v_swap_b32 v102, v108
v_swap_b32 v99, v105
v_swap_b32 v103, v109
s_nop 1
v_smfmac_f32_16x16x64_bf16 v[120:123], v[16:19], v[96:103], v20
v_smfmac_f32_16x16x64_bf16 v[124:127], v[16:19], v[104:111], v20
s_setprio 0
s_waitcnt vmcnt(10)
buffer_load_dwordx4 v[72:75], v4, s[16:19], s58 offen offset:0
s_waitcnt vmcnt(10)
buffer_load_dwordx4 v[76:79], v4, s[16:19], s59 offen offset:0
s_waitcnt vmcnt(10)
buffer_load_dwordx4 v[80:83], v4, s[16:19], s56 offen offset:2048
s_waitcnt vmcnt(10)
buffer_load_dwordx4 v[84:87], v4, s[16:19], s57 offen offset:2048
s_setprio 2
v_swap_b32 v34, v40
v_swap_b32 v38, v44
v_swap_b32 v35, v41
v_swap_b32 v39, v45
v_cvt_pk_bf16_f32 v144, v112, v120
v_cvt_pk_bf16_f32 v146, v113, v121
v_cvt_pk_bf16_f32 v148, v114, v122
v_cvt_pk_bf16_f32 v150, v115, v123
v_cvt_pk_bf16_f32 v152, v116, v124
v_cvt_pk_bf16_f32 v154, v117, v125
v_cvt_pk_bf16_f32 v156, v118, v126
v_cvt_pk_bf16_f32 v158, v119, v127
v_mov_b64 v[112:113], 0
v_mov_b64 v[114:115], 0
v_mov_b64 v[116:117], 0
v_mov_b64 v[118:119], 0
v_mov_b64 v[120:121], 0
v_mov_b64 v[122:123], 0
v_mov_b64 v[124:125], 0
v_mov_b64 v[126:127], 0
v_smfmac_f32_16x16x64_bf16 v[128:131], v[16:19], v[32:39], v20
v_smfmac_f32_16x16x64_bf16 v[132:135], v[16:19], v[40:47], v20
s_setprio 0
s_waitcnt vmcnt(10)
buffer_load_dwordx4 v[88:91], v4, s[16:19], s58 offen offset:2048
s_waitcnt vmcnt(10)
buffer_load_dwordx4 v[92:95], v4, s[16:19], s59 offen offset:2048
s_waitcnt vmcnt(10)
buffer_load_dwordx4 v[96:99], v4, s[16:19], s60 offen offset:0
s_waitcnt vmcnt(10)
buffer_load_dwordx4 v[100:103], v4, s[16:19], s61 offen offset:0
s_setprio 2
v_swap_b32 v50, v56
v_swap_b32 v54, v60
v_swap_b32 v51, v57
v_swap_b32 v55, v61
s_nop 1
v_smfmac_f32_16x16x64_bf16 v[136:139], v[16:19], v[48:55], v20
v_smfmac_f32_16x16x64_bf16 v[140:143], v[16:19], v[56:63], v20
s_setprio 0
s_waitcnt vmcnt(10)
buffer_load_dwordx4 v[104:107], v4, s[16:19], s62 offen offset:0
s_waitcnt vmcnt(10)
buffer_load_dwordx4 v[108:111], v4, s[16:19], s63 offen offset:0
s_waitcnt vmcnt(10)
buffer_load_dwordx4 v[32:35], v4, s[16:19], s60 offen offset:2048
s_waitcnt vmcnt(10)
buffer_load_dwordx4 v[36:39], v4, s[16:19], s61 offen offset:2048
s_waitcnt vmcnt(10)
buffer_load_dwordx4 v[40:43], v4, s[16:19], s62 offen offset:2048
s_setprio 2
v_swap_b32 v66, v72
v_swap_b32 v70, v76
v_swap_b32 v67, v73
v_swap_b32 v71, v77
v_cvt_pk_bf16_f32 v145, v128, v136
v_cvt_pk_bf16_f32 v147, v129, v137
v_cvt_pk_bf16_f32 v149, v130, v138
v_cvt_pk_bf16_f32 v151, v131, v139
v_cvt_pk_bf16_f32 v153, v132, v140
v_cvt_pk_bf16_f32 v155, v133, v141
v_cvt_pk_bf16_f32 v157, v134, v142
v_cvt_pk_bf16_f32 v159, v135, v143
v_mov_b64 v[128:129], 0
v_mov_b64 v[130:131], 0
v_mov_b64 v[132:133], 0
v_mov_b64 v[134:135], 0
v_mov_b64 v[136:137], 0
v_mov_b64 v[138:139], 0
v_mov_b64 v[140:141], 0
v_mov_b64 v[142:143], 0
v_smfmac_f32_16x16x64_bf16 v[112:115], v[16:19], v[64:71], v20
v_smfmac_f32_16x16x64_bf16 v[116:119], v[16:19], v[72:79], v20
s_mov_b32 s41, 0
L_bw4:
ds_read_b128 v[24:27], v8
s_add_u32 s41, s41, 1
s_waitcnt lgkmcnt(0)
v_min3_u32 v24, v24, v25, v26
v_min_u32 v24, v24, v27
s_cmp_gt_u32 s41, 0x100000
v_readfirstlane_b32 s40, v24
s_cbranch_scc1 L_bd4
s_cmp_ge_u32 s40, 4
s_cbranch_scc1 L_bd4
s_sleep 1
s_branch L_bw4
L_bd4:
ds_write_b64 v6, v[144:145] offset:49152
ds_write_b64 v6, v[146:147] offset:50176
ds_write_b64 v6, v[148:149] offset:51200
ds_write_b64 v6, v[150:151] offset:52224
ds_write_b64 v6, v[152:153] offset:49168
ds_write_b64 v6, v[154:155] offset:50192
ds_write_b64 v6, v[156:157] offset:51216
ds_write_b64 v6, v[158:159] offset:52240
s_mov_b64 exec, 15
ds_add_u32 v9, v11 offset:16
s_mov_b64 exec, -1
s_setprio 0
s_waitcnt vmcnt(10)
buffer_load_dwordx4 v[44:47], v4, s[16:19], s63 offen offset:2048
v_add_u32 v4, 0x10000, v4
s_cmp_eq_u32 s87, 8
s_cselect_b32 s22, 15728640, 0
buffer_load_dword v15, v14, s[20:23], s86 offen
s_waitcnt vmcnt(10)
buffer_load_dwordx4 v[48:51], v4, s[16:19], s56 offen offset:0
s_waitcnt vmcnt(10)
buffer_load_dwordx4 v[52:55], v4, s[16:19], s57 offen offset:0
s_setprio 2
v_swap_b32 v82, v88
v_swap_b32 v86, v92
v_swap_b32 v83, v89
v_swap_b32 v87, v93
s_load_dword s100, s[98:99], 0
s_load_dword s100, s[98:99], 64
s_load_dword s100, s[98:99], 128
s_load_dword s100, s[98:99], 192
s_load_dword s100, s[98:99], 256
s_load_dword s100, s[98:99], 320
s_load_dword s100, s[98:99], 384
s_load_dword s100, s[98:99], 448
s_load_dword s100, s[98:99], 512
s_load_dword s100, s[98:99], 576
s_load_dword s100, s[98:99], 640
s_load_dword s100, s[98:99], 704
s_load_dword s100, s[98:99], 768
s_load_dword s100, s[98:99], 832
s_load_dword s100, s[98:99], 896
v_smfmac_f32_16x16x64_bf16 v[120:123], v[16:19], v[80:87], v20
v_smfmac_f32_16x16x64_bf16 v[124:127], v[16:19], v[88:95], v20
s_setprio 0
s_waitcnt vmcnt(10)
buffer_load_dwordx4 v[56:59], v4, s[16:19], s58 offen offset:0
s_waitcnt vmcnt(10)
buffer_load_dwordx4 v[60:63], v4, s[16:19], s59 offen offset:0
s_waitcnt vmcnt(10)
buffer_load_dwordx4 v[64:67], v4, s[16:19], s56 offen offset:2048
s_waitcnt vmcnt(10)
buffer_load_dwordx4 v[68:71], v4, s[16:19], s57 offen offset:2048
s_setprio 2
v_swap_b32 v98, v104
v_swap_b32 v102, v108
v_swap_b32 v99, v105
v_swap_b32 v103, v109
v_cvt_pk_bf16_f32 v144, v112, v120
v_cvt_pk_bf16_f32 v146, v113, v121
v_cvt_pk_bf16_f32 v148, v114, v122
v_cvt_pk_bf16_f32 v150, v115, v123
v_cvt_pk_bf16_f32 v152, v116, v124
v_cvt_pk_bf16_f32 v154, v117, v125
v_cvt_pk_bf16_f32 v156, v118, v126
v_cvt_pk_bf16_f32 v158, v119, v127
v_mov_b64 v[112:113], 0
v_mov_b64 v[114:115], 0
v_mov_b64 v[116:117], 0
v_mov_b64 v[118:119], 0
v_mov_b64 v[120:121], 0
v_mov_b64 v[122:123], 0
v_mov_b64 v[124:125], 0
v_mov_b64 v[126:127], 0
v_smfmac_f32_16x16x64_bf16 v[128:131], v[16:19], v[96:103], v20
v_smfmac_f32_16x16x64_bf16 v[132:135], v[16:19], v[104:111], v20
s_setprio 0
s_waitcnt vmcnt(10)
buffer_load_dwordx4 v[72:75], v4, s[16:19], s58 offen offset:2048
s_waitcnt vmcnt(10)
buffer_load_dwordx4 v[76:79], v4, s[16:19], s59 offen offset:2048
s_waitcnt vmcnt(10)
buffer_load_dwordx4 v[80:83], v4, s[16:19], s60 offen offset:0
s_waitcnt vmcnt(10)
buffer_load_dwordx4 v[84:87], v4, s[16:19], s61 offen offset:0
s_setprio 2
v_swap_b32 v34, v40
v_swap_b32 v38, v44
v_swap_b32 v35, v41
v_swap_b32 v39, v45
s_nop 1
v_smfmac_f32_16x16x64_bf16 v[136:139], v[16:19], v[32:39], v20
v_smfmac_f32_16x16x64_bf16 v[140:143], v[16:19], v[40:47], v20
s_setprio 0
s_waitcnt vmcnt(10)
buffer_load_dwordx4 v[88:91], v4, s[16:19], s62 offen offset:0
s_waitcnt vmcnt(10)
buffer_load_dwordx4 v[92:95], v4, s[16:19], s63 offen offset:0
s_waitcnt vmcnt(10)
buffer_load_dwordx4 v[96:99], v4, s[16:19], s60 offen offset:2048
s_waitcnt vmcnt(10)
buffer_load_dwordx4 v[100:103], v4, s[16:19], s61 offen offset:2048
s_waitcnt vmcnt(10)
buffer_load_dwordx4 v[104:107], v4, s[16:19], s62 offen offset:2048
s_setprio 2
v_swap_b32 v50, v56
v_swap_b32 v54, v60
v_swap_b32 v51, v57
v_swap_b32 v55, v61
v_cvt_pk_bf16_f32 v145, v128, v136
v_cvt_pk_bf16_f32 v147, v129, v137
v_cvt_pk_bf16_f32 v149, v130, v138
v_cvt_pk_bf16_f32 v151, v131, v139
v_cvt_pk_bf16_f32 v153, v132, v140
v_cvt_pk_bf16_f32 v155, v133, v141
v_cvt_pk_bf16_f32 v157, v134, v142
v_cvt_pk_bf16_f32 v159, v135, v143
v_mov_b64 v[128:129], 0
v_mov_b64 v[130:131], 0
v_mov_b64 v[132:133], 0
v_mov_b64 v[134:135], 0
v_mov_b64 v[136:137], 0
v_mov_b64 v[138:139], 0
v_mov_b64 v[140:141], 0
v_mov_b64 v[142:143], 0
v_smfmac_f32_16x16x64_bf16 v[112:115], v[16:19], v[48:55], v20
v_smfmac_f32_16x16x64_bf16 v[116:119], v[16:19], v[56:63], v20
s_mov_b32 s41, 0
L_bw5:
ds_read_b128 v[24:27], v8
s_add_u32 s41, s41, 1
s_waitcnt lgkmcnt(0)
v_min3_u32 v24, v24, v25, v26
v_min_u32 v24, v24, v27
s_cmp_gt_u32 s41, 0x100000
v_readfirstlane_b32 s40, v24
s_cbranch_scc1 L_bd5
s_cmp_ge_u32 s40, 5
s_cbranch_scc1 L_bd5
s_sleep 1
s_branch L_bw5
L_bd5:
ds_write_b64 v5, v[144:145] offset:0
ds_write_b64 v5, v[146:147] offset:1024
ds_write_b64 v5, v[148:149] offset:2048
ds_write_b64 v5, v[150:151] offset:3072
ds_write_b64 v5, v[152:153] offset:16
ds_write_b64 v5, v[154:155] offset:1040
ds_write_b64 v5, v[156:157] offset:2064
ds_write_b64 v5, v[158:159] offset:3088
s_mov_b64 exec, 15
ds_add_u32 v9, v11 offset:16
s_mov_b64 exec, -1
s_setprio 0
s_waitcnt vmcnt(10)
buffer_load_dwordx4 v[108:111], v4, s[16:19], s63 offen offset:2048
v_add_u32 v4, 0x10000, v4
s_cmp_eq_u32 s87, 9
s_cselect_b32 s22, 15728640, 0
buffer_load_dword v15, v14, s[20:23], s86 offen
s_cmp_eq_u32 s89, 9
s_cselect_b32 s22, 15728640, 0
buffer_load_dword v15, v14, s[20:23], s88 offen
s_waitcnt vmcnt(10)
buffer_load_dwordx4 v[32:35], v4, s[16:19], s56 offen offset:0
s_setprio 2
v_swap_b32 v66, v72
v_swap_b32 v70, v76
v_swap_b32 v67, v73
v_swap_b32 v71, v77
s_load_dword s100, s[98:99], 65280
s_load_dword s100, s[98:99], 65344
s_load_dword s100, s[98:99], 65408
s_load_dword s100, s[98:99], 65472
s_load_dword s100, s[98:99], 65536
s_load_dword s100, s[98:99], 65600
s_load_dword s100, s[98:99], 65664
s_load_dword s100, s[98:99], 65728
s_load_dword s100, s[98:99], 65792
s_load_dword s100, s[98:99], 65856
s_load_dword s100, s[98:99], 65920
s_load_dword s100, s[98:99], 65984
s_load_dword s100, s[98:99], 66048
s_load_dword s100, s[98:99], 66112
s_load_dword s100, s[98:99], 66176
v_smfmac_f32_16x16x64_bf16 v[120:123], v[16:19], v[64:71], v20
v_smfmac_f32_16x16x64_bf16 v[124:127], v[16:19], v[72:79], v20
s_setprio 0
s_waitcnt vmcnt(10)
buffer_load_dwordx4 v[36:39], v4, s[16:19], s57 offen offset:0
s_waitcnt vmcnt(10)
buffer_load_dwordx4 v[40:43], v4, s[16:19], s58 offen offset:0
s_waitcnt vmcnt(10)
buffer_load_dwordx4 v[44:47], v4, s[16:19], s59 offen offset:0
s_waitcnt vmcnt(10)
buffer_load_dwordx4 v[48:51], v4, s[16:19], s56 offen offset:2048
s_setprio 2
v_swap_b32 v82, v88
v_swap_b32 v86, v92
v_swap_b32 v83, v89
v_swap_b32 v87, v93
v_cvt_pk_bf16_f32 v144, v112, v120
v_cvt_pk_bf16_f32 v146, v113, v121
v_cvt_pk_bf16_f32 v148, v114, v122
v_cvt_pk_bf16_f32 v150, v115, v123
v_cvt_pk_bf16_f32 v152, v116, v124
v_cvt_pk_bf16_f32 v154, v117, v125
v_cvt_pk_bf16_f32 v156, v118, v126
v_cvt_pk_bf16_f32 v158, v119, v127
v_mov_b64 v[112:113], 0
v_mov_b64 v[114:115], 0
v_mov_b64 v[116:117], 0
v_mov_b64 v[118:119], 0
v_mov_b64 v[120:121], 0
v_mov_b64 v[122:123], 0
v_mov_b64 v[124:125], 0
v_mov_b64 v[126:127], 0
v_smfmac_f32_16x16x64_bf16 v[128:131], v[16:19], v[80:87], v20
v_smfmac_f32_16x16x64_bf16 v[132:135], v[16:19], v[88:95], v20
s_setprio 0
s_waitcnt vmcnt(10)
buffer_load_dwordx4 v[52:55], v4, s[16:19], s57 offen offset:2048
s_waitcnt vmcnt(10)
buffer_load_dwordx4 v[56:59], v4, s[16:19], s58 offen offset:2048
s_waitcnt vmcnt(10)
buffer_load_dwordx4 v[60:63], v4, s[16:19], s59 offen offset:2048
s_waitcnt vmcnt(10)
buffer_load_dwordx4 v[64:67], v4, s[16:19], s60 offen offset:0
s_setprio 2
v_swap_b32 v98, v104
v_swap_b32 v102, v108
v_swap_b32 v99, v105
v_swap_b32 v103, v109
s_nop 1
v_smfmac_f32_16x16x64_bf16 v[136:139], v[16:19], v[96:103], v20
v_smfmac_f32_16x16x64_bf16 v[140:143], v[16:19], v[104:111], v20
s_setprio 0
s_waitcnt vmcnt(10)
buffer_load_dwordx4 v[68:71], v4, s[16:19], s61 offen offset:0
s_waitcnt vmcnt(10)
buffer_load_dwordx4 v[72:75], v4, s[16:19], s62 offen offset:0
s_waitcnt vmcnt(10)
buffer_load_dwordx4 v[76:79], v4, s[16:19], s63 offen offset:0
s_waitcnt vmcnt(10)
buffer_load_dwordx4 v[80:83], v4, s[16:19], s60 offen offset:2048
s_waitcnt vmcnt(10)
buffer_load_dwordx4 v[84:87], v4, s[16:19], s61 offen offset:2048
s_waitcnt vmcnt(10)
buffer_load_dwordx4 v[88:91], v4, s[16:19], s62 offen offset:2048
s_setprio 2
v_swap_b32 v34, v40
v_swap_b32 v38, v44
v_swap_b32 v35, v41
v_swap_b32 v39, v45
v_cvt_pk_bf16_f32 v145, v128, v136
v_cvt_pk_bf16_f32 v147, v129, v137
v_cvt_pk_bf16_f32 v149, v130, v138
v_cvt_pk_bf16_f32 v151, v131, v139
v_cvt_pk_bf16_f32 v153, v132, v140
v_cvt_pk_bf16_f32 v155, v133, v141
v_cvt_pk_bf16_f32 v157, v134, v142
v_cvt_pk_bf16_f32 v159, v135, v143
v_mov_b64 v[128:129], 0
v_mov_b64 v[130:131], 0
v_mov_b64 v[132:133], 0
v_mov_b64 v[134:135], 0
v_mov_b64 v[136:137], 0
v_mov_b64 v[138:139], 0
v_mov_b64 v[140:141], 0
v_mov_b64 v[142:143], 0
v_smfmac_f32_16x16x64_bf16 v[112:115], v[16:19], v[32:39], v20
v_smfmac_f32_16x16x64_bf16 v[116:119], v[16:19], v[40:47], v20
s_mov_b32 s41, 0
L_bw6:
ds_read_b128 v[24:27], v8
s_add_u32 s41, s41, 1
s_waitcnt lgkmcnt(0)
v_min3_u32 v24, v24, v25, v26
v_min_u32 v24, v24, v27
s_cmp_gt_u32 s41, 0x100000
v_readfirstlane_b32 s40, v24
s_cbranch_scc1 L_bd6
s_cmp_ge_u32 s40, 6
s_cbranch_scc1 L_bd6
s_sleep 1
s_branch L_bw6
L_bd6:
ds_write_b64 v5, v[144:145] offset:16384
ds_write_b64 v5, v[146:147] offset:17408
ds_write_b64 v5, v[148:149] offset:18432
ds_write_b64 v5, v[150:151] offset:19456
ds_write_b64 v5, v[152:153] offset:16400
ds_write_b64 v5, v[154:155] offset:17424
ds_write_b64 v5, v[156:157] offset:18448
ds_write_b64 v5, v[158:159] offset:19472
s_mov_b64 exec, 15
ds_add_u32 v9, v11 offset:16
s_mov_b64 exec, -1
s_setprio 0
s_waitcnt vmcnt(10)
buffer_load_dwordx4 v[92:95], v4, s[16:19], s63 offen offset:2048
v_add_u32 v4, 0x10000, v4
s_cmp_eq_u32 s89, 10
s_cselect_b32 s22, 15728640, 0
buffer_load_dword v15, v14, s[20:23], s88 offen
s_waitcnt vmcnt(10)
buffer_load_dwordx4 v[96:99], v4, s[16:19], s56 offen offset:0
s_waitcnt vmcnt(10)
buffer_load_dwordx4 v[100:103], v4, s[16:19], s57 offen offset:0
s_setprio 2
v_swap_b32 v50, v56
v_swap_b32 v54, v60
v_swap_b32 v51, v57
v_swap_b32 v55, v61
s_nop 1
v_smfmac_f32_16x16x64_bf16 v[120:123], v[16:19], v[48:55], v20
v_smfmac_f32_16x16x64_bf16 v[124:127], v[16:19], v[56:63], v20
s_setprio 0
s_waitcnt vmcnt(10)
buffer_load_dwordx4 v[104:107], v4, s[16:19], s58 offen offset:0
s_waitcnt vmcnt(10)
buffer_load_dwordx4 v[108:111], v4, s[16:19], s59 offen offset:0
s_waitcnt vmcnt(10)
buffer_load_dwordx4 v[32:35], v4, s[16:19], s56 offen offset:2048
s_waitcnt vmcnt(10)
buffer_load_dwordx4 v[36:39], v4, s[16:19], s57 offen offset:2048
s_setprio 2
v_swap_b32 v66, v72
v_swap_b32 v70, v76
v_swap_b32 v67, v73
v_swap_b32 v71, v77
v_cvt_pk_bf16_f32 v144, v112, v120
v_cvt_pk_bf16_f32 v146, v113, v121
v_cvt_pk_bf16_f32 v148, v114, v122
v_cvt_pk_bf16_f32 v150, v115, v123
v_cvt_pk_bf16_f32 v152, v116, v124
v_cvt_pk_bf16_f32 v154, v117, v125
v_cvt_pk_bf16_f32 v156, v118, v126
v_cvt_pk_bf16_f32 v158, v119, v127
v_mov_b64 v[112:113], 0
v_mov_b64 v[114:115], 0
v_mov_b64 v[116:117], 0
v_mov_b64 v[118:119], 0
v_mov_b64 v[120:121], 0
v_mov_b64 v[122:123], 0
v_mov_b64 v[124:125], 0
v_mov_b64 v[126:127], 0
v_smfmac_f32_16x16x64_bf16 v[128:131], v[16:19], v[64:71], v20
v_smfmac_f32_16x16x64_bf16 v[132:135], v[16:19], v[72:79], v20
s_setprio 0
s_waitcnt vmcnt(10)
buffer_load_dwordx4 v[40:43], v4, s[16:19], s58 offen offset:2048
s_waitcnt vmcnt(10)
buffer_load_dwordx4 v[44:47], v4, s[16:19], s59 offen offset:2048
s_waitcnt vmcnt(10)
buffer_load_dwordx4 v[48:51], v4, s[16:19], s60 offen offset:0
s_waitcnt vmcnt(10)
buffer_load_dwordx4 v[52:55], v4, s[16:19], s61 offen offset:0
s_setprio 2
v_swap_b32 v82, v88
v_swap_b32 v86, v92
v_swap_b32 v83, v89
v_swap_b32 v87, v93
s_nop 1
v_smfmac_f32_16x16x64_bf16 v[136:139], v[16:19], v[80:87], v20
v_smfmac_f32_16x16x64_bf16 v[140:143], v[16:19], v[88:95], v20
s_setprio 0
s_waitcnt vmcnt(10)
buffer_load_dwordx4 v[56:59], v4, s[16:19], s62 offen offset:0
s_waitcnt vmcnt(10)
buffer_load_dwordx4 v[60:63], v4, s[16:19], s63 offen offset:0
s_waitcnt vmcnt(10)
buffer_load_dwordx4 v[64:67], v4, s[16:19], s60 offen offset:2048
s_waitcnt vmcnt(10)
buffer_load_dwordx4 v[68:71], v4, s[16:19], s61 offen offset:2048
s_waitcnt vmcnt(10)
buffer_load_dwordx4 v[72:75], v4, s[16:19], s62 offen offset:2048
s_setprio 2
v_swap_b32 v98, v104
v_swap_b32 v102, v108
v_swap_b32 v99, v105
v_swap_b32 v103, v109
v_cvt_pk_bf16_f32 v145, v128, v136
v_cvt_pk_bf16_f32 v147, v129, v137
v_cvt_pk_bf16_f32 v149, v130, v138
v_cvt_pk_bf16_f32 v151, v131, v139
v_cvt_pk_bf16_f32 v153, v132, v140
v_cvt_pk_bf16_f32 v155, v133, v141
v_cvt_pk_bf16_f32 v157, v134, v142
v_cvt_pk_bf16_f32 v159, v135, v143
v_mov_b64 v[128:129], 0
v_mov_b64 v[130:131], 0
v_mov_b64 v[132:133], 0
v_mov_b64 v[134:135], 0
v_mov_b64 v[136:137], 0
v_mov_b64 v[138:139], 0
v_mov_b64 v[140:141], 0
v_mov_b64 v[142:143], 0
v_smfmac_f32_16x16x64_bf16 v[112:115], v[16:19], v[96:103], v20
v_smfmac_f32_16x16x64_bf16 v[116:119], v[16:19], v[104:111], v20
s_mov_b32 s41, 0
L_bw7:
ds_read_b128 v[24:27], v8
s_add_u32 s41, s41, 1
s_waitcnt lgkmcnt(0)
v_min3_u32 v24, v24, v25, v26
v_min_u32 v24, v24, v27
s_cmp_gt_u32 s41, 0x100000
v_readfirstlane_b32 s40, v24
s_cbranch_scc1 L_bd7
s_cmp_ge_u32 s40, 7
s_cbranch_scc1 L_bd7
s_sleep 1
s_branch L_bw7
L_bd7:
ds_write_b64 v5, v[144:145] offset:32768
ds_write_b64 v5, v[146:147] offset:33792
ds_write_b64 v5, v[148:149] offset:34816
ds_write_b64 v5, v[150:151] offset:35840
ds_write_b64 v5, v[152:153] offset:32784
ds_write_b64 v5, v[154:155] offset:33808
ds_write_b64 v5, v[156:157] offset:34832
ds_write_b64 v5, v[158:159] offset:35856
s_mov_b64 exec, 15
ds_add_u32 v9, v11 offset:16
s_mov_b64 exec, -1
s_setprio 0
s_waitcnt vmcnt(10)
buffer_load_dwordx4 v[76:79], v4, s[16:19], s63 offen offset:2048
v_add_u32 v4, 0x10000, v4
s_waitcnt vmcnt(10)
buffer_load_dwordx4 v[80:83], v4, s[16:19], s56 offen offset:0
s_waitcnt vmcnt(10)
buffer_load_dwordx4 v[84:87], v4, s[16:19], s57 offen offset:0
s_waitcnt vmcnt(10)
buffer_load_dwordx4 v[88:91], v4, s[16:19], s58 offen offset:0
s_setprio 2
v_swap_b32 v34, v40
v_swap_b32 v38, v44
v_swap_b32 v35, v41
v_swap_b32 v39, v45
s_nop 1
v_smfmac_f32_16x16x64_bf16 v[120:123], v[16:19], v[32:39], v20
v_smfmac_f32_16x16x64_bf16 v[124:127], v[16:19], v[40:47], v20
s_setprio 0
s_waitcnt vmcnt(10)
buffer_load_dwordx4 v[92:95], v4, s[16:19], s59 offen offset:0
s_waitcnt vmcnt(10)
buffer_load_dwordx4 v[96:99], v4, s[16:19], s56 offen offset:2048
s_waitcnt vmcnt(10)
buffer_load_dwordx4 v[100:103], v4, s[16:19], s57 offen offset:2048
s_waitcnt vmcnt(10)
buffer_load_dwordx4 v[104:107], v4, s[16:19], s58 offen offset:2048
s_setprio 2
v_swap_b32 v50, v56
v_swap_b32 v54, v60
v_swap_b32 v51, v57
v_swap_b32 v55, v61
v_cvt_pk_bf16_f32 v144, v112, v120
v_cvt_pk_bf16_f32 v146, v113, v121
v_cvt_pk_bf16_f32 v148, v114, v122
v_cvt_pk_bf16_f32 v150, v115, v123
v_cvt_pk_bf16_f32 v152, v116, v124
v_cvt_pk_bf16_f32 v154, v117, v125
v_cvt_pk_bf16_f32 v156, v118, v126
v_cvt_pk_bf16_f32 v158, v119, v127
v_mov_b64 v[112:113], 0
v_mov_b64 v[114:115], 0
v_mov_b64 v[116:117], 0
v_mov_b64 v[118:119], 0
v_mov_b64 v[120:121], 0
v_mov_b64 v[122:123], 0
v_mov_b64 v[124:125], 0
v_mov_b64 v[126:127], 0
v_smfmac_f32_16x16x64_bf16 v[128:131], v[16:19], v[48:55], v20
v_smfmac_f32_16x16x64_bf16 v[132:135], v[16:19], v[56:63], v20
s_setprio 0
s_waitcnt vmcnt(10)
buffer_load_dwordx4 v[108:111], v4, s[16:19], s59 offen offset:2048
s_waitcnt vmcnt(10)
buffer_load_dwordx4 v[32:35], v4, s[16:19], s60 offen offset:0
s_waitcnt vmcnt(10)
buffer_load_dwordx4 v[36:39], v4, s[16:19], s61 offen offset:0
s_waitcnt vmcnt(10)
buffer_load_dwordx4 v[40:43], v4, s[16:19], s62 offen offset:0
s_setprio 2
v_swap_b32 v66, v72
v_swap_b32 v70, v76
v_swap_b32 v67, v73
v_swap_b32 v71, v77
s_nop 1
v_smfmac_f32_16x16x64_bf16 v[136:139], v[16:19], v[64:71], v20
v_smfmac_f32_16x16x64_bf16 v[140:143], v[16:19], v[72:79], v20
s_setprio 0
s_waitcnt vmcnt(10)
buffer_load_dwordx4 v[44:47], v4, s[16:19], s63 offen offset:0
s_waitcnt vmcnt(10)
buffer_load_dwordx4 v[48:51], v4, s[16:19], s60 offen offset:2048
s_waitcnt vmcnt(10)
buffer_load_dwordx4 v[52:55], v4, s[16:19], s61 offen offset:2048
s_waitcnt vmcnt(10)
buffer_load_dwordx4 v[56:59], v4, s[16:19], s62 offen offset:2048
s_setprio 2
v_swap_b32 v82, v88
v_swap_b32 v86, v92
v_swap_b32 v83, v89
v_swap_b32 v87, v93
v_cvt_pk_bf16_f32 v145, v128, v136
v_cvt_pk_bf16_f32 v147, v129, v137
v_cvt_pk_bf16_f32 v149, v130, v138
v_cvt_pk_bf16_f32 v151, v131, v139
v_cvt_pk_bf16_f32 v153, v132, v140
v_cvt_pk_bf16_f32 v155, v133, v141
v_cvt_pk_bf16_f32 v157, v134, v142
v_cvt_pk_bf16_f32 v159, v135, v143
v_mov_b64 v[128:129], 0
v_mov_b64 v[130:131], 0
v_mov_b64 v[132:133], 0
v_mov_b64 v[134:135], 0
v_mov_b64 v[136:137], 0
v_mov_b64 v[138:139], 0
v_mov_b64 v[140:141], 0
v_mov_b64 v[142:143], 0
v_smfmac_f32_16x16x64_bf16 v[112:115], v[16:19], v[80:87], v20
v_smfmac_f32_16x16x64_bf16 v[116:119], v[16:19], v[88:95], v20
s_mov_b32 s41, 0
L_bw8:
ds_read_b128 v[24:27], v8
s_add_u32 s41, s41, 1
s_waitcnt lgkmcnt(0)
v_min3_u32 v24, v24, v25, v26
v_min_u32 v24, v24, v27
s_cmp_gt_u32 s41, 0x100000
v_readfirstlane_b32 s40, v24
s_cbranch_scc1 L_bd8
s_cmp_ge_u32 s40, 8
s_cbranch_scc1 L_bd8
s_sleep 1
s_branch L_bw8
L_bd8:
ds_write_b64 v5, v[144:145] offset:49152
ds_write_b64 v5, v[146:147] offset:50176
ds_write_b64 v5, v[148:149] offset:51200
ds_write_b64 v5, v[150:151] offset:52224
ds_write_b64 v5, v[152:153] offset:49168
ds_write_b64 v5, v[154:155] offset:50192
ds_write_b64 v5, v[156:157] offset:51216
ds_write_b64 v5, v[158:159] offset:52240
s_mov_b64 exec, 15
ds_add_u32 v9, v11 offset:16
s_mov_b64 exec, -1
s_setprio 0
s_waitcnt vmcnt(10)
buffer_load_dwordx4 v[60:63], v4, s[16:19], s63 offen offset:2048
v_add_u32 v4, 0x10000, v4
s_waitcnt vmcnt(10)
buffer_load_dwordx4 v[64:67], v4, s[16:19], s56 offen offset:0
s_waitcnt vmcnt(10)
buffer_load_dwordx4 v[68:71], v4, s[16:19], s57 offen offset:0
s_waitcnt vmcnt(10)
buffer_load_dwordx4 v[72:75], v4, s[16:19], s58 offen offset:0
s_setprio 2
v_swap_b32 v98, v104
v_swap_b32 v102, v108
v_swap_b32 v99, v105
v_swap_b32 v103, v109
s_nop 1
v_smfmac_f32_16x16x64_bf16 v[120:123], v[16:19], v[96:103], v20
v_smfmac_f32_16x16x64_bf16 v[124:127], v[16:19], v[104:111], v20
s_setprio 0
s_waitcnt vmcnt(10)
buffer_load_dwordx4 v[76:79], v4, s[16:19], s59 offen offset:0
s_waitcnt vmcnt(10)
buffer_load_dwordx4 v[80:83], v4, s[16:19], s56 offen offset:2048
s_waitcnt vmcnt(10)
buffer_load_dwordx4 v[84:87], v4, s[16:19], s57 offen offset:2048
s_waitcnt vmcnt(10)
buffer_load_dwordx4 v[88:91], v4, s[16:19], s58 offen offset:2048
s_setprio 2
v_swap_b32 v34, v40
v_swap_b32 v38, v44
v_swap_b32 v35, v41
v_swap_b32 v39, v45
v_cvt_pk_bf16_f32 v144, v112, v120
v_cvt_pk_bf16_f32 v146, v113, v121
v_cvt_pk_bf16_f32 v148, v114, v122
v_cvt_pk_bf16_f32 v150, v115, v123
v_cvt_pk_bf16_f32 v152, v116, v124
v_cvt_pk_bf16_f32 v154, v117, v125
v_cvt_pk_bf16_f32 v156, v118, v126
v_cvt_pk_bf16_f32 v158, v119, v127
v_mov_b64 v[112:113], 0
v_mov_b64 v[114:115], 0
v_mov_b64 v[116:117], 0
v_mov_b64 v[118:119], 0
v_mov_b64 v[120:121], 0
v_mov_b64 v[122:123], 0
v_mov_b64 v[124:125], 0
v_mov_b64 v[126:127], 0
v_smfmac_f32_16x16x64_bf16 v[128:131], v[16:19], v[32:39], v20
v_smfmac_f32_16x16x64_bf16 v[132:135], v[16:19], v[40:47], v20
s_setprio 0
s_waitcnt vmcnt(10)
buffer_load_dwordx4 v[92:95], v4, s[16:19], s59 offen offset:2048
s_waitcnt vmcnt(10)
buffer_load_dwordx4 v[96:99], v4, s[16:19], s60 offen offset:0
s_waitcnt vmcnt(10)
buffer_load_dwordx4 v[100:103], v4, s[16:19], s61 offen offset:0
s_waitcnt vmcnt(10)
buffer_load_dwordx4 v[104:107], v4, s[16:19], s62 offen offset:0
s_setprio 2
v_swap_b32 v50, v56
v_swap_b32 v54, v60
v_swap_b32 v51, v57
v_swap_b32 v55, v61
s_nop 1
v_smfmac_f32_16x16x64_bf16 v[136:139], v[16:19], v[48:55], v20
v_smfmac_f32_16x16x64_bf16 v[140:143], v[16:19], v[56:63], v20
s_setprio 0
s_waitcnt vmcnt(10)
buffer_load_dwordx4 v[108:111], v4, s[16:19], s63 offen offset:0
s_waitcnt vmcnt(10)
buffer_load_dwordx4 v[32:35], v4, s[16:19], s60 offen offset:2048
s_waitcnt vmcnt(10)
buffer_load_dwordx4 v[36:39], v4, s[16:19], s61 offen offset:2048
s_waitcnt vmcnt(10)
buffer_load_dwordx4 v[40:43], v4, s[16:19], s62 offen offset:2048
s_setprio 2
v_swap_b32 v66, v72
v_swap_b32 v70, v76
v_swap_b32 v67, v73
v_swap_b32 v71, v77
v_cvt_pk_bf16_f32 v145, v128, v136
v_cvt_pk_bf16_f32 v147, v129, v137
v_cvt_pk_bf16_f32 v149, v130, v138
v_cvt_pk_bf16_f32 v151, v131, v139
v_cvt_pk_bf16_f32 v153, v132, v140
v_cvt_pk_bf16_f32 v155, v133, v141
v_cvt_pk_bf16_f32 v157, v134, v142
v_cvt_pk_bf16_f32 v159, v135, v143
v_mov_b64 v[128:129], 0
v_mov_b64 v[130:131], 0
v_mov_b64 v[132:133], 0
v_mov_b64 v[134:135], 0
v_mov_b64 v[136:137], 0
v_mov_b64 v[138:139], 0
v_mov_b64 v[140:141], 0
v_mov_b64 v[142:143], 0
v_smfmac_f32_16x16x64_bf16 v[112:115], v[16:19], v[64:71], v20
v_smfmac_f32_16x16x64_bf16 v[116:119], v[16:19], v[72:79], v20
s_mov_b32 s41, 0
L_bw10:
ds_read_b128 v[24:27], v8
s_add_u32 s41, s41, 1
s_waitcnt lgkmcnt(0)
v_min3_u32 v24, v24, v25, v26
v_min_u32 v24, v24, v27
s_cmp_gt_u32 s41, 0x100000
v_readfirstlane_b32 s40, v24
s_cbranch_scc1 L_bd10
s_cmp_ge_u32 s40, 10
s_cbranch_scc1 L_bd10
s_sleep 1
s_branch L_bw10
L_bd10:
ds_write_b64 v6, v[144:145] offset:0
ds_write_b64 v6, v[146:147] offset:1024
ds_write_b64 v6, v[148:149] offset:2048
ds_write_b64 v6, v[150:151] offset:3072
ds_write_b64 v6, v[152:153] offset:16
ds_write_b64 v6, v[154:155] offset:1040
ds_write_b64 v6, v[156:157] offset:2064
ds_write_b64 v6, v[158:159] offset:3088
s_mov_b64 exec, 15
ds_add_u32 v9, v11 offset:16
s_mov_b64 exec, -1
s_setprio 0
s_waitcnt vmcnt(10)
buffer_load_dwordx4 v[44:47], v4, s[16:19], s63 offen offset:2048
v_add_u32 v4, 0x10000, v4
s_waitcnt vmcnt(10)
buffer_load_dwordx4 v[48:51], v4, s[16:19], s56 offen offset:0
s_waitcnt vmcnt(10)
buffer_load_dwordx4 v[52:55], v4, s[16:19], s57 offen offset:0
s_waitcnt vmcnt(10)
buffer_load_dwordx4 v[56:59], v4, s[16:19], s58 offen offset:0
s_setprio 2
v_swap_b32 v82, v88
v_swap_b32 v86, v92
v_swap_b32 v83, v89
v_swap_b32 v87, v93
s_nop 1
v_smfmac_f32_16x16x64_bf16 v[120:123], v[16:19], v[80:87], v20
v_smfmac_f32_16x16x64_bf16 v[124:127], v[16:19], v[88:95], v20
s_setprio 0
s_waitcnt vmcnt(10)
buffer_load_dwordx4 v[60:63], v4, s[16:19], s59 offen offset:0
s_waitcnt vmcnt(10)
buffer_load_dwordx4 v[64:67], v4, s[16:19], s56 offen offset:2048
s_waitcnt vmcnt(10)
buffer_load_dwordx4 v[68:71], v4, s[16:19], s57 offen offset:2048
s_waitcnt vmcnt(10)
buffer_load_dwordx4 v[72:75], v4, s[16:19], s58 offen offset:2048
s_setprio 2
v_swap_b32 v98, v104
v_swap_b32 v102, v108
v_swap_b32 v99, v105
v_swap_b32 v103, v109
v_cvt_pk_bf16_f32 v144, v112, v120
v_cvt_pk_bf16_f32 v146, v113, v121
v_cvt_pk_bf16_f32 v148, v114, v122
v_cvt_pk_bf16_f32 v150, v115, v123
v_cvt_pk_bf16_f32 v152, v116, v124
v_cvt_pk_bf16_f32 v154, v117, v125
v_cvt_pk_bf16_f32 v156, v118, v126
v_cvt_pk_bf16_f32 v158, v119, v127
v_mov_b64 v[112:113], 0
v_mov_b64 v[114:115], 0
v_mov_b64 v[116:117], 0
v_mov_b64 v[118:119], 0
v_mov_b64 v[120:121], 0
v_mov_b64 v[122:123], 0
v_mov_b64 v[124:125], 0
v_mov_b64 v[126:127], 0
v_smfmac_f32_16x16x64_bf16 v[128:131], v[16:19], v[96:103], v20
v_smfmac_f32_16x16x64_bf16 v[132:135], v[16:19], v[104:111], v20
s_setprio 0
s_waitcnt vmcnt(10)
buffer_load_dwordx4 v[76:79], v4, s[16:19], s59 offen offset:2048
s_waitcnt vmcnt(10)
buffer_load_dwordx4 v[80:83], v4, s[16:19], s60 offen offset:0
s_waitcnt vmcnt(10)
buffer_load_dwordx4 v[84:87], v4, s[16:19], s61 offen offset:0
s_waitcnt vmcnt(10)
buffer_load_dwordx4 v[88:91], v4, s[16:19], s62 offen offset:0
s_setprio 2
v_swap_b32 v34, v40
v_swap_b32 v38, v44
v_swap_b32 v35, v41
v_swap_b32 v39, v45
s_nop 1
v_smfmac_f32_16x16x64_bf16 v[136:139], v[16:19], v[32:39], v20
v_smfmac_f32_16x16x64_bf16 v[140:143], v[16:19], v[40:47], v20
s_setprio 0
s_waitcnt vmcnt(10)
buffer_load_dwordx4 v[92:95], v4, s[16:19], s63 offen offset:0
s_waitcnt vmcnt(10)
buffer_load_dwordx4 v[96:99], v4, s[16:19], s60 offen offset:2048
s_waitcnt vmcnt(10)
buffer_load_dwordx4 v[100:103], v4, s[16:19], s61 offen offset:2048
s_waitcnt vmcnt(10)
buffer_load_dwordx4 v[104:107], v4, s[16:19], s62 offen offset:2048
s_setprio 2
v_swap_b32 v50, v56
v_swap_b32 v54, v60
v_swap_b32 v51, v57
v_swap_b32 v55, v61
v_cvt_pk_bf16_f32 v145, v128, v136
v_cvt_pk_bf16_f32 v147, v129, v137
v_cvt_pk_bf16_f32 v149, v130, v138
v_cvt_pk_bf16_f32 v151, v131, v139
v_cvt_pk_bf16_f32 v153, v132, v140
v_cvt_pk_bf16_f32 v155, v133, v141
v_cvt_pk_bf16_f32 v157, v134, v142
v_cvt_pk_bf16_f32 v159, v135, v143
v_mov_b64 v[128:129], 0
v_mov_b64 v[130:131], 0
v_mov_b64 v[132:133], 0
v_mov_b64 v[134:135], 0
v_mov_b64 v[136:137], 0
v_mov_b64 v[138:139], 0
v_mov_b64 v[140:141], 0
v_mov_b64 v[142:143], 0
v_smfmac_f32_16x16x64_bf16 v[112:115], v[16:19], v[48:55], v20
v_smfmac_f32_16x16x64_bf16 v[116:119], v[16:19], v[56:63], v20
s_mov_b32 s41, 0
L_bw11:
ds_read_b128 v[24:27], v8
s_add_u32 s41, s41, 1
s_waitcnt lgkmcnt(0)
v_min3_u32 v24, v24, v25, v26
v_min_u32 v24, v24, v27
s_cmp_gt_u32 s41, 0x100000
v_readfirstlane_b32 s40, v24
s_cbranch_scc1 L_bd11
s_cmp_ge_u32 s40, 11
s_cbranch_scc1 L_bd11
s_sleep 1
s_branch L_bw11
L_bd11:
ds_write_b64 v6, v[144:145] offset:16384
ds_write_b64 v6, v[146:147] offset:17408
ds_write_b64 v6, v[148:149] offset:18432
ds_write_b64 v6, v[150:151] offset:19456
ds_write_b64 v6, v[152:153] offset:16400
ds_write_b64 v6, v[154:155] offset:17424
ds_write_b64 v6, v[156:157] offset:18448
ds_write_b64 v6, v[158:159] offset:19472
s_mov_b64 exec, 15
ds_add_u32 v9, v11 offset:16
s_mov_b64 exec, -1
s_setprio 0
s_waitcnt vmcnt(10)
buffer_load_dwordx4 v[108:111], v4, s[16:19], s63 offen offset:2048
v_add_u32 v4, 0x10000, v4
s_waitcnt vmcnt(10)
buffer_load_dwordx4 v[32:35], v4, s[16:19], s56 offen offset:0
s_waitcnt vmcnt(10)
buffer_load_dwordx4 v[36:39], v4, s[16:19], s57 offen offset:0
s_waitcnt vmcnt(10)
buffer_load_dwordx4 v[40:43], v4, s[16:19], s58 offen offset:0
s_setprio 2
v_swap_b32 v66, v72
v_swap_b32 v70, v76
v_swap_b32 v67, v73
v_swap_b32 v71, v77
s_nop 1
v_smfmac_f32_16x16x64_bf16 v[120:123], v[16:19], v[64:71], v20
v_smfmac_f32_16x16x64_bf16 v[124:127], v[16:19], v[72:79], v20
s_setprio 0
s_waitcnt vmcnt(10)
buffer_load_dwordx4 v[44:47], v4, s[16:19], s59 offen offset:0
s_waitcnt vmcnt(10)
buffer_load_dwordx4 v[48:51], v4, s[16:19], s56 offen offset:2048
s_waitcnt vmcnt(10)
buffer_load_dwordx4 v[52:55], v4, s[16:19], s57 offen offset:2048
s_waitcnt vmcnt(10)
buffer_load_dwordx4 v[56:59], v4, s[16:19], s58 offen offset:2048
s_setprio 2
v_swap_b32 v82, v88
v_swap_b32 v86, v92
v_swap_b32 v83, v89
v_swap_b32 v87, v93
v_cvt_pk_bf16_f32 v144, v112, v120
v_cvt_pk_bf16_f32 v146, v113, v121
v_cvt_pk_bf16_f32 v148, v114, v122
v_cvt_pk_bf16_f32 v150, v115, v123
v_cvt_pk_bf16_f32 v152, v116, v124
v_cvt_pk_bf16_f32 v154, v117, v125
v_cvt_pk_bf16_f32 v156, v118, v126
v_cvt_pk_bf16_f32 v158, v119, v127
v_mov_b64 v[112:113], 0
v_mov_b64 v[114:115], 0
v_mov_b64 v[116:117], 0
v_mov_b64 v[118:119], 0
v_mov_b64 v[120:121], 0
v_mov_b64 v[122:123], 0
v_mov_b64 v[124:125], 0
v_mov_b64 v[126:127], 0
v_smfmac_f32_16x16x64_bf16 v[128:131], v[16:19], v[80:87], v20
v_smfmac_f32_16x16x64_bf16 v[132:135], v[16:19], v[88:95], v20
s_setprio 0
s_waitcnt vmcnt(10)
buffer_load_dwordx4 v[60:63], v4, s[16:19], s59 offen offset:2048
s_waitcnt vmcnt(10)
buffer_load_dwordx4 v[64:67], v4, s[16:19], s60 offen offset:0
s_waitcnt vmcnt(10)
buffer_load_dwordx4 v[68:71], v4, s[16:19], s61 offen offset:0
s_waitcnt vmcnt(10)
buffer_load_dwordx4 v[72:75], v4, s[16:19], s62 offen offset:0
s_setprio 2
v_swap_b32 v98, v104
v_swap_b32 v102, v108
v_swap_b32 v99, v105
v_swap_b32 v103, v109
s_nop 1
v_smfmac_f32_16x16x64_bf16 v[136:139], v[16:19], v[96:103], v20
v_smfmac_f32_16x16x64_bf16 v[140:143], v[16:19], v[104:111], v20
s_setprio 0
s_waitcnt vmcnt(10)
buffer_load_dwordx4 v[76:79], v4, s[16:19], s63 offen offset:0
s_waitcnt vmcnt(10)
buffer_load_dwordx4 v[80:83], v4, s[16:19], s60 offen offset:2048
s_waitcnt vmcnt(10)
buffer_load_dwordx4 v[84:87], v4, s[16:19], s61 offen offset:2048
s_waitcnt vmcnt(10)
buffer_load_dwordx4 v[88:91], v4, s[16:19], s62 offen offset:2048
s_setprio 2
v_swap_b32 v34, v40
v_swap_b32 v38, v44
v_swap_b32 v35, v41
v_swap_b32 v39, v45
v_cvt_pk_bf16_f32 v145, v128, v136
v_cvt_pk_bf16_f32 v147, v129, v137
v_cvt_pk_bf16_f32 v149, v130, v138
v_cvt_pk_bf16_f32 v151, v131, v139
v_cvt_pk_bf16_f32 v153, v132, v140
v_cvt_pk_bf16_f32 v155, v133, v141
v_cvt_pk_bf16_f32 v157, v134, v142
v_cvt_pk_bf16_f32 v159, v135, v143
v_mov_b64 v[128:129], 0
v_mov_b64 v[130:131], 0
v_mov_b64 v[132:133], 0
v_mov_b64 v[134:135], 0
v_mov_b64 v[136:137], 0
v_mov_b64 v[138:139], 0
v_mov_b64 v[140:141], 0
v_mov_b64 v[142:143], 0
v_smfmac_f32_16x16x64_bf16 v[112:115], v[16:19], v[32:39], v20
v_smfmac_f32_16x16x64_bf16 v[116:119], v[16:19], v[40:47], v20
s_mov_b32 s41, 0
L_bw12:
ds_read_b128 v[24:27], v8
s_add_u32 s41, s41, 1
s_waitcnt lgkmcnt(0)
v_min3_u32 v24, v24, v25, v26
v_min_u32 v24, v24, v27
s_cmp_gt_u32 s41, 0x100000
v_readfirstlane_b32 s40, v24
s_cbranch_scc1 L_bd12
s_cmp_ge_u32 s40, 12
s_cbranch_scc1 L_bd12
s_sleep 1
s_branch L_bw12
L_bd12:
ds_write_b64 v6, v[144:145] offset:32768
ds_write_b64 v6, v[146:147] offset:33792
ds_write_b64 v6, v[148:149] offset:34816
ds_write_b64 v6, v[150:151] offset:35840
ds_write_b64 v6, v[152:153] offset:32784
ds_write_b64 v6, v[154:155] offset:33808
ds_write_b64 v6, v[156:157] offset:34832
ds_write_b64 v6, v[158:159] offset:35856
s_mov_b64 exec, 15
ds_add_u32 v9, v11 offset:16
s_mov_b64 exec, -1
s_setprio 0
s_waitcnt vmcnt(10)
buffer_load_dwordx4 v[92:95], v4, s[16:19], s63 offen offset:2048
v_add_u32 v4, 0x10000, v4
s_setprio 2
buffer_load_dword v10, v0, s[24:27], 0 offen sc1
s_waitcnt vmcnt(9)
v_swap_b32 v50, v56
v_swap_b32 v54, v60
v_swap_b32 v51, v57
v_swap_b32 v55, v61
s_nop 1
v_smfmac_f32_16x16x64_bf16 v[120:123], v[16:19], v[48:55], v20
v_smfmac_f32_16x16x64_bf16 v[124:127], v[16:19], v[56:63], v20
s_waitcnt vmcnt(5)
v_swap_b32 v66, v72
v_swap_b32 v70, v76
v_swap_b32 v67, v73
v_swap_b32 v71, v77
s_nop 2
v_cvt_pk_bf16_f32 v144, v112, v120
v_cvt_pk_bf16_f32 v146, v113, v121
v_cvt_pk_bf16_f32 v148, v114, v122
v_cvt_pk_bf16_f32 v150, v115, v123
v_cvt_pk_bf16_f32 v152, v116, v124
v_cvt_pk_bf16_f32 v154, v117, v125
v_cvt_pk_bf16_f32 v156, v118, v126
v_cvt_pk_bf16_f32 v158, v119, v127
v_mov_b64 v[112:113], 0
v_mov_b64 v[114:115], 0
v_mov_b64 v[116:117], 0
v_mov_b64 v[118:119], 0
v_mov_b64 v[120:121], 0
v_mov_b64 v[122:123], 0
v_mov_b64 v[124:125], 0
v_mov_b64 v[126:127], 0
v_smfmac_f32_16x16x64_bf16 v[128:131], v[16:19], v[64:71], v20
v_smfmac_f32_16x16x64_bf16 v[132:135], v[16:19], v[72:79], v20
s_waitcnt vmcnt(1)
v_swap_b32 v82, v88
v_swap_b32 v86, v92
v_swap_b32 v83, v89
v_swap_b32 v87, v93
s_nop 1
v_smfmac_f32_16x16x64_bf16 v[136:139], v[16:19], v[80:87], v20
v_smfmac_f32_16x16x64_bf16 v[140:143], v[16:19], v[88:95], v20
s_nop 7
v_cvt_pk_bf16_f32 v145, v128, v136
v_cvt_pk_bf16_f32 v147, v129, v137
v_cvt_pk_bf16_f32 v149, v130, v138
v_cvt_pk_bf16_f32 v151, v131, v139
v_cvt_pk_bf16_f32 v153, v132, v140
v_cvt_pk_bf16_f32 v155, v133, v141
v_cvt_pk_bf16_f32 v157, v134, v142
v_cvt_pk_bf16_f32 v159, v135, v143
v_mov_b64 v[128:129], 0
v_mov_b64 v[130:131], 0
v_mov_b64 v[132:133], 0
v_mov_b64 v[134:135], 0
v_mov_b64 v[136:137], 0
v_mov_b64 v[138:139], 0
v_mov_b64 v[140:141], 0
v_mov_b64 v[142:143], 0
s_mov_b32 s41, 0
L_bw13:
ds_read_b128 v[24:27], v8
s_add_u32 s41, s41, 1
s_waitcnt lgkmcnt(0)
v_min3_u32 v24, v24, v25, v26
v_min_u32 v24, v24, v27
s_cmp_gt_u32 s41, 0x100000
v_readfirstlane_b32 s40, v24
s_cbranch_scc1 L_bd13
s_cmp_ge_u32 s40, 13
s_cbranch_scc1 L_bd13
s_sleep 1
s_branch L_bw13
L_bd13:
ds_write_b64 v6, v[144:145] offset:49152
ds_write_b64 v6, v[146:147] offset:50176
ds_write_b64 v6, v[148:149] offset:51200
ds_write_b64 v6, v[150:151] offset:52224
ds_write_b64 v6, v[152:153] offset:49168
ds_write_b64 v6, v[154:155] offset:50192
ds_write_b64 v6, v[156:157] offset:51216
ds_write_b64 v6, v[158:159] offset:52240
s_mov_b64 exec, 15
ds_add_u32 v9, v11 offset:16
s_mov_b64 exec, -1
s_cmp_lg_u32 s32, 0
s_cbranch_scc1 L_noipf
s_cmp_lt_u32 s2, 240
s_cbranch_scc1 L_noipf
s_getpc_b64 s[44:45]
L_pcb:
s_add_u32 s44, s44, L_epi-L_pcb
s_addc_u32 s45, s45, (L_epi-L_pcb)>>32
v_lshlrev_b32 v28, 7, v1
v_add_u32 v28, 0, v28
v_min_u32 v28, L_B-L_epi-4, v28
v_mov_b32 v29, s45
v_add_co_u32 v28, vcc, s44, v28
s_nop 1
v_addc_co_u32 v29, vcc, 0, v29, vcc
global_load_dword v30, v[28:29], off
v_lshlrev_b32 v28, 7, v1
v_add_u32 v28, 8192, v28
v_min_u32 v28, L_B-L_epi-4, v28
v_mov_b32 v29, s45
v_add_co_u32 v28, vcc, s44, v28
s_nop 1
v_addc_co_u32 v29, vcc, 0, v29, vcc
global_load_dword v30, v[28:29], off
s_getpc_b64 s[44:45]
L_pcc:
s_add_u32 s44, s44, L_noipf-L_pcc
s_addc_u32 s45, s45, (L_noipf-L_pcc)>>32
v_lshlrev_b32 v28, 7, v1
v_add_u32 v28, 0, v28
v_min_u32 v28, L_end-L_noipf-4, v28
v_mov_b32 v29, s45
v_add_co_u32 v28, vcc, s44, v28
s_nop 1
v_addc_co_u32 v29, vcc, 0, v29, vcc
global_load_dword v30, v[28:29], off
v_lshlrev_b32 v28, 7, v1
v_add_u32 v28, 8192, v28
v_min_u32 v28, L_end-L_noipf-4, v28
v_mov_b32 v29, s45
v_add_co_u32 v28, vcc, s44, v28
s_nop 1
v_addc_co_u32 v29, vcc, 0, v29, vcc
global_load_dword v30, v[28:29], off
L_noipf:
s_cmp_ge_u32 s38, 160
s_cbranch_scc0 L_pk3
s_waitcnt lgkmcnt(0)
s_endpgm
L_pk3:
s_waitcnt vmcnt(0)
s_mov_b32 s41, 0
L_wip:
v_readfirstlane_b32 s40, v10
s_add_u32 s41, s41, 1
s_cmp_lg_u32 s40, 0
s_cbranch_scc1 L_widp
s_cmp_gt_u32 s41, 0x8000
s_cbranch_scc1 L_widp
s_sleep 2
buffer_load_dword v10, v0, s[24:27], 0 offen sc1
s_waitcnt vmcnt(0)
s_branch L_wip
L_widp:
s_lshl_b32 s40, s32, 17
s_add_u32 s40, s40, 46137344
s_add_u32 s16, s14, s40
s_addc_u32 s17, s15, 0
s_mov_b32 s18, 131072
s_mov_b32 s19, 0x20000
s_mov_b32 s20, s10
s_mov_b32 s21, s11
s_mov_b32 s22, 8192000
s_mov_b32 s23, 0x20000
v_lshlrev_b32 v4, 4, v1
s_mul_i32 s54, s32, 0
s_add_u32 s54, s54, 75776
v_add_u32 v7, s54, v4
s_setprio 0
v_and_b32 v88, 3, v2
v_lshrrev_b32 v89, 2, v2
v_lshl_add_u32 v90, v88, 2, v89
v_and_b32 v91, 1, v89
s_cmp_eq_u32 s32, 3
s_cselect_b64 vcc, -1, 0
s_lshl_b32 s40, s32, 4
s_add_u32 s40, s40, 14
v_cndmask_b32 v90, v90, v91, vcc
v_add_u32 v90, s40, v90
v_cvt_f32_u32 v90, v90
v_mul_f32 v90, 0x3c000000, v90
v_add_f32 v91, v90, v90
v_lshl_add_u32 v92, v3, 3, 1
v_cvt_f32_u32 v92, v92
s_mov_b32 s42, 0xbd38aa3b
s_mov_b32 s43, 0x3d38aa3b
v_add_f32 v93, 0x0, v92
v_mul_f32 v93, v93, v90
v_cos_f32 v96, v93
v_sin_f32 v97, v93
v_add_f32 v93, v93, v91
v_cos_f32 v98, v93
v_sin_f32 v99, v93
v_add_f32 v93, v93, v91
v_cos_f32 v100, v93
v_sin_f32 v101, v93
v_add_f32 v93, v93, v91
v_cos_f32 v102, v93
v_sin_f32 v103, v93
s_nop 0
v_mul_f32 v96, s42, v96
v_mul_f32 v97, s43, v97
v_cvt_pk_bf16_f32 v104, v96, v97
v_mul_f32 v98, s42, v98
v_mul_f32 v99, s43, v99
v_cvt_pk_bf16_f32 v105, v98, v99
v_mul_f32 v100, s42, v100
v_mul_f32 v101, s43, v101
v_cvt_pk_bf16_f32 v106, v100, v101
v_mul_f32 v102, s42, v102
v_mul_f32 v103, s43, v103
v_cvt_pk_bf16_f32 v107, v102, v103
v_add_f32 v93, 0x42000000, v92
v_mul_f32 v93, v93, v90
v_cos_f32 v96, v93
v_sin_f32 v97, v93
v_add_f32 v93, v93, v91
v_cos_f32 v98, v93
v_sin_f32 v99, v93
v_add_f32 v93, v93, v91
v_cos_f32 v100, v93
v_sin_f32 v101, v93
v_add_f32 v93, v93, v91
v_cos_f32 v102, v93
v_sin_f32 v103, v93
s_nop 0
v_mul_f32 v96, s42, v96
v_mul_f32 v97, s43, v97
v_cvt_pk_bf16_f32 v108, v96, v97
v_mul_f32 v98, s42, v98
v_mul_f32 v99, s43, v99
v_cvt_pk_bf16_f32 v109, v98, v99
v_mul_f32 v100, s42, v100
v_mul_f32 v101, s43, v101
v_cvt_pk_bf16_f32 v110, v100, v101
v_mul_f32 v102, s42, v102
v_mul_f32 v103, s43, v103
v_cvt_pk_bf16_f32 v111, v102, v103
s_lshl_b32 s40, s32, 11
s_add_u32 s40, s40, 65536
v_add_u32 v94, s40, v4
s_cmp_eq_u32 s32, 3
s_cbranch_scc0 L_tw3
v_and_b32 v95, 11, v2
v_cmp_eq_u32 vcc, 8, v95
s_nop 1
v_cndmask_b32 v112, 0, v104, vcc
v_cndmask_b32 v113, 0, v105, vcc
v_cndmask_b32 v114, 0, v106, vcc
v_cndmask_b32 v115, 0, v107, vcc
v_cndmask_b32 v116, 0, v108, vcc
v_cndmask_b32 v117, 0, v109, vcc
v_cndmask_b32 v118, 0, v110, vcc
v_cndmask_b32 v119, 0, v111, vcc
v_cmp_eq_u32 vcc, 0, v95
ds_write_b128 v94, v[112:115] offset:2048
ds_write_b128 v94, v[116:119] offset:3072
v_cndmask_b32 v104, 0, v104, vcc
v_cndmask_b32 v105, 0, v105, vcc
v_cndmask_b32 v106, 0, v106, vcc
v_cndmask_b32 v107, 0, v107, vcc
v_cndmask_b32 v108, 0, v108, vcc
v_cndmask_b32 v109, 0, v109, vcc
v_cndmask_b32 v110, 0, v110, vcc
v_cndmask_b32 v111, 0, v111, vcc
L_tw3:
ds_write_b128 v94, v[104:107]
ds_write_b128 v94, v[108:111] offset:1024
s_lshl_b32 s40, s32, 12
v_add_u32 v94, s40, v4
v_mov_b32 v96, 0
v_mov_b32 v97, 0
v_mov_b32 v98, 0
v_mov_b32 v99, 0
ds_write_b128 v94, v[96:99] offset:3072
ds_write_b128 v94, v[96:99] offset:19456
ds_write_b128 v94, v[96:99] offset:35840
ds_write_b128 v94, v[96:99] offset:52224
s_waitcnt lgkmcnt(0)
v_mov_b32 v120, 160532
v_mov_b32 v121, 1
s_mov_b64 exec, 1
ds_add_u32 v120, v121
s_mov_b64 exec, -1
s_cmp_lg_u32 s32, 0
s_cbranch_scc1 L_dw
v_and_b32 v120, 7, v1
v_mul_u32_u24 v120, 4224, v120
s_mov_b32 s42, 101376
s_mov_b32 s41, 0
s_mov_b64 exec, 0xff
L_pl5:
buffer_load_dword v121, v120, s[24:27], s42 offen sc1
s_add_u32 s41, s41, 1
s_cmp_gt_u32 s41, 0x8000
s_cbranch_scc1 L_px5
s_waitcnt vmcnt(0)
v_cmp_ne_u32 vcc, 1, v121
s_nop 1
s_cbranch_vccz L_px5
s_sleep 1
s_branch L_pl5
L_px5:
s_mov_b64 exec, -1
v_mov_b32 v120, 160536
v_mov_b32 v121, 1
s_mov_b64 exec, 1
ds_add_u32 v120, v121
s_mov_b64 exec, -1
L_dw:
v_mov_b32 v120, 160516
s_mov_b32 s41, 0
L_lws:
ds_read_b32 v121, v120
s_add_u32 s41, s41, 1
s_waitcnt lgkmcnt(0)
v_readfirstlane_b32 s40, v121
s_cmp_gt_u32 s41, 0x100000
s_cbranch_scc1 L_lwds
s_cmp_ge_u32 s40, 4
s_cbranch_scc1 L_lwds
s_sleep 2
s_branch L_lws
L_lwds:
s_mov_b32 s52, 0
buffer_load_dwordx4 v[8:11], v4, s[16:19], s52 offen offset:0 sc1
buffer_load_dwordx4 v[12:15], v4, s[16:19], s52 offen offset:1024 sc1
buffer_load_dwordx4 v[16:19], v4, s[16:19], s52 offen offset:2048 sc1
buffer_load_dwordx4 v[20:23], v4, s[16:19], s52 offen offset:3072 sc1
s_mov_b32 s52, 4096
buffer_load_dwordx4 v[24:27], v4, s[16:19], s52 offen offset:0 sc1
buffer_load_dwordx4 v[28:31], v4, s[16:19], s52 offen offset:1024 sc1
buffer_load_dwordx4 v[32:35], v4, s[16:19], s52 offen offset:2048 sc1
buffer_load_dwordx4 v[36:39], v4, s[16:19], s52 offen offset:3072 sc1
s_mov_b32 s52, 8192
buffer_load_dwordx4 v[40:43], v4, s[16:19], s52 offen offset:0 sc1
buffer_load_dwordx4 v[44:47], v4, s[16:19], s52 offen offset:1024 sc1
buffer_load_dwordx4 v[48:51], v4, s[16:19], s52 offen offset:2048 sc1
buffer_load_dwordx4 v[52:55], v4, s[16:19], s52 offen offset:3072 sc1
s_mov_b32 s52, 12288
buffer_load_dwordx4 v[56:59], v4, s[16:19], s52 offen offset:0 sc1
buffer_load_dwordx4 v[60:63], v4, s[16:19], s52 offen offset:1024 sc1
buffer_load_dwordx4 v[64:67], v4, s[16:19], s52 offen offset:2048 sc1
buffer_load_dwordx4 v[68:71], v4, s[16:19], s52 offen offset:3072 sc1
s_mov_b32 s52, 16384
buffer_load_dwordx4 v[72:75], v4, s[16:19], s52 offen offset:0 sc1
buffer_load_dwordx4 v[76:79], v4, s[16:19], s52 offen offset:1024 sc1
buffer_load_dwordx4 v[80:83], v4, s[16:19], s52 offen offset:2048 sc1
buffer_load_dwordx4 v[84:87], v4, s[16:19], s52 offen offset:3072 sc1
s_lshr_b32 s40, s38, 4
s_cmp_ge_u32 s40, 5
s_cselect_b32 s41, 1, 0
s_mul_i32 s42, s41, 5
s_sub_u32 s40, s40, s42
s_lshl_b32 s40, s40, 3
s_bfe_u32 s42, s38, 0x30001
s_add_u32 s40, s40, s42
s_mul_i32 s40, s40, 100
s_and_b32 s42, s38, 1
s_add_u32 s40, s40, s42
s_mul_i32 s41, s41, 4000
s_add_u32 s40, s40, s41
s_lshl_b32 s40, s40, 10
s_lshl_b32 s41, s32, 8
s_add_u32 s53, s40, s41
v_lshlrev_b32 v5, 11, v3
v_lshl_add_u32 v5, v2, 4, v5
v_cmp_gt_u32 vcc, 2, v3
v_mov_b32 v6, 0x7f000000
s_nop 0
v_cndmask_b32 v6, v6, v5, vcc
v_mov_b32 v120, 160576
s_branch L_zs0
L_zf0:
ds_read_b128 v[88:91], v4 offset:0
ds_read_b128 v[92:95], v4 offset:1024
ds_read_b128 v[96:99], v4 offset:2048
ds_read_b128 v[100:103], v4 offset:3072
s_waitcnt lgkmcnt(0)
s_waitcnt vmcnt(19)
v_mfma_f32_16x16x32_bf16 v[128:131], v[88:91], v[8:11], 0
v_mfma_f32_16x16x32_bf16 v[160:163], v[92:95], v[8:11], 0
v_mfma_f32_16x16x32_bf16 v[192:195], v[96:99], v[8:11], 0
v_mfma_f32_16x16x32_bf16 v[224:227], v[100:103], v[8:11], 0
s_mov_b32 s52, 20480
buffer_load_dwordx4 v[8:11], v4, s[16:19], s52 offen offset:0 sc1
s_waitcnt vmcnt(19)
v_mfma_f32_16x16x32_bf16 v[132:135], v[88:91], v[12:15], 0
v_mfma_f32_16x16x32_bf16 v[164:167], v[92:95], v[12:15], 0
v_mfma_f32_16x16x32_bf16 v[196:199], v[96:99], v[12:15], 0
v_mfma_f32_16x16x32_bf16 v[228:231], v[100:103], v[12:15], 0
buffer_load_dwordx4 v[12:15], v4, s[16:19], s52 offen offset:1024 sc1
s_waitcnt vmcnt(19)
v_mfma_f32_16x16x32_bf16 v[136:139], v[88:91], v[16:19], 0
ds_read_b128 v[104:107], v4 offset:4096
v_mfma_f32_16x16x32_bf16 v[168:171], v[92:95], v[16:19], 0
ds_read_b128 v[108:111], v4 offset:5120
v_mfma_f32_16x16x32_bf16 v[200:203], v[96:99], v[16:19], 0
ds_read_b128 v[112:115], v4 offset:6144
v_mfma_f32_16x16x32_bf16 v[232:235], v[100:103], v[16:19], 0
ds_read_b128 v[116:119], v4 offset:7168
buffer_load_dwordx4 v[16:19], v4, s[16:19], s52 offen offset:2048 sc1
s_waitcnt vmcnt(19)
v_mfma_f32_16x16x32_bf16 v[140:143], v[88:91], v[20:23], 0
v_mfma_f32_16x16x32_bf16 v[172:175], v[92:95], v[20:23], 0
v_mfma_f32_16x16x32_bf16 v[204:207], v[96:99], v[20:23], 0
v_mfma_f32_16x16x32_bf16 v[236:239], v[100:103], v[20:23], 0
buffer_load_dwordx4 v[20:23], v4, s[16:19], s52 offen offset:3072 sc1
s_waitcnt vmcnt(19)
v_mfma_f32_16x16x32_bf16 v[144:147], v[88:91], v[24:27], 0
v_mfma_f32_16x16x32_bf16 v[176:179], v[92:95], v[24:27], 0
v_mfma_f32_16x16x32_bf16 v[208:211], v[96:99], v[24:27], 0
v_mfma_f32_16x16x32_bf16 v[240:243], v[100:103], v[24:27], 0
s_mov_b32 s52, 24576
buffer_load_dwordx4 v[24:27], v4, s[16:19], s52 offen offset:0 sc1
s_waitcnt vmcnt(19)
v_mfma_f32_16x16x32_bf16 v[148:151], v[88:91], v[28:31], 0
v_mfma_f32_16x16x32_bf16 v[180:183], v[92:95], v[28:31], 0
v_mfma_f32_16x16x32_bf16 v[212:215], v[96:99], v[28:31], 0
v_mfma_f32_16x16x32_bf16 v[244:247], v[100:103], v[28:31], 0
buffer_load_dwordx4 v[28:31], v4, s[16:19], s52 offen offset:1024 sc1
s_waitcnt vmcnt(19)
v_mfma_f32_16x16x32_bf16 v[152:155], v[88:91], v[32:35], 0
v_mfma_f32_16x16x32_bf16 v[184:187], v[92:95], v[32:35], 0
v_mfma_f32_16x16x32_bf16 v[216:219], v[96:99], v[32:35], 0
v_mfma_f32_16x16x32_bf16 v[248:251], v[100:103], v[32:35], 0
buffer_load_dwordx4 v[32:35], v4, s[16:19], s52 offen offset:2048 sc1
s_waitcnt vmcnt(19)
v_mfma_f32_16x16x32_bf16 v[156:159], v[88:91], v[36:39], 0
v_mfma_f32_16x16x32_bf16 v[188:191], v[92:95], v[36:39], 0
v_mfma_f32_16x16x32_bf16 v[220:223], v[96:99], v[36:39], 0
v_mfma_f32_16x16x32_bf16 v[252:255], v[100:103], v[36:39], 0
buffer_load_dwordx4 v[36:39], v4, s[16:19], s52 offen offset:3072 sc1
s_waitcnt lgkmcnt(0)
s_waitcnt vmcnt(19)
v_mfma_f32_16x16x32_bf16 v[128:131], v[104:107], v[40:43], v[128:131]
v_mfma_f32_16x16x32_bf16 v[160:163], v[108:111], v[40:43], v[160:163]
v_mfma_f32_16x16x32_bf16 v[192:195], v[112:115], v[40:43], v[192:195]
v_mfma_f32_16x16x32_bf16 v[224:227], v[116:119], v[40:43], v[224:227]
s_mov_b32 s52, 28672
buffer_load_dwordx4 v[40:43], v4, s[16:19], s52 offen offset:0 sc1
s_waitcnt vmcnt(19)
v_mfma_f32_16x16x32_bf16 v[132:135], v[104:107], v[44:47], v[132:135]
v_mfma_f32_16x16x32_bf16 v[164:167], v[108:111], v[44:47], v[164:167]
v_mfma_f32_16x16x32_bf16 v[196:199], v[112:115], v[44:47], v[196:199]
v_mfma_f32_16x16x32_bf16 v[228:231], v[116:119], v[44:47], v[228:231]
buffer_load_dwordx4 v[44:47], v4, s[16:19], s52 offen offset:1024 sc1
s_waitcnt vmcnt(19)
v_mfma_f32_16x16x32_bf16 v[136:139], v[104:107], v[48:51], v[136:139]
ds_read_b128 v[88:91], v4 offset:8192
v_mfma_f32_16x16x32_bf16 v[168:171], v[108:111], v[48:51], v[168:171]
ds_read_b128 v[92:95], v4 offset:9216
v_mfma_f32_16x16x32_bf16 v[200:203], v[112:115], v[48:51], v[200:203]
ds_read_b128 v[96:99], v4 offset:10240
v_mfma_f32_16x16x32_bf16 v[232:235], v[116:119], v[48:51], v[232:235]
ds_read_b128 v[100:103], v4 offset:11264
buffer_load_dwordx4 v[48:51], v4, s[16:19], s52 offen offset:2048 sc1
s_waitcnt vmcnt(19)
v_mfma_f32_16x16x32_bf16 v[140:143], v[104:107], v[52:55], v[140:143]
v_mfma_f32_16x16x32_bf16 v[172:175], v[108:111], v[52:55], v[172:175]
v_mfma_f32_16x16x32_bf16 v[204:207], v[112:115], v[52:55], v[204:207]
v_mfma_f32_16x16x32_bf16 v[236:239], v[116:119], v[52:55], v[236:239]
buffer_load_dwordx4 v[52:55], v4, s[16:19], s52 offen offset:3072 sc1
s_waitcnt vmcnt(19)
v_mfma_f32_16x16x32_bf16 v[144:147], v[104:107], v[56:59], v[144:147]
v_mfma_f32_16x16x32_bf16 v[176:179], v[108:111], v[56:59], v[176:179]
v_mfma_f32_16x16x32_bf16 v[208:211], v[112:115], v[56:59], v[208:211]
v_mfma_f32_16x16x32_bf16 v[240:243], v[116:119], v[56:59], v[240:243]
s_mov_b32 s52, 32768
buffer_load_dwordx4 v[56:59], v4, s[16:19], s52 offen offset:0 sc1
s_waitcnt vmcnt(19)
v_mfma_f32_16x16x32_bf16 v[148:151], v[104:107], v[60:63], v[148:151]
v_mfma_f32_16x16x32_bf16 v[180:183], v[108:111], v[60:63], v[180:183]
v_mfma_f32_16x16x32_bf16 v[212:215], v[112:115], v[60:63], v[212:215]
v_mfma_f32_16x16x32_bf16 v[244:247], v[116:119], v[60:63], v[244:247]
buffer_load_dwordx4 v[60:63], v4, s[16:19], s52 offen offset:1024 sc1
s_waitcnt vmcnt(19)
v_mfma_f32_16x16x32_bf16 v[152:155], v[104:107], v[64:67], v[152:155]
v_mfma_f32_16x16x32_bf16 v[184:187], v[108:111], v[64:67], v[184:187]
v_mfma_f32_16x16x32_bf16 v[216:219], v[112:115], v[64:67], v[216:219]
v_mfma_f32_16x16x32_bf16 v[248:251], v[116:119], v[64:67], v[248:251]
buffer_load_dwordx4 v[64:67], v4, s[16:19], s52 offen offset:2048 sc1
s_waitcnt vmcnt(19)
v_mfma_f32_16x16x32_bf16 v[156:159], v[104:107], v[68:71], v[156:159]
v_mfma_f32_16x16x32_bf16 v[188:191], v[108:111], v[68:71], v[188:191]
v_mfma_f32_16x16x32_bf16 v[220:223], v[112:115], v[68:71], v[220:223]
v_mfma_f32_16x16x32_bf16 v[252:255], v[116:119], v[68:71], v[252:255]
buffer_load_dwordx4 v[68:71], v4, s[16:19], s52 offen offset:3072 sc1
s_waitcnt lgkmcnt(0)
s_waitcnt vmcnt(19)
v_mfma_f32_16x16x32_bf16 v[128:131], v[88:91], v[72:75], v[128:131]
v_mfma_f32_16x16x32_bf16 v[160:163], v[92:95], v[72:75], v[160:163]
v_mfma_f32_16x16x32_bf16 v[192:195], v[96:99], v[72:75], v[192:195]
v_mfma_f32_16x16x32_bf16 v[224:227], v[100:103], v[72:75], v[224:227]
s_mov_b32 s52, 36864
buffer_load_dwordx4 v[72:75], v4, s[16:19], s52 offen offset:0 sc1
s_waitcnt vmcnt(19)
v_mfma_f32_16x16x32_bf16 v[132:135], v[88:91], v[76:79], v[132:135]
v_mfma_f32_16x16x32_bf16 v[164:167], v[92:95], v[76:79], v[164:167]
v_mfma_f32_16x16x32_bf16 v[196:199], v[96:99], v[76:79], v[196:199]
v_mfma_f32_16x16x32_bf16 v[228:231], v[100:103], v[76:79], v[228:231]
buffer_load_dwordx4 v[76:79], v4, s[16:19], s52 offen offset:1024 sc1
s_waitcnt vmcnt(19)
v_mfma_f32_16x16x32_bf16 v[136:139], v[88:91], v[80:83], v[136:139]
ds_read_b128 v[104:107], v4 offset:12288
v_mfma_f32_16x16x32_bf16 v[168:171], v[92:95], v[80:83], v[168:171]
ds_read_b128 v[108:111], v4 offset:13312
v_mfma_f32_16x16x32_bf16 v[200:203], v[96:99], v[80:83], v[200:203]
ds_read_b128 v[112:115], v4 offset:14336
v_mfma_f32_16x16x32_bf16 v[232:235], v[100:103], v[80:83], v[232:235]
ds_read_b128 v[116:119], v4 offset:15360
buffer_load_dwordx4 v[80:83], v4, s[16:19], s52 offen offset:2048 sc1
s_waitcnt vmcnt(19)
v_mfma_f32_16x16x32_bf16 v[140:143], v[88:91], v[84:87], v[140:143]
v_mfma_f32_16x16x32_bf16 v[172:175], v[92:95], v[84:87], v[172:175]
v_mfma_f32_16x16x32_bf16 v[204:207], v[96:99], v[84:87], v[204:207]
v_mfma_f32_16x16x32_bf16 v[236:239], v[100:103], v[84:87], v[236:239]
buffer_load_dwordx4 v[84:87], v4, s[16:19], s52 offen offset:3072 sc1
s_waitcnt vmcnt(19)
v_mfma_f32_16x16x32_bf16 v[144:147], v[88:91], v[8:11], v[144:147]
v_mfma_f32_16x16x32_bf16 v[176:179], v[92:95], v[8:11], v[176:179]
v_mfma_f32_16x16x32_bf16 v[208:211], v[96:99], v[8:11], v[208:211]
v_mfma_f32_16x16x32_bf16 v[240:243], v[100:103], v[8:11], v[240:243]
s_mov_b32 s52, 40960
buffer_load_dwordx4 v[8:11], v4, s[16:19], s52 offen offset:0 sc1
s_waitcnt vmcnt(19)
v_mfma_f32_16x16x32_bf16 v[148:151], v[88:91], v[12:15], v[148:151]
v_mfma_f32_16x16x32_bf16 v[180:183], v[92:95], v[12:15], v[180:183]
v_mfma_f32_16x16x32_bf16 v[212:215], v[96:99], v[12:15], v[212:215]
v_mfma_f32_16x16x32_bf16 v[244:247], v[100:103], v[12:15], v[244:247]
buffer_load_dwordx4 v[12:15], v4, s[16:19], s52 offen offset:1024 sc1
s_waitcnt vmcnt(19)
v_mfma_f32_16x16x32_bf16 v[152:155], v[88:91], v[16:19], v[152:155]
v_mfma_f32_16x16x32_bf16 v[184:187], v[92:95], v[16:19], v[184:187]
v_mfma_f32_16x16x32_bf16 v[216:219], v[96:99], v[16:19], v[216:219]
v_mfma_f32_16x16x32_bf16 v[248:251], v[100:103], v[16:19], v[248:251]
buffer_load_dwordx4 v[16:19], v4, s[16:19], s52 offen offset:2048 sc1
s_waitcnt vmcnt(19)
v_mfma_f32_16x16x32_bf16 v[156:159], v[88:91], v[20:23], v[156:159]
v_mfma_f32_16x16x32_bf16 v[188:191], v[92:95], v[20:23], v[188:191]
v_mfma_f32_16x16x32_bf16 v[220:223], v[96:99], v[20:23], v[220:223]
v_mfma_f32_16x16x32_bf16 v[252:255], v[100:103], v[20:23], v[252:255]
buffer_load_dwordx4 v[20:23], v4, s[16:19], s52 offen offset:3072 sc1
s_waitcnt lgkmcnt(0)
s_waitcnt vmcnt(19)
v_mfma_f32_16x16x32_bf16 v[128:131], v[104:107], v[24:27], v[128:131]
v_mfma_f32_16x16x32_bf16 v[160:163], v[108:111], v[24:27], v[160:163]
v_mfma_f32_16x16x32_bf16 v[192:195], v[112:115], v[24:27], v[192:195]
v_mfma_f32_16x16x32_bf16 v[224:227], v[116:119], v[24:27], v[224:227]
s_mov_b32 s52, 45056
buffer_load_dwordx4 v[24:27], v4, s[16:19], s52 offen offset:0 sc1
s_waitcnt vmcnt(19)
v_mfma_f32_16x16x32_bf16 v[132:135], v[104:107], v[28:31], v[132:135]
v_mfma_f32_16x16x32_bf16 v[164:167], v[108:111], v[28:31], v[164:167]
v_mfma_f32_16x16x32_bf16 v[196:199], v[112:115], v[28:31], v[196:199]
v_mfma_f32_16x16x32_bf16 v[228:231], v[116:119], v[28:31], v[228:231]
buffer_load_dwordx4 v[28:31], v4, s[16:19], s52 offen offset:1024 sc1
s_waitcnt vmcnt(19)
v_mfma_f32_16x16x32_bf16 v[136:139], v[104:107], v[32:35], v[136:139]
v_mfma_f32_16x16x32_bf16 v[168:171], v[108:111], v[32:35], v[168:171]
v_mfma_f32_16x16x32_bf16 v[200:203], v[112:115], v[32:35], v[200:203]
v_mfma_f32_16x16x32_bf16 v[232:235], v[116:119], v[32:35], v[232:235]
buffer_load_dwordx4 v[32:35], v4, s[16:19], s52 offen offset:2048 sc1
s_waitcnt vmcnt(19)
v_mfma_f32_16x16x32_bf16 v[140:143], v[104:107], v[36:39], v[140:143]
ds_read_b32 v121, v120
v_mfma_f32_16x16x32_bf16 v[172:175], v[108:111], v[36:39], v[172:175]
v_mfma_f32_16x16x32_bf16 v[204:207], v[112:115], v[36:39], v[204:207]
v_mfma_f32_16x16x32_bf16 v[236:239], v[116:119], v[36:39], v[236:239]
buffer_load_dwordx4 v[36:39], v4, s[16:19], s52 offen offset:3072 sc1
s_waitcnt vmcnt(19)
v_mfma_f32_16x16x32_bf16 v[144:147], v[104:107], v[40:43], v[144:147]
v_mfma_f32_16x16x32_bf16 v[176:179], v[108:111], v[40:43], v[176:179]
s_waitcnt lgkmcnt(0)
v_readfirstlane_b32 s57, v121
v_mfma_f32_16x16x32_bf16 v[208:211], v[112:115], v[40:43], v[208:211]
s_sub_u32 s57, s57, 0x2020202
v_mfma_f32_16x16x32_bf16 v[240:243], v[116:119], v[40:43], v[240:243]
s_and_b32 s57, s57, 0x80808080
s_cbranch_scc1 L_zs4
L_zf4:
s_mov_b32 s52, 49152
buffer_load_dwordx4 v[40:43], v4, s[16:19], s52 offen offset:0 sc1
s_waitcnt vmcnt(19)
v_mfma_f32_16x16x32_bf16 v[148:151], v[104:107], v[44:47], v[148:151]
ds_read_b128 v[88:91], v4 offset:16384
v_mfma_f32_16x16x32_bf16 v[180:183], v[108:111], v[44:47], v[180:183]
ds_read_b128 v[92:95], v4 offset:17408
v_mfma_f32_16x16x32_bf16 v[212:215], v[112:115], v[44:47], v[212:215]
ds_read_b128 v[96:99], v4 offset:18432
v_mfma_f32_16x16x32_bf16 v[244:247], v[116:119], v[44:47], v[244:247]
ds_read_b128 v[100:103], v4 offset:19456
buffer_load_dwordx4 v[44:47], v4, s[16:19], s52 offen offset:1024 sc1
s_waitcnt vmcnt(19)
v_mfma_f32_16x16x32_bf16 v[152:155], v[104:107], v[48:51], v[152:155]
v_mfma_f32_16x16x32_bf16 v[184:187], v[108:111], v[48:51], v[184:187]
v_mfma_f32_16x16x32_bf16 v[216:219], v[112:115], v[48:51], v[216:219]
v_mfma_f32_16x16x32_bf16 v[248:251], v[116:119], v[48:51], v[248:251]
buffer_load_dwordx4 v[48:51], v4, s[16:19], s52 offen offset:2048 sc1
s_waitcnt vmcnt(19)
v_mfma_f32_16x16x32_bf16 v[156:159], v[104:107], v[52:55], v[156:159]
v_mfma_f32_16x16x32_bf16 v[188:191], v[108:111], v[52:55], v[188:191]
v_mfma_f32_16x16x32_bf16 v[220:223], v[112:115], v[52:55], v[220:223]
v_mfma_f32_16x16x32_bf16 v[252:255], v[116:119], v[52:55], v[252:255]
buffer_load_dwordx4 v[52:55], v4, s[16:19], s52 offen offset:3072 sc1
s_waitcnt lgkmcnt(0)
s_waitcnt vmcnt(19)
v_mfma_f32_16x16x32_bf16 v[128:131], v[88:91], v[56:59], v[128:131]
v_mfma_f32_16x16x32_bf16 v[160:163], v[92:95], v[56:59], v[160:163]
v_mfma_f32_16x16x32_bf16 v[192:195], v[96:99], v[56:59], v[192:195]
v_mfma_f32_16x16x32_bf16 v[224:227], v[100:103], v[56:59], v[224:227]
s_mov_b32 s52, 53248
buffer_load_dwordx4 v[56:59], v4, s[16:19], s52 offen offset:0 sc1
s_waitcnt vmcnt(19)
v_mfma_f32_16x16x32_bf16 v[132:135], v[88:91], v[60:63], v[132:135]
v_mfma_f32_16x16x32_bf16 v[164:167], v[92:95], v[60:63], v[164:167]
v_mfma_f32_16x16x32_bf16 v[196:199], v[96:99], v[60:63], v[196:199]
v_mfma_f32_16x16x32_bf16 v[228:231], v[100:103], v[60:63], v[228:231]
buffer_load_dwordx4 v[60:63], v4, s[16:19], s52 offen offset:1024 sc1
s_waitcnt vmcnt(19)
v_mfma_f32_16x16x32_bf16 v[136:139], v[88:91], v[64:67], v[136:139]
ds_read_b128 v[104:107], v4 offset:20480
v_mfma_f32_16x16x32_bf16 v[168:171], v[92:95], v[64:67], v[168:171]
ds_read_b128 v[108:111], v4 offset:21504
v_mfma_f32_16x16x32_bf16 v[200:203], v[96:99], v[64:67], v[200:203]
ds_read_b128 v[112:115], v4 offset:22528
v_mfma_f32_16x16x32_bf16 v[232:235], v[100:103], v[64:67], v[232:235]
ds_read_b128 v[116:119], v4 offset:23552
buffer_load_dwordx4 v[64:67], v4, s[16:19], s52 offen offset:2048 sc1
s_waitcnt vmcnt(19)
v_mfma_f32_16x16x32_bf16 v[140:143], v[88:91], v[68:71], v[140:143]
v_mfma_f32_16x16x32_bf16 v[172:175], v[92:95], v[68:71], v[172:175]
v_mfma_f32_16x16x32_bf16 v[204:207], v[96:99], v[68:71], v[204:207]
v_mfma_f32_16x16x32_bf16 v[236:239], v[100:103], v[68:71], v[236:239]
buffer_load_dwordx4 v[68:71], v4, s[16:19], s52 offen offset:3072 sc1
s_waitcnt vmcnt(19)
v_mfma_f32_16x16x32_bf16 v[144:147], v[88:91], v[72:75], v[144:147]
v_mfma_f32_16x16x32_bf16 v[176:179], v[92:95], v[72:75], v[176:179]
v_mfma_f32_16x16x32_bf16 v[208:211], v[96:99], v[72:75], v[208:211]
v_mfma_f32_16x16x32_bf16 v[240:243], v[100:103], v[72:75], v[240:243]
s_mov_b32 s52, 57344
buffer_load_dwordx4 v[72:75], v4, s[16:19], s52 offen offset:0 sc1
s_waitcnt vmcnt(19)
v_mfma_f32_16x16x32_bf16 v[148:151], v[88:91], v[76:79], v[148:151]
v_mfma_f32_16x16x32_bf16 v[180:183], v[92:95], v[76:79], v[180:183]
v_mfma_f32_16x16x32_bf16 v[212:215], v[96:99], v[76:79], v[212:215]
v_mfma_f32_16x16x32_bf16 v[244:247], v[100:103], v[76:79], v[244:247]
buffer_load_dwordx4 v[76:79], v4, s[16:19], s52 offen offset:1024 sc1
s_waitcnt vmcnt(19)
v_mfma_f32_16x16x32_bf16 v[152:155], v[88:91], v[80:83], v[152:155]
v_mfma_f32_16x16x32_bf16 v[184:187], v[92:95], v[80:83], v[184:187]
v_mfma_f32_16x16x32_bf16 v[216:219], v[96:99], v[80:83], v[216:219]
v_mfma_f32_16x16x32_bf16 v[248:251], v[100:103], v[80:83], v[248:251]
buffer_load_dwordx4 v[80:83], v4, s[16:19], s52 offen offset:2048 sc1
s_waitcnt vmcnt(19)
v_mfma_f32_16x16x32_bf16 v[156:159], v[88:91], v[84:87], v[156:159]
v_mfma_f32_16x16x32_bf16 v[188:191], v[92:95], v[84:87], v[188:191]
v_mfma_f32_16x16x32_bf16 v[220:223], v[96:99], v[84:87], v[220:223]
v_mfma_f32_16x16x32_bf16 v[252:255], v[100:103], v[84:87], v[252:255]
buffer_load_dwordx4 v[84:87], v4, s[16:19], s52 offen offset:3072 sc1
s_waitcnt lgkmcnt(0)
s_waitcnt vmcnt(19)
v_mfma_f32_16x16x32_bf16 v[128:131], v[104:107], v[8:11], v[128:131]
v_mfma_f32_16x16x32_bf16 v[160:163], v[108:111], v[8:11], v[160:163]
v_mfma_f32_16x16x32_bf16 v[192:195], v[112:115], v[8:11], v[192:195]
v_mfma_f32_16x16x32_bf16 v[224:227], v[116:119], v[8:11], v[224:227]
s_mov_b32 s52, 61440
buffer_load_dwordx4 v[8:11], v4, s[16:19], s52 offen offset:0 sc1
s_waitcnt vmcnt(19)
v_mfma_f32_16x16x32_bf16 v[132:135], v[104:107], v[12:15], v[132:135]
v_mfma_f32_16x16x32_bf16 v[164:167], v[108:111], v[12:15], v[164:167]
v_mfma_f32_16x16x32_bf16 v[196:199], v[112:115], v[12:15], v[196:199]
v_mfma_f32_16x16x32_bf16 v[228:231], v[116:119], v[12:15], v[228:231]
buffer_load_dwordx4 v[12:15], v4, s[16:19], s52 offen offset:1024 sc1
s_waitcnt vmcnt(19)
v_mfma_f32_16x16x32_bf16 v[136:139], v[104:107], v[16:19], v[136:139]
ds_read_b128 v[88:91], v4 offset:24576
v_mfma_f32_16x16x32_bf16 v[168:171], v[108:111], v[16:19], v[168:171]
ds_read_b128 v[92:95], v4 offset:25600
v_mfma_f32_16x16x32_bf16 v[200:203], v[112:115], v[16:19], v[200:203]
ds_read_b128 v[96:99], v4 offset:26624
v_mfma_f32_16x16x32_bf16 v[232:235], v[116:119], v[16:19], v[232:235]
ds_read_b128 v[100:103], v4 offset:27648
buffer_load_dwordx4 v[16:19], v4, s[16:19], s52 offen offset:2048 sc1
s_waitcnt vmcnt(19)
v_mfma_f32_16x16x32_bf16 v[140:143], v[104:107], v[20:23], v[140:143]
v_mfma_f32_16x16x32_bf16 v[172:175], v[108:111], v[20:23], v[172:175]
v_mfma_f32_16x16x32_bf16 v[204:207], v[112:115], v[20:23], v[204:207]
v_mfma_f32_16x16x32_bf16 v[236:239], v[116:119], v[20:23], v[236:239]
buffer_load_dwordx4 v[20:23], v4, s[16:19], s52 offen offset:3072 sc1
s_waitcnt vmcnt(19)
v_mfma_f32_16x16x32_bf16 v[144:147], v[104:107], v[24:27], v[144:147]
v_mfma_f32_16x16x32_bf16 v[176:179], v[108:111], v[24:27], v[176:179]
v_mfma_f32_16x16x32_bf16 v[208:211], v[112:115], v[24:27], v[208:211]
v_mfma_f32_16x16x32_bf16 v[240:243], v[116:119], v[24:27], v[240:243]
s_mov_b32 s52, 65536
buffer_load_dwordx4 v[24:27], v4, s[16:19], s52 offen offset:0 sc1
s_waitcnt vmcnt(19)
v_mfma_f32_16x16x32_bf16 v[148:151], v[104:107], v[28:31], v[148:151]
v_mfma_f32_16x16x32_bf16 v[180:183], v[108:111], v[28:31], v[180:183]
v_mfma_f32_16x16x32_bf16 v[212:215], v[112:115], v[28:31], v[212:215]
v_mfma_f32_16x16x32_bf16 v[244:247], v[116:119], v[28:31], v[244:247]
buffer_load_dwordx4 v[28:31], v4, s[16:19], s52 offen offset:1024 sc1
s_waitcnt vmcnt(19)
v_mfma_f32_16x16x32_bf16 v[152:155], v[104:107], v[32:35], v[152:155]
v_mfma_f32_16x16x32_bf16 v[184:187], v[108:111], v[32:35], v[184:187]
v_mfma_f32_16x16x32_bf16 v[216:219], v[112:115], v[32:35], v[216:219]
v_mfma_f32_16x16x32_bf16 v[248:251], v[116:119], v[32:35], v[248:251]
buffer_load_dwordx4 v[32:35], v4, s[16:19], s52 offen offset:2048 sc1
s_waitcnt vmcnt(19)
v_mfma_f32_16x16x32_bf16 v[156:159], v[104:107], v[36:39], v[156:159]
v_mfma_f32_16x16x32_bf16 v[188:191], v[108:111], v[36:39], v[188:191]
v_mfma_f32_16x16x32_bf16 v[220:223], v[112:115], v[36:39], v[220:223]
v_mfma_f32_16x16x32_bf16 v[252:255], v[116:119], v[36:39], v[252:255]
buffer_load_dwordx4 v[36:39], v4, s[16:19], s52 offen offset:3072 sc1
s_waitcnt lgkmcnt(0)
s_waitcnt vmcnt(19)
v_mfma_f32_16x16x32_bf16 v[128:131], v[88:91], v[40:43], v[128:131]
v_mfma_f32_16x16x32_bf16 v[160:163], v[92:95], v[40:43], v[160:163]
v_mfma_f32_16x16x32_bf16 v[192:195], v[96:99], v[40:43], v[192:195]
v_mfma_f32_16x16x32_bf16 v[224:227], v[100:103], v[40:43], v[224:227]
s_mov_b32 s52, 69632
buffer_load_dwordx4 v[40:43], v4, s[16:19], s52 offen offset:0 sc1
s_waitcnt vmcnt(19)
v_mfma_f32_16x16x32_bf16 v[132:135], v[88:91], v[44:47], v[132:135]
v_mfma_f32_16x16x32_bf16 v[164:167], v[92:95], v[44:47], v[164:167]
v_mfma_f32_16x16x32_bf16 v[196:199], v[96:99], v[44:47], v[196:199]
v_mfma_f32_16x16x32_bf16 v[228:231], v[100:103], v[44:47], v[228:231]
buffer_load_dwordx4 v[44:47], v4, s[16:19], s52 offen offset:1024 sc1
s_waitcnt vmcnt(19)
v_mfma_f32_16x16x32_bf16 v[136:139], v[88:91], v[48:51], v[136:139]
ds_read_b128 v[104:107], v4 offset:28672
v_mfma_f32_16x16x32_bf16 v[168:171], v[92:95], v[48:51], v[168:171]
ds_read_b128 v[108:111], v4 offset:29696
v_mfma_f32_16x16x32_bf16 v[200:203], v[96:99], v[48:51], v[200:203]
ds_read_b128 v[112:115], v4 offset:30720
v_mfma_f32_16x16x32_bf16 v[232:235], v[100:103], v[48:51], v[232:235]
ds_read_b128 v[116:119], v4 offset:31744
buffer_load_dwordx4 v[48:51], v4, s[16:19], s52 offen offset:2048 sc1
s_waitcnt vmcnt(19)
v_mfma_f32_16x16x32_bf16 v[140:143], v[88:91], v[52:55], v[140:143]
v_mfma_f32_16x16x32_bf16 v[172:175], v[92:95], v[52:55], v[172:175]
v_mfma_f32_16x16x32_bf16 v[204:207], v[96:99], v[52:55], v[204:207]
v_mfma_f32_16x16x32_bf16 v[236:239], v[100:103], v[52:55], v[236:239]
buffer_load_dwordx4 v[52:55], v4, s[16:19], s52 offen offset:3072 sc1
s_waitcnt vmcnt(19)
v_mfma_f32_16x16x32_bf16 v[144:147], v[88:91], v[56:59], v[144:147]
v_mfma_f32_16x16x32_bf16 v[176:179], v[92:95], v[56:59], v[176:179]
v_mfma_f32_16x16x32_bf16 v[208:211], v[96:99], v[56:59], v[208:211]
v_mfma_f32_16x16x32_bf16 v[240:243], v[100:103], v[56:59], v[240:243]
s_mov_b32 s52, 73728
buffer_load_dwordx4 v[56:59], v4, s[16:19], s52 offen offset:0 sc1
s_waitcnt vmcnt(19)
v_mfma_f32_16x16x32_bf16 v[148:151], v[88:91], v[60:63], v[148:151]
v_mfma_f32_16x16x32_bf16 v[180:183], v[92:95], v[60:63], v[180:183]
v_mfma_f32_16x16x32_bf16 v[212:215], v[96:99], v[60:63], v[212:215]
v_mfma_f32_16x16x32_bf16 v[244:247], v[100:103], v[60:63], v[244:247]
buffer_load_dwordx4 v[60:63], v4, s[16:19], s52 offen offset:1024 sc1
s_waitcnt vmcnt(19)
v_mfma_f32_16x16x32_bf16 v[152:155], v[88:91], v[64:67], v[152:155]
v_mfma_f32_16x16x32_bf16 v[184:187], v[92:95], v[64:67], v[184:187]
v_mfma_f32_16x16x32_bf16 v[216:219], v[96:99], v[64:67], v[216:219]
v_mfma_f32_16x16x32_bf16 v[248:251], v[100:103], v[64:67], v[248:251]
buffer_load_dwordx4 v[64:67], v4, s[16:19], s52 offen offset:2048 sc1
s_waitcnt vmcnt(19)
v_mfma_f32_16x16x32_bf16 v[156:159], v[88:91], v[68:71], v[156:159]
v_mfma_f32_16x16x32_bf16 v[188:191], v[92:95], v[68:71], v[188:191]
v_mfma_f32_16x16x32_bf16 v[220:223], v[96:99], v[68:71], v[220:223]
v_mfma_f32_16x16x32_bf16 v[252:255], v[100:103], v[68:71], v[252:255]
buffer_load_dwordx4 v[68:71], v4, s[16:19], s52 offen offset:3072 sc1
s_waitcnt lgkmcnt(0)
s_waitcnt vmcnt(19)
v_mfma_f32_16x16x32_bf16 v[128:131], v[104:107], v[72:75], v[128:131]
v_mfma_f32_16x16x32_bf16 v[160:163], v[108:111], v[72:75], v[160:163]
v_mfma_f32_16x16x32_bf16 v[192:195], v[112:115], v[72:75], v[192:195]
v_mfma_f32_16x16x32_bf16 v[224:227], v[116:119], v[72:75], v[224:227]
s_mov_b32 s52, 77824
buffer_load_dwordx4 v[72:75], v4, s[16:19], s52 offen offset:0 sc1
s_waitcnt vmcnt(19)
v_mfma_f32_16x16x32_bf16 v[132:135], v[104:107], v[76:79], v[132:135]
v_mfma_f32_16x16x32_bf16 v[164:167], v[108:111], v[76:79], v[164:167]
v_mfma_f32_16x16x32_bf16 v[196:199], v[112:115], v[76:79], v[196:199]
v_mfma_f32_16x16x32_bf16 v[228:231], v[116:119], v[76:79], v[228:231]
buffer_load_dwordx4 v[76:79], v4, s[16:19], s52 offen offset:1024 sc1
s_waitcnt vmcnt(19)
v_mfma_f32_16x16x32_bf16 v[136:139], v[104:107], v[80:83], v[136:139]
v_mfma_f32_16x16x32_bf16 v[168:171], v[108:111], v[80:83], v[168:171]
v_mfma_f32_16x16x32_bf16 v[200:203], v[112:115], v[80:83], v[200:203]
v_mfma_f32_16x16x32_bf16 v[232:235], v[116:119], v[80:83], v[232:235]
buffer_load_dwordx4 v[80:83], v4, s[16:19], s52 offen offset:2048 sc1
s_waitcnt vmcnt(19)
v_mfma_f32_16x16x32_bf16 v[140:143], v[104:107], v[84:87], v[140:143]
ds_read_b32 v121, v120
v_mfma_f32_16x16x32_bf16 v[172:175], v[108:111], v[84:87], v[172:175]
v_mfma_f32_16x16x32_bf16 v[204:207], v[112:115], v[84:87], v[204:207]
v_mfma_f32_16x16x32_bf16 v[236:239], v[116:119], v[84:87], v[236:239]
buffer_load_dwordx4 v[84:87], v4, s[16:19], s52 offen offset:3072 sc1
s_waitcnt vmcnt(19)
v_mfma_f32_16x16x32_bf16 v[144:147], v[104:107], v[8:11], v[144:147]
v_mfma_f32_16x16x32_bf16 v[176:179], v[108:111], v[8:11], v[176:179]
s_waitcnt lgkmcnt(0)
v_readfirstlane_b32 s57, v121
v_mfma_f32_16x16x32_bf16 v[208:211], v[112:115], v[8:11], v[208:211]
s_sub_u32 s57, s57, 0x3030303
v_mfma_f32_16x16x32_bf16 v[240:243], v[116:119], v[8:11], v[240:243]
s_and_b32 s57, s57, 0x80808080
s_cbranch_scc1 L_zs8
L_zf8:
s_mov_b32 s52, 81920
buffer_load_dwordx4 v[8:11], v4, s[16:19], s52 offen offset:0 sc1
s_waitcnt vmcnt(19)
v_mfma_f32_16x16x32_bf16 v[148:151], v[104:107], v[12:15], v[148:151]
ds_read_b128 v[88:91], v4 offset:32768
v_mfma_f32_16x16x32_bf16 v[180:183], v[108:111], v[12:15], v[180:183]
ds_read_b128 v[92:95], v4 offset:33792
v_mfma_f32_16x16x32_bf16 v[212:215], v[112:115], v[12:15], v[212:215]
ds_read_b128 v[96:99], v4 offset:34816
v_mfma_f32_16x16x32_bf16 v[244:247], v[116:119], v[12:15], v[244:247]
ds_read_b128 v[100:103], v4 offset:35840
buffer_load_dwordx4 v[12:15], v4, s[16:19], s52 offen offset:1024 sc1
s_waitcnt vmcnt(19)
v_mfma_f32_16x16x32_bf16 v[152:155], v[104:107], v[16:19], v[152:155]
v_mfma_f32_16x16x32_bf16 v[184:187], v[108:111], v[16:19], v[184:187]
v_mfma_f32_16x16x32_bf16 v[216:219], v[112:115], v[16:19], v[216:219]
v_mfma_f32_16x16x32_bf16 v[248:251], v[116:119], v[16:19], v[248:251]
buffer_load_dwordx4 v[16:19], v4, s[16:19], s52 offen offset:2048 sc1
s_waitcnt vmcnt(19)
v_mfma_f32_16x16x32_bf16 v[156:159], v[104:107], v[20:23], v[156:159]
v_mfma_f32_16x16x32_bf16 v[188:191], v[108:111], v[20:23], v[188:191]
v_mfma_f32_16x16x32_bf16 v[220:223], v[112:115], v[20:23], v[220:223]
v_mfma_f32_16x16x32_bf16 v[252:255], v[116:119], v[20:23], v[252:255]
buffer_load_dwordx4 v[20:23], v4, s[16:19], s52 offen offset:3072 sc1
s_waitcnt lgkmcnt(0)
s_waitcnt vmcnt(19)
v_mfma_f32_16x16x32_bf16 v[128:131], v[88:91], v[24:27], v[128:131]
v_mfma_f32_16x16x32_bf16 v[160:163], v[92:95], v[24:27], v[160:163]
v_mfma_f32_16x16x32_bf16 v[192:195], v[96:99], v[24:27], v[192:195]
v_mfma_f32_16x16x32_bf16 v[224:227], v[100:103], v[24:27], v[224:227]
s_mov_b32 s52, 86016
buffer_load_dwordx4 v[24:27], v4, s[16:19], s52 offen offset:0 sc1
s_waitcnt vmcnt(19)
v_mfma_f32_16x16x32_bf16 v[132:135], v[88:91], v[28:31], v[132:135]
v_mfma_f32_16x16x32_bf16 v[164:167], v[92:95], v[28:31], v[164:167]
v_mfma_f32_16x16x32_bf16 v[196:199], v[96:99], v[28:31], v[196:199]
v_mfma_f32_16x16x32_bf16 v[228:231], v[100:103], v[28:31], v[228:231]
buffer_load_dwordx4 v[28:31], v4, s[16:19], s52 offen offset:1024 sc1
s_waitcnt vmcnt(19)
v_mfma_f32_16x16x32_bf16 v[136:139], v[88:91], v[32:35], v[136:139]
ds_read_b128 v[104:107], v4 offset:36864
v_mfma_f32_16x16x32_bf16 v[168:171], v[92:95], v[32:35], v[168:171]
ds_read_b128 v[108:111], v4 offset:37888
v_mfma_f32_16x16x32_bf16 v[200:203], v[96:99], v[32:35], v[200:203]
ds_read_b128 v[112:115], v4 offset:38912
v_mfma_f32_16x16x32_bf16 v[232:235], v[100:103], v[32:35], v[232:235]
ds_read_b128 v[116:119], v4 offset:39936
buffer_load_dwordx4 v[32:35], v4, s[16:19], s52 offen offset:2048 sc1
s_waitcnt vmcnt(19)
v_mfma_f32_16x16x32_bf16 v[140:143], v[88:91], v[36:39], v[140:143]
v_mfma_f32_16x16x32_bf16 v[172:175], v[92:95], v[36:39], v[172:175]
v_mfma_f32_16x16x32_bf16 v[204:207], v[96:99], v[36:39], v[204:207]
v_mfma_f32_16x16x32_bf16 v[236:239], v[100:103], v[36:39], v[236:239]
buffer_load_dwordx4 v[36:39], v4, s[16:19], s52 offen offset:3072 sc1
s_waitcnt vmcnt(19)
v_mfma_f32_16x16x32_bf16 v[144:147], v[88:91], v[40:43], v[144:147]
v_mfma_f32_16x16x32_bf16 v[176:179], v[92:95], v[40:43], v[176:179]
v_mfma_f32_16x16x32_bf16 v[208:211], v[96:99], v[40:43], v[208:211]
v_mfma_f32_16x16x32_bf16 v[240:243], v[100:103], v[40:43], v[240:243]
s_mov_b32 s52, 90112
buffer_load_dwordx4 v[40:43], v4, s[16:19], s52 offen offset:0 sc1
s_waitcnt vmcnt(19)
v_mfma_f32_16x16x32_bf16 v[148:151], v[88:91], v[44:47], v[148:151]
v_mfma_f32_16x16x32_bf16 v[180:183], v[92:95], v[44:47], v[180:183]
v_mfma_f32_16x16x32_bf16 v[212:215], v[96:99], v[44:47], v[212:215]
v_mfma_f32_16x16x32_bf16 v[244:247], v[100:103], v[44:47], v[244:247]
buffer_load_dwordx4 v[44:47], v4, s[16:19], s52 offen offset:1024 sc1
s_waitcnt vmcnt(19)
v_mfma_f32_16x16x32_bf16 v[152:155], v[88:91], v[48:51], v[152:155]
v_mfma_f32_16x16x32_bf16 v[184:187], v[92:95], v[48:51], v[184:187]
v_mfma_f32_16x16x32_bf16 v[216:219], v[96:99], v[48:51], v[216:219]
v_mfma_f32_16x16x32_bf16 v[248:251], v[100:103], v[48:51], v[248:251]
buffer_load_dwordx4 v[48:51], v4, s[16:19], s52 offen offset:2048 sc1
s_waitcnt vmcnt(19)
v_mfma_f32_16x16x32_bf16 v[156:159], v[88:91], v[52:55], v[156:159]
v_mfma_f32_16x16x32_bf16 v[188:191], v[92:95], v[52:55], v[188:191]
v_mfma_f32_16x16x32_bf16 v[220:223], v[96:99], v[52:55], v[220:223]
v_mfma_f32_16x16x32_bf16 v[252:255], v[100:103], v[52:55], v[252:255]
buffer_load_dwordx4 v[52:55], v4, s[16:19], s52 offen offset:3072 sc1
s_waitcnt lgkmcnt(0)
s_waitcnt vmcnt(19)
v_mfma_f32_16x16x32_bf16 v[128:131], v[104:107], v[56:59], v[128:131]
v_mfma_f32_16x16x32_bf16 v[160:163], v[108:111], v[56:59], v[160:163]
v_mfma_f32_16x16x32_bf16 v[192:195], v[112:115], v[56:59], v[192:195]
v_mfma_f32_16x16x32_bf16 v[224:227], v[116:119], v[56:59], v[224:227]
s_mov_b32 s52, 94208
buffer_load_dwordx4 v[56:59], v4, s[16:19], s52 offen offset:0 sc1
s_waitcnt vmcnt(19)
v_mfma_f32_16x16x32_bf16 v[132:135], v[104:107], v[60:63], v[132:135]
v_mfma_f32_16x16x32_bf16 v[164:167], v[108:111], v[60:63], v[164:167]
v_mfma_f32_16x16x32_bf16 v[196:199], v[112:115], v[60:63], v[196:199]
v_mfma_f32_16x16x32_bf16 v[228:231], v[116:119], v[60:63], v[228:231]
buffer_load_dwordx4 v[60:63], v4, s[16:19], s52 offen offset:1024 sc1
s_waitcnt vmcnt(19)
v_mfma_f32_16x16x32_bf16 v[136:139], v[104:107], v[64:67], v[136:139]
ds_read_b128 v[88:91], v4 offset:40960
v_mfma_f32_16x16x32_bf16 v[168:171], v[108:111], v[64:67], v[168:171]
ds_read_b128 v[92:95], v4 offset:41984
v_mfma_f32_16x16x32_bf16 v[200:203], v[112:115], v[64:67], v[200:203]
ds_read_b128 v[96:99], v4 offset:43008
v_mfma_f32_16x16x32_bf16 v[232:235], v[116:119], v[64:67], v[232:235]
ds_read_b128 v[100:103], v4 offset:44032
buffer_load_dwordx4 v[64:67], v4, s[16:19], s52 offen offset:2048 sc1
s_waitcnt vmcnt(19)
v_mfma_f32_16x16x32_bf16 v[140:143], v[104:107], v[68:71], v[140:143]
v_mfma_f32_16x16x32_bf16 v[172:175], v[108:111], v[68:71], v[172:175]
v_mfma_f32_16x16x32_bf16 v[204:207], v[112:115], v[68:71], v[204:207]
v_mfma_f32_16x16x32_bf16 v[236:239], v[116:119], v[68:71], v[236:239]
buffer_load_dwordx4 v[68:71], v4, s[16:19], s52 offen offset:3072 sc1
s_waitcnt vmcnt(19)
v_mfma_f32_16x16x32_bf16 v[144:147], v[104:107], v[72:75], v[144:147]
v_mfma_f32_16x16x32_bf16 v[176:179], v[108:111], v[72:75], v[176:179]
v_mfma_f32_16x16x32_bf16 v[208:211], v[112:115], v[72:75], v[208:211]
v_mfma_f32_16x16x32_bf16 v[240:243], v[116:119], v[72:75], v[240:243]
s_mov_b32 s52, 98304
buffer_load_dwordx4 v[72:75], v4, s[16:19], s52 offen offset:0 sc1
s_waitcnt vmcnt(19)
v_mfma_f32_16x16x32_bf16 v[148:151], v[104:107], v[76:79], v[148:151]
v_mfma_f32_16x16x32_bf16 v[180:183], v[108:111], v[76:79], v[180:183]
v_mfma_f32_16x16x32_bf16 v[212:215], v[112:115], v[76:79], v[212:215]
v_mfma_f32_16x16x32_bf16 v[244:247], v[116:119], v[76:79], v[244:247]
buffer_load_dwordx4 v[76:79], v4, s[16:19], s52 offen offset:1024 sc1
s_waitcnt vmcnt(19)
v_mfma_f32_16x16x32_bf16 v[152:155], v[104:107], v[80:83], v[152:155]
v_mfma_f32_16x16x32_bf16 v[184:187], v[108:111], v[80:83], v[184:187]
v_mfma_f32_16x16x32_bf16 v[216:219], v[112:115], v[80:83], v[216:219]
v_mfma_f32_16x16x32_bf16 v[248:251], v[116:119], v[80:83], v[248:251]
buffer_load_dwordx4 v[80:83], v4, s[16:19], s52 offen offset:2048 sc1
s_waitcnt vmcnt(19)
v_mfma_f32_16x16x32_bf16 v[156:159], v[104:107], v[84:87], v[156:159]
v_mfma_f32_16x16x32_bf16 v[188:191], v[108:111], v[84:87], v[188:191]
v_mfma_f32_16x16x32_bf16 v[220:223], v[112:115], v[84:87], v[220:223]
v_mfma_f32_16x16x32_bf16 v[252:255], v[116:119], v[84:87], v[252:255]
buffer_load_dwordx4 v[84:87], v4, s[16:19], s52 offen offset:3072 sc1
s_waitcnt lgkmcnt(0)
s_waitcnt vmcnt(19)
v_mfma_f32_16x16x32_bf16 v[128:131], v[88:91], v[8:11], v[128:131]
v_mfma_f32_16x16x32_bf16 v[160:163], v[92:95], v[8:11], v[160:163]
v_mfma_f32_16x16x32_bf16 v[192:195], v[96:99], v[8:11], v[192:195]
v_mfma_f32_16x16x32_bf16 v[224:227], v[100:103], v[8:11], v[224:227]
s_mov_b32 s52, 102400
buffer_load_dwordx4 v[8:11], v4, s[16:19], s52 offen offset:0 sc1
s_waitcnt vmcnt(19)
v_mfma_f32_16x16x32_bf16 v[132:135], v[88:91], v[12:15], v[132:135]
v_mfma_f32_16x16x32_bf16 v[164:167], v[92:95], v[12:15], v[164:167]
v_mfma_f32_16x16x32_bf16 v[196:199], v[96:99], v[12:15], v[196:199]
v_mfma_f32_16x16x32_bf16 v[228:231], v[100:103], v[12:15], v[228:231]
buffer_load_dwordx4 v[12:15], v4, s[16:19], s52 offen offset:1024 sc1
s_waitcnt vmcnt(19)
v_mfma_f32_16x16x32_bf16 v[136:139], v[88:91], v[16:19], v[136:139]
ds_read_b128 v[104:107], v4 offset:45056
v_mfma_f32_16x16x32_bf16 v[168:171], v[92:95], v[16:19], v[168:171]
ds_read_b128 v[108:111], v4 offset:46080
v_mfma_f32_16x16x32_bf16 v[200:203], v[96:99], v[16:19], v[200:203]
ds_read_b128 v[112:115], v4 offset:47104
v_mfma_f32_16x16x32_bf16 v[232:235], v[100:103], v[16:19], v[232:235]
ds_read_b128 v[116:119], v4 offset:48128
buffer_load_dwordx4 v[16:19], v4, s[16:19], s52 offen offset:2048 sc1
s_waitcnt vmcnt(19)
v_mfma_f32_16x16x32_bf16 v[140:143], v[88:91], v[20:23], v[140:143]
v_mfma_f32_16x16x32_bf16 v[172:175], v[92:95], v[20:23], v[172:175]
v_mfma_f32_16x16x32_bf16 v[204:207], v[96:99], v[20:23], v[204:207]
v_mfma_f32_16x16x32_bf16 v[236:239], v[100:103], v[20:23], v[236:239]
buffer_load_dwordx4 v[20:23], v4, s[16:19], s52 offen offset:3072 sc1
s_waitcnt vmcnt(19)
v_mfma_f32_16x16x32_bf16 v[144:147], v[88:91], v[24:27], v[144:147]
v_mfma_f32_16x16x32_bf16 v[176:179], v[92:95], v[24:27], v[176:179]
v_mfma_f32_16x16x32_bf16 v[208:211], v[96:99], v[24:27], v[208:211]
v_mfma_f32_16x16x32_bf16 v[240:243], v[100:103], v[24:27], v[240:243]
s_mov_b32 s52, 106496
buffer_load_dwordx4 v[24:27], v4, s[16:19], s52 offen offset:0 sc1
s_waitcnt vmcnt(19)
v_mfma_f32_16x16x32_bf16 v[148:151], v[88:91], v[28:31], v[148:151]
v_mfma_f32_16x16x32_bf16 v[180:183], v[92:95], v[28:31], v[180:183]
v_mfma_f32_16x16x32_bf16 v[212:215], v[96:99], v[28:31], v[212:215]
v_mfma_f32_16x16x32_bf16 v[244:247], v[100:103], v[28:31], v[244:247]
buffer_load_dwordx4 v[28:31], v4, s[16:19], s52 offen offset:1024 sc1
s_waitcnt vmcnt(19)
v_mfma_f32_16x16x32_bf16 v[152:155], v[88:91], v[32:35], v[152:155]
v_mfma_f32_16x16x32_bf16 v[184:187], v[92:95], v[32:35], v[184:187]
v_mfma_f32_16x16x32_bf16 v[216:219], v[96:99], v[32:35], v[216:219]
v_mfma_f32_16x16x32_bf16 v[248:251], v[100:103], v[32:35], v[248:251]
buffer_load_dwordx4 v[32:35], v4, s[16:19], s52 offen offset:2048 sc1
s_waitcnt vmcnt(19)
v_mfma_f32_16x16x32_bf16 v[156:159], v[88:91], v[36:39], v[156:159]
v_mfma_f32_16x16x32_bf16 v[188:191], v[92:95], v[36:39], v[188:191]
v_mfma_f32_16x16x32_bf16 v[220:223], v[96:99], v[36:39], v[220:223]
v_mfma_f32_16x16x32_bf16 v[252:255], v[100:103], v[36:39], v[252:255]
buffer_load_dwordx4 v[36:39], v4, s[16:19], s52 offen offset:3072 sc1
s_waitcnt lgkmcnt(0)
s_waitcnt vmcnt(19)
v_mfma_f32_16x16x32_bf16 v[128:131], v[104:107], v[40:43], v[128:131]
v_mfma_f32_16x16x32_bf16 v[160:163], v[108:111], v[40:43], v[160:163]
v_mfma_f32_16x16x32_bf16 v[192:195], v[112:115], v[40:43], v[192:195]
v_mfma_f32_16x16x32_bf16 v[224:227], v[116:119], v[40:43], v[224:227]
s_mov_b32 s52, 110592
buffer_load_dwordx4 v[40:43], v4, s[16:19], s52 offen offset:0 sc1
s_waitcnt vmcnt(19)
v_mfma_f32_16x16x32_bf16 v[132:135], v[104:107], v[44:47], v[132:135]
v_mfma_f32_16x16x32_bf16 v[164:167], v[108:111], v[44:47], v[164:167]
v_mfma_f32_16x16x32_bf16 v[196:199], v[112:115], v[44:47], v[196:199]
v_mfma_f32_16x16x32_bf16 v[228:231], v[116:119], v[44:47], v[228:231]
buffer_load_dwordx4 v[44:47], v4, s[16:19], s52 offen offset:1024 sc1
s_waitcnt vmcnt(19)
v_mfma_f32_16x16x32_bf16 v[136:139], v[104:107], v[48:51], v[136:139]
v_mfma_f32_16x16x32_bf16 v[168:171], v[108:111], v[48:51], v[168:171]
v_mfma_f32_16x16x32_bf16 v[200:203], v[112:115], v[48:51], v[200:203]
v_mfma_f32_16x16x32_bf16 v[232:235], v[116:119], v[48:51], v[232:235]
buffer_load_dwordx4 v[48:51], v4, s[16:19], s52 offen offset:2048 sc1
s_waitcnt vmcnt(19)
v_mfma_f32_16x16x32_bf16 v[140:143], v[104:107], v[52:55], v[140:143]
ds_read_b32 v121, v120
v_mfma_f32_16x16x32_bf16 v[172:175], v[108:111], v[52:55], v[172:175]
v_mfma_f32_16x16x32_bf16 v[204:207], v[112:115], v[52:55], v[204:207]
v_mfma_f32_16x16x32_bf16 v[236:239], v[116:119], v[52:55], v[236:239]
buffer_load_dwordx4 v[52:55], v4, s[16:19], s52 offen offset:3072 sc1
s_waitcnt vmcnt(19)
v_mfma_f32_16x16x32_bf16 v[144:147], v[104:107], v[56:59], v[144:147]
v_mfma_f32_16x16x32_bf16 v[176:179], v[108:111], v[56:59], v[176:179]
s_waitcnt lgkmcnt(0)
v_readfirstlane_b32 s57, v121
v_mfma_f32_16x16x32_bf16 v[208:211], v[112:115], v[56:59], v[208:211]
s_sub_u32 s57, s57, 0x4040404
v_mfma_f32_16x16x32_bf16 v[240:243], v[116:119], v[56:59], v[240:243]
s_and_b32 s57, s57, 0x80808080
s_cbranch_scc1 L_zs12
L_zf12:
s_mov_b32 s52, 114688
buffer_load_dwordx4 v[56:59], v4, s[16:19], s52 offen offset:0 sc1
s_waitcnt vmcnt(19)
v_mfma_f32_16x16x32_bf16 v[148:151], v[104:107], v[60:63], v[148:151]
ds_read_b128 v[88:91], v4 offset:49152
v_mfma_f32_16x16x32_bf16 v[180:183], v[108:111], v[60:63], v[180:183]
ds_read_b128 v[92:95], v4 offset:50176
v_mfma_f32_16x16x32_bf16 v[212:215], v[112:115], v[60:63], v[212:215]
ds_read_b128 v[96:99], v4 offset:51200
v_mfma_f32_16x16x32_bf16 v[244:247], v[116:119], v[60:63], v[244:247]
ds_read_b128 v[100:103], v4 offset:52224
buffer_load_dwordx4 v[60:63], v4, s[16:19], s52 offen offset:1024 sc1
s_waitcnt vmcnt(19)
v_mfma_f32_16x16x32_bf16 v[152:155], v[104:107], v[64:67], v[152:155]
v_mfma_f32_16x16x32_bf16 v[184:187], v[108:111], v[64:67], v[184:187]
v_mfma_f32_16x16x32_bf16 v[216:219], v[112:115], v[64:67], v[216:219]
v_mfma_f32_16x16x32_bf16 v[248:251], v[116:119], v[64:67], v[248:251]
buffer_load_dwordx4 v[64:67], v4, s[16:19], s52 offen offset:2048 sc1
s_waitcnt vmcnt(19)
v_mfma_f32_16x16x32_bf16 v[156:159], v[104:107], v[68:71], v[156:159]
v_mfma_f32_16x16x32_bf16 v[188:191], v[108:111], v[68:71], v[188:191]
v_mfma_f32_16x16x32_bf16 v[220:223], v[112:115], v[68:71], v[220:223]
v_mfma_f32_16x16x32_bf16 v[252:255], v[116:119], v[68:71], v[252:255]
buffer_load_dwordx4 v[68:71], v4, s[16:19], s52 offen offset:3072 sc1
s_waitcnt lgkmcnt(0)
s_waitcnt vmcnt(19)
v_mfma_f32_16x16x32_bf16 v[128:131], v[88:91], v[72:75], v[128:131]
v_mfma_f32_16x16x32_bf16 v[160:163], v[92:95], v[72:75], v[160:163]
v_mfma_f32_16x16x32_bf16 v[192:195], v[96:99], v[72:75], v[192:195]
v_mfma_f32_16x16x32_bf16 v[224:227], v[100:103], v[72:75], v[224:227]
s_mov_b32 s52, 118784
buffer_load_dwordx4 v[72:75], v4, s[16:19], s52 offen offset:0 sc1
s_waitcnt vmcnt(19)
v_mfma_f32_16x16x32_bf16 v[132:135], v[88:91], v[76:79], v[132:135]
v_mfma_f32_16x16x32_bf16 v[164:167], v[92:95], v[76:79], v[164:167]
v_mfma_f32_16x16x32_bf16 v[196:199], v[96:99], v[76:79], v[196:199]
v_mfma_f32_16x16x32_bf16 v[228:231], v[100:103], v[76:79], v[228:231]
buffer_load_dwordx4 v[76:79], v4, s[16:19], s52 offen offset:1024 sc1
s_waitcnt vmcnt(19)
v_mfma_f32_16x16x32_bf16 v[136:139], v[88:91], v[80:83], v[136:139]
ds_read_b128 v[104:107], v4 offset:53248
v_mfma_f32_16x16x32_bf16 v[168:171], v[92:95], v[80:83], v[168:171]
ds_read_b128 v[108:111], v4 offset:54272
v_mfma_f32_16x16x32_bf16 v[200:203], v[96:99], v[80:83], v[200:203]
ds_read_b128 v[112:115], v4 offset:55296
v_mfma_f32_16x16x32_bf16 v[232:235], v[100:103], v[80:83], v[232:235]
ds_read_b128 v[116:119], v4 offset:56320
buffer_load_dwordx4 v[80:83], v4, s[16:19], s52 offen offset:2048 sc1
s_waitcnt vmcnt(19)
v_mfma_f32_16x16x32_bf16 v[140:143], v[88:91], v[84:87], v[140:143]
v_mfma_f32_16x16x32_bf16 v[172:175], v[92:95], v[84:87], v[172:175]
v_mfma_f32_16x16x32_bf16 v[204:207], v[96:99], v[84:87], v[204:207]
v_mfma_f32_16x16x32_bf16 v[236:239], v[100:103], v[84:87], v[236:239]
buffer_load_dwordx4 v[84:87], v4, s[16:19], s52 offen offset:3072 sc1
s_waitcnt vmcnt(19)
v_mfma_f32_16x16x32_bf16 v[144:147], v[88:91], v[8:11], v[144:147]
v_mfma_f32_16x16x32_bf16 v[176:179], v[92:95], v[8:11], v[176:179]
v_mfma_f32_16x16x32_bf16 v[208:211], v[96:99], v[8:11], v[208:211]
v_mfma_f32_16x16x32_bf16 v[240:243], v[100:103], v[8:11], v[240:243]
s_mov_b32 s52, 122880
buffer_load_dwordx4 v[8:11], v4, s[16:19], s52 offen offset:0 sc1
s_waitcnt vmcnt(19)
v_mfma_f32_16x16x32_bf16 v[148:151], v[88:91], v[12:15], v[148:151]
v_mfma_f32_16x16x32_bf16 v[180:183], v[92:95], v[12:15], v[180:183]
v_mfma_f32_16x16x32_bf16 v[212:215], v[96:99], v[12:15], v[212:215]
v_mfma_f32_16x16x32_bf16 v[244:247], v[100:103], v[12:15], v[244:247]
buffer_load_dwordx4 v[12:15], v4, s[16:19], s52 offen offset:1024 sc1
s_waitcnt vmcnt(19)
v_mfma_f32_16x16x32_bf16 v[152:155], v[88:91], v[16:19], v[152:155]
v_mfma_f32_16x16x32_bf16 v[184:187], v[92:95], v[16:19], v[184:187]
v_mfma_f32_16x16x32_bf16 v[216:219], v[96:99], v[16:19], v[216:219]
v_mfma_f32_16x16x32_bf16 v[248:251], v[100:103], v[16:19], v[248:251]
buffer_load_dwordx4 v[16:19], v4, s[16:19], s52 offen offset:2048 sc1
s_waitcnt vmcnt(19)
v_mfma_f32_16x16x32_bf16 v[156:159], v[88:91], v[20:23], v[156:159]
v_mfma_f32_16x16x32_bf16 v[188:191], v[92:95], v[20:23], v[188:191]
v_mfma_f32_16x16x32_bf16 v[220:223], v[96:99], v[20:23], v[220:223]
v_mfma_f32_16x16x32_bf16 v[252:255], v[100:103], v[20:23], v[252:255]
buffer_load_dwordx4 v[20:23], v4, s[16:19], s52 offen offset:3072 sc1
s_waitcnt lgkmcnt(0)
s_waitcnt vmcnt(19)
v_mfma_f32_16x16x32_bf16 v[128:131], v[104:107], v[24:27], v[128:131]
v_mfma_f32_16x16x32_bf16 v[160:163], v[108:111], v[24:27], v[160:163]
v_mfma_f32_16x16x32_bf16 v[192:195], v[112:115], v[24:27], v[192:195]
v_mfma_f32_16x16x32_bf16 v[224:227], v[116:119], v[24:27], v[224:227]
s_mov_b32 s52, 126976
buffer_load_dwordx4 v[24:27], v4, s[16:19], s52 offen offset:0 sc1
s_waitcnt vmcnt(19)
v_mfma_f32_16x16x32_bf16 v[132:135], v[104:107], v[28:31], v[132:135]
v_mfma_f32_16x16x32_bf16 v[164:167], v[108:111], v[28:31], v[164:167]
v_mfma_f32_16x16x32_bf16 v[196:199], v[112:115], v[28:31], v[196:199]
v_mfma_f32_16x16x32_bf16 v[228:231], v[116:119], v[28:31], v[228:231]
buffer_load_dwordx4 v[28:31], v4, s[16:19], s52 offen offset:1024 sc1
s_waitcnt vmcnt(19)
v_mfma_f32_16x16x32_bf16 v[136:139], v[104:107], v[32:35], v[136:139]
ds_read_b128 v[88:91], v4 offset:57344
v_mfma_f32_16x16x32_bf16 v[168:171], v[108:111], v[32:35], v[168:171]
ds_read_b128 v[92:95], v4 offset:58368
v_mfma_f32_16x16x32_bf16 v[200:203], v[112:115], v[32:35], v[200:203]
ds_read_b128 v[96:99], v4 offset:59392
v_mfma_f32_16x16x32_bf16 v[232:235], v[116:119], v[32:35], v[232:235]
ds_read_b128 v[100:103], v4 offset:60416
buffer_load_dwordx4 v[32:35], v4, s[16:19], s52 offen offset:2048 sc1
s_waitcnt vmcnt(19)
v_mfma_f32_16x16x32_bf16 v[140:143], v[104:107], v[36:39], v[140:143]
v_mfma_f32_16x16x32_bf16 v[172:175], v[108:111], v[36:39], v[172:175]
v_mfma_f32_16x16x32_bf16 v[204:207], v[112:115], v[36:39], v[204:207]
v_mfma_f32_16x16x32_bf16 v[236:239], v[116:119], v[36:39], v[236:239]
buffer_load_dwordx4 v[36:39], v4, s[16:19], s52 offen offset:3072 sc1
s_waitcnt vmcnt(19)
v_mfma_f32_16x16x32_bf16 v[144:147], v[104:107], v[40:43], v[144:147]
v_mfma_f32_16x16x32_bf16 v[176:179], v[108:111], v[40:43], v[176:179]
v_mfma_f32_16x16x32_bf16 v[208:211], v[112:115], v[40:43], v[208:211]
v_mfma_f32_16x16x32_bf16 v[240:243], v[116:119], v[40:43], v[240:243]
s_waitcnt vmcnt(18)
v_mfma_f32_16x16x32_bf16 v[148:151], v[104:107], v[44:47], v[148:151]
v_mfma_f32_16x16x32_bf16 v[180:183], v[108:111], v[44:47], v[180:183]
v_mfma_f32_16x16x32_bf16 v[212:215], v[112:115], v[44:47], v[212:215]
v_mfma_f32_16x16x32_bf16 v[244:247], v[116:119], v[44:47], v[244:247]
s_waitcnt vmcnt(17)
v_mfma_f32_16x16x32_bf16 v[152:155], v[104:107], v[48:51], v[152:155]
v_mfma_f32_16x16x32_bf16 v[184:187], v[108:111], v[48:51], v[184:187]
v_mfma_f32_16x16x32_bf16 v[216:219], v[112:115], v[48:51], v[216:219]
v_mfma_f32_16x16x32_bf16 v[248:251], v[116:119], v[48:51], v[248:251]
s_waitcnt vmcnt(16)
v_mfma_f32_16x16x32_bf16 v[156:159], v[104:107], v[52:55], v[156:159]
v_mfma_f32_16x16x32_bf16 v[188:191], v[108:111], v[52:55], v[188:191]
v_mfma_f32_16x16x32_bf16 v[220:223], v[112:115], v[52:55], v[220:223]
v_mfma_f32_16x16x32_bf16 v[252:255], v[116:119], v[52:55], v[252:255]
ds_read_b128 v[104:107], v4 offset:61440
ds_read_b128 v[108:111], v4 offset:62464
ds_read_b128 v[112:115], v4 offset:63488
ds_read_b128 v[116:119], v4 offset:64512
s_waitcnt lgkmcnt(4)
s_waitcnt vmcnt(15)
v_mfma_f32_16x16x32_bf16 v[128:131], v[88:91], v[56:59], v[128:131]
s_waitcnt vmcnt(14)
v_mfma_f32_16x16x32_bf16 v[132:135], v[88:91], v[60:63], v[132:135]
s_waitcnt vmcnt(13)
v_mfma_f32_16x16x32_bf16 v[136:139], v[88:91], v[64:67], v[136:139]
s_waitcnt vmcnt(12)
v_mfma_f32_16x16x32_bf16 v[140:143], v[88:91], v[68:71], v[140:143]
s_waitcnt vmcnt(11)
v_mfma_f32_16x16x32_bf16 v[144:147], v[88:91], v[72:75], v[144:147]
s_waitcnt vmcnt(10)
v_mfma_f32_16x16x32_bf16 v[148:151], v[88:91], v[76:79], v[148:151]
s_waitcnt vmcnt(9)
v_mfma_f32_16x16x32_bf16 v[152:155], v[88:91], v[80:83], v[152:155]
s_waitcnt vmcnt(8)
v_mfma_f32_16x16x32_bf16 v[156:159], v[88:91], v[84:87], v[156:159]
s_waitcnt lgkmcnt(0)
s_waitcnt vmcnt(7)
v_mfma_f32_16x16x32_bf16 v[128:131], v[104:107], v[8:11], v[128:131]
s_waitcnt vmcnt(6)
v_mfma_f32_16x16x32_bf16 v[132:135], v[104:107], v[12:15], v[132:135]
s_waitcnt vmcnt(5)
v_mfma_f32_16x16x32_bf16 v[136:139], v[104:107], v[16:19], v[136:139]
s_waitcnt vmcnt(4)
v_mfma_f32_16x16x32_bf16 v[140:143], v[104:107], v[20:23], v[140:143]
s_waitcnt vmcnt(3)
v_mfma_f32_16x16x32_bf16 v[144:147], v[104:107], v[24:27], v[144:147]
s_waitcnt vmcnt(2)
v_mfma_f32_16x16x32_bf16 v[148:151], v[104:107], v[28:31], v[148:151]
s_waitcnt vmcnt(1)
v_mfma_f32_16x16x32_bf16 v[152:155], v[104:107], v[32:35], v[152:155]
s_waitcnt vmcnt(0)
v_mfma_f32_16x16x32_bf16 v[156:159], v[104:107], v[36:39], v[156:159]
v_mfma_f32_16x16x32_bf16 v[160:163], v[92:95], v[56:59], v[160:163]
v_mfma_f32_16x16x32_bf16 v[164:167], v[92:95], v[60:63], v[164:167]
v_mfma_f32_16x16x32_bf16 v[168:171], v[92:95], v[64:67], v[168:171]
v_mfma_f32_16x16x32_bf16 v[172:175], v[92:95], v[68:71], v[172:175]
v_mfma_f32_16x16x32_bf16 v[176:179], v[92:95], v[72:75], v[176:179]
v_mfma_f32_16x16x32_bf16 v[180:183], v[92:95], v[76:79], v[180:183]
v_mfma_f32_16x16x32_bf16 v[184:187], v[92:95], v[80:83], v[184:187]
v_mfma_f32_16x16x32_bf16 v[188:191], v[92:95], v[84:87], v[188:191]
v_cvt_pk_bf16_f32 v40, v128, v132
v_cvt_pk_bf16_f32 v41, v136, v140
v_cvt_pk_bf16_f32 v42, v144, v148
v_mfma_f32_16x16x32_bf16 v[160:163], v[108:111], v[8:11], v[160:163]
v_cvt_pk_bf16_f32 v43, v152, v156
s_add_u32 s40, s53, 0
buffer_store_dwordx4 v[40:43], v5, s[20:23], s40 offen sc1
v_mfma_f32_16x16x32_bf16 v[164:167], v[108:111], v[12:15], v[164:167]
v_cvt_pk_bf16_f32 v44, v129, v133
v_cvt_pk_bf16_f32 v45, v137, v141
v_cvt_pk_bf16_f32 v46, v145, v149
v_mfma_f32_16x16x32_bf16 v[168:171], v[108:111], v[16:19], v[168:171]
v_cvt_pk_bf16_f32 v47, v153, v157
s_add_u32 s40, s53, 8192
buffer_store_dwordx4 v[44:47], v5, s[20:23], s40 offen sc1
v_mfma_f32_16x16x32_bf16 v[172:175], v[108:111], v[20:23], v[172:175]
v_cvt_pk_bf16_f32 v48, v130, v134
v_cvt_pk_bf16_f32 v49, v138, v142
v_cvt_pk_bf16_f32 v50, v146, v150
v_mfma_f32_16x16x32_bf16 v[176:179], v[108:111], v[24:27], v[176:179]
v_cvt_pk_bf16_f32 v51, v154, v158
s_add_u32 s40, s53, 16384
buffer_store_dwordx4 v[48:51], v5, s[20:23], s40 offen sc1
v_mfma_f32_16x16x32_bf16 v[180:183], v[108:111], v[28:31], v[180:183]
v_cvt_pk_bf16_f32 v52, v131, v135
v_cvt_pk_bf16_f32 v53, v139, v143
v_cvt_pk_bf16_f32 v54, v147, v151
v_mfma_f32_16x16x32_bf16 v[184:187], v[108:111], v[32:35], v[184:187]
v_cvt_pk_bf16_f32 v55, v155, v159
s_add_u32 s40, s53, 24576
buffer_store_dwordx4 v[52:55], v5, s[20:23], s40 offen sc1
v_mfma_f32_16x16x32_bf16 v[188:191], v[108:111], v[36:39], v[188:191]
v_mfma_f32_16x16x32_bf16 v[192:195], v[96:99], v[56:59], v[192:195]
v_mfma_f32_16x16x32_bf16 v[196:199], v[96:99], v[60:63], v[196:199]
v_mfma_f32_16x16x32_bf16 v[200:203], v[96:99], v[64:67], v[200:203]
v_mfma_f32_16x16x32_bf16 v[204:207], v[96:99], v[68:71], v[204:207]
v_mfma_f32_16x16x32_bf16 v[208:211], v[96:99], v[72:75], v[208:211]
v_mfma_f32_16x16x32_bf16 v[212:215], v[96:99], v[76:79], v[212:215]
v_mfma_f32_16x16x32_bf16 v[216:219], v[96:99], v[80:83], v[216:219]
v_mfma_f32_16x16x32_bf16 v[220:223], v[96:99], v[84:87], v[220:223]
v_cvt_pk_bf16_f32 v40, v160, v164
v_cvt_pk_bf16_f32 v41, v168, v172
v_cvt_pk_bf16_f32 v42, v176, v180
v_mfma_f32_16x16x32_bf16 v[192:195], v[112:115], v[8:11], v[192:195]
v_cvt_pk_bf16_f32 v43, v184, v188
s_add_u32 s40, s53, 32768
buffer_store_dwordx4 v[40:43], v5, s[20:23], s40 offen sc1
v_mfma_f32_16x16x32_bf16 v[196:199], v[112:115], v[12:15], v[196:199]
v_cvt_pk_bf16_f32 v44, v161, v165
v_cvt_pk_bf16_f32 v45, v169, v173
v_cvt_pk_bf16_f32 v46, v177, v181
v_mfma_f32_16x16x32_bf16 v[200:203], v[112:115], v[16:19], v[200:203]
v_cvt_pk_bf16_f32 v47, v185, v189
s_add_u32 s40, s53, 40960
buffer_store_dwordx4 v[44:47], v5, s[20:23], s40 offen sc1
v_mfma_f32_16x16x32_bf16 v[204:207], v[112:115], v[20:23], v[204:207]
v_cvt_pk_bf16_f32 v48, v162, v166
v_cvt_pk_bf16_f32 v49, v170, v174
v_cvt_pk_bf16_f32 v50, v178, v182
v_mfma_f32_16x16x32_bf16 v[208:211], v[112:115], v[24:27], v[208:211]
v_cvt_pk_bf16_f32 v51, v186, v190
s_add_u32 s40, s53, 49152
buffer_store_dwordx4 v[48:51], v5, s[20:23], s40 offen sc1
v_mfma_f32_16x16x32_bf16 v[212:215], v[112:115], v[28:31], v[212:215]
v_cvt_pk_bf16_f32 v52, v163, v167
v_cvt_pk_bf16_f32 v53, v171, v175
v_cvt_pk_bf16_f32 v54, v179, v183
v_mfma_f32_16x16x32_bf16 v[216:219], v[112:115], v[32:35], v[216:219]
v_cvt_pk_bf16_f32 v55, v187, v191
s_add_u32 s40, s53, 57344
buffer_store_dwordx4 v[52:55], v5, s[20:23], s40 offen sc1
v_mfma_f32_16x16x32_bf16 v[220:223], v[112:115], v[36:39], v[220:223]
v_mfma_f32_16x16x32_bf16 v[224:227], v[100:103], v[56:59], v[224:227]
v_mfma_f32_16x16x32_bf16 v[228:231], v[100:103], v[60:63], v[228:231]
v_mfma_f32_16x16x32_bf16 v[232:235], v[100:103], v[64:67], v[232:235]
v_mfma_f32_16x16x32_bf16 v[236:239], v[100:103], v[68:71], v[236:239]
v_mfma_f32_16x16x32_bf16 v[240:243], v[100:103], v[72:75], v[240:243]
v_mfma_f32_16x16x32_bf16 v[244:247], v[100:103], v[76:79], v[244:247]
v_mfma_f32_16x16x32_bf16 v[248:251], v[100:103], v[80:83], v[248:251]
v_mfma_f32_16x16x32_bf16 v[252:255], v[100:103], v[84:87], v[252:255]
v_cvt_pk_bf16_f32 v40, v192, v196
v_cvt_pk_bf16_f32 v41, v200, v204
v_cvt_pk_bf16_f32 v42, v208, v212
v_mfma_f32_16x16x32_bf16 v[224:227], v[116:119], v[8:11], v[224:227]
v_cvt_pk_bf16_f32 v43, v216, v220
s_add_u32 s40, s53, 65536
buffer_store_dwordx4 v[40:43], v5, s[20:23], s40 offen sc1
v_mfma_f32_16x16x32_bf16 v[228:231], v[116:119], v[12:15], v[228:231]
v_cvt_pk_bf16_f32 v44, v193, v197
v_cvt_pk_bf16_f32 v45, v201, v205
v_cvt_pk_bf16_f32 v46, v209, v213
v_mfma_f32_16x16x32_bf16 v[232:235], v[116:119], v[16:19], v[232:235]
v_cvt_pk_bf16_f32 v47, v217, v221
s_add_u32 s40, s53, 73728
buffer_store_dwordx4 v[44:47], v5, s[20:23], s40 offen sc1
v_mfma_f32_16x16x32_bf16 v[236:239], v[116:119], v[20:23], v[236:239]
v_cvt_pk_bf16_f32 v48, v194, v198
v_cvt_pk_bf16_f32 v49, v202, v206
v_cvt_pk_bf16_f32 v50, v210, v214
v_mfma_f32_16x16x32_bf16 v[240:243], v[116:119], v[24:27], v[240:243]
v_cvt_pk_bf16_f32 v51, v218, v222
s_add_u32 s40, s53, 81920
buffer_store_dwordx4 v[48:51], v5, s[20:23], s40 offen sc1
v_mfma_f32_16x16x32_bf16 v[244:247], v[116:119], v[28:31], v[244:247]
v_cvt_pk_bf16_f32 v52, v195, v199
v_cvt_pk_bf16_f32 v53, v203, v207
v_cvt_pk_bf16_f32 v54, v211, v215
v_mfma_f32_16x16x32_bf16 v[248:251], v[116:119], v[32:35], v[248:251]
v_cvt_pk_bf16_f32 v55, v219, v223
s_add_u32 s40, s53, 90112
buffer_store_dwordx4 v[52:55], v5, s[20:23], s40 offen sc1
v_mfma_f32_16x16x32_bf16 v[252:255], v[116:119], v[36:39], v[252:255]
s_nop 7
v_cvt_pk_bf16_f32 v88, v224, v228
v_cvt_pk_bf16_f32 v89, v232, v236
v_cvt_pk_bf16_f32 v90, v240, v244
v_cvt_pk_bf16_f32 v91, v248, v252
s_add_u32 s40, s53, 98304
buffer_store_dwordx4 v[88:91], v6, s[20:23], s40 offen sc1
s_endpgm
L_zs0:
s_mov_b32 s41, 0
L_zt0:
ds_read_b32 v121, v120
s_add_u32 s41, s41, 1
s_waitcnt lgkmcnt(0)
v_readfirstlane_b32 s57, v121
s_cmp_gt_u32 s41, 0x100000
s_cbranch_scc1 L_zf0
s_sub_u32 s57, s57, 0x1010101
s_and_b32 s57, s57, 0x80808080
s_cbranch_scc0 L_zf0
s_sleep 1
s_branch L_zt0
L_zs4:
s_mov_b32 s41, 0
L_zt4:
ds_read_b32 v121, v120
s_add_u32 s41, s41, 1
s_waitcnt lgkmcnt(0)
v_readfirstlane_b32 s57, v121
s_cmp_gt_u32 s41, 0x100000
s_cbranch_scc1 L_zf4
s_sub_u32 s57, s57, 0x2020202
s_and_b32 s57, s57, 0x80808080
s_cbranch_scc0 L_zf4
s_sleep 1
s_branch L_zt4
L_zs8:
s_mov_b32 s41, 0
L_zt8:
ds_read_b32 v121, v120
s_add_u32 s41, s41, 1
s_waitcnt lgkmcnt(0)
v_readfirstlane_b32 s57, v121
s_cmp_gt_u32 s41, 0x100000
s_cbranch_scc1 L_zf8
s_sub_u32 s57, s57, 0x3030303
s_and_b32 s57, s57, 0x80808080
s_cbranch_scc0 L_zf8
s_sleep 1
s_branch L_zt8
L_zs12:
s_mov_b32 s41, 0
L_zt12:
ds_read_b32 v121, v120
s_add_u32 s41, s41, 1
s_waitcnt lgkmcnt(0)
v_readfirstlane_b32 s57, v121
s_cmp_gt_u32 s41, 0x100000
s_cbranch_scc1 L_zf12
s_sub_u32 s57, s57, 0x4040404
s_and_b32 s57, s57, 0x80808080
s_cbranch_scc0 L_zf12
s_sleep 1
s_branch L_zt12
L_end:
s_endpgm
L_tiny:
v_min_f32 v168, s48, v136
v_min_f32 v169, s48, v137
s_add_u32 m0, s51, 0
s_nop 0
buffer_load_dwordx4 v0, s[16:19], s56 offen offset:0 sc1 lds
v_min_f32 v170, s48, v138
v_min_f32 v171, s48, v139
v_mfma_f32_16x16x32_bf16 v[152:155], v[8:11], v[208:211], 0
v_min_f32 v172, s48, v140
v_min_f32 v173, s48, v141
v_min_f32 v174, s48, v142
v_min_f32 v175, s48, v143
v_exp_f32 v144, v144
v_exp_f32 v145, v145
v_mfma_f32_16x16x32_bf16 v[156:159], v[12:15], v[208:211], 0
v_exp_f32 v146, v146
v_exp_f32 v147, v147
s_add_u32 m0, s51, 1024
s_nop 0
buffer_load_dwordx4 v0, s[16:19], s57 offen offset:0 sc1 lds
v_exp_f32 v148, v148
v_exp_f32 v149, v149
v_exp_f32 v150, v150
v_exp_f32 v151, v151
v_mfma_f32_16x16x32_bf16 v[160:163], v[24:27], v[208:211], 0
v_cmp_lt_f32 s[64:65], abs(v136), s52
v_cmp_lt_f32 s[66:67], abs(v137), s52
v_cmp_lt_f32 s[86:87], abs(v138), s52
v_cmp_lt_f32 s[88:89], abs(v139), s52
v_cmp_lt_f32 s[90:91], abs(v140), s52
v_cmp_lt_f32 s[92:93], abs(v141), s52
v_mfma_f32_16x16x32_bf16 v[164:167], v[28:31], v[208:211], 0
s_add_u32 m0, s51, 0
s_nop 0
buffer_load_dwordx4 v0, s[16:19], s56 offen offset:2048 sc1 lds
v_cmp_lt_f32 s[94:95], abs(v142), s52
v_cmp_lt_f32 s[96:97], abs(v143), s52
v_exp_f32 v168, v168
v_exp_f32 v169, v169
v_exp_f32 v170, v170
v_exp_f32 v171, v171
v_mfma_f32_16x16x32_bf16 v[152:155], v[16:19], v[212:215], v[152:155]
v_exp_f32 v172, v172
v_exp_f32 v173, v173
v_exp_f32 v174, v174
v_exp_f32 v175, v175
s_add_u32 m0, s51, 1024
s_nop 0
buffer_load_dwordx4 v0, s[16:19], s57 offen offset:2048 sc1 lds
v_add_f32 v144, 1.0, v144
v_add_f32 v145, 1.0, v145
v_mfma_f32_16x16x32_bf16 v[156:159], v[20:23], v[212:215], v[156:159]
v_add_f32 v146, 1.0, v146
v_add_f32 v147, 1.0, v147
v_add_f32 v148, 1.0, v148
v_add_f32 v149, 1.0, v149
v_add_f32 v150, 1.0, v150
v_add_f32 v151, 1.0, v151
v_mfma_f32_16x16x32_bf16 v[160:163], v[32:35], v[212:215], v[160:163]
v_mul_f32 v136, s53, v136
v_mul_f32 v137, s53, v137
s_add_u32 m0, s51, 4096
s_nop 0
buffer_load_dwordx4 v0, s[16:19], s60 offen offset:0 sc1 lds
v_mul_f32 v138, s53, v138
v_mul_f32 v139, s53, v139
v_mul_f32 v140, s53, v140
v_mul_f32 v141, s53, v141
v_mfma_f32_16x16x32_bf16 v[164:167], v[36:39], v[212:215], v[164:167]
v_mul_f32 v142, s53, v142
v_mul_f32 v143, s53, v143
v_fma_f32 v144, v168, v144, v144
v_fma_f32 v145, v169, v145, v145
v_fma_f32 v146, v170, v146, v146
v_fma_f32 v147, v171, v147, v147
v_mfma_f32_16x16x32_bf16 v[188:191], v[224:227], v[8:11], 0
s_add_u32 m0, s51, 5120
s_nop 0
buffer_load_dwordx4 v0, s[16:19], s61 offen offset:0 sc1 lds
v_fma_f32 v148, v172, v148, v148
v_fma_f32 v149, v173, v149, v149
v_fma_f32 v150, v174, v150, v150
v_fma_f32 v151, v175, v151, v151
v_sub_f32 v168, 1.0, v168
v_sub_f32 v169, 1.0, v169
v_mfma_f32_16x16x32_bf16 v[192:195], v[224:227], v[24:27], 0
v_sub_f32 v170, 1.0, v170
v_sub_f32 v171, 1.0, v171
v_sub_f32 v172, 1.0, v172
v_sub_f32 v173, 1.0, v173
s_add_u32 m0, s51, 4096
s_nop 0
buffer_load_dwordx4 v0, s[16:19], s60 offen offset:2048 sc1 lds
v_sub_f32 v174, 1.0, v174
v_sub_f32 v175, 1.0, v175
v_mfma_f32_16x16x32_bf16 v[188:191], v[232:235], v[12:15], v[188:191]
v_rcp_f32 v144, v144
v_rcp_f32 v145, v145
v_rcp_f32 v146, v146
v_rcp_f32 v147, v147
v_rcp_f32 v148, v148
v_rcp_f32 v149, v149
v_mfma_f32_16x16x32_bf16 v[192:195], v[232:235], v[28:31], v[192:195]
v_rcp_f32 v150, v150
v_rcp_f32 v151, v151
s_add_u32 m0, s51, 5120
s_nop 0
buffer_load_dwordx4 v0, s[16:19], s61 offen offset:2048 sc1 lds
v_cndmask_b32 v136, v168, v136, s[64:65]
v_cndmask_b32 v137, v169, v137, s[66:67]
v_cndmask_b32 v138, v170, v138, s[86:87]
v_cndmask_b32 v139, v171, v139, s[88:89]
v_cndmask_b32 v140, v172, v140, s[90:91]
v_cndmask_b32 v141, v173, v141, s[92:93]
v_cndmask_b32 v142, v174, v142, s[94:95]
v_cndmask_b32 v143, v175, v143, s[96:97]
v_mul_f32 v136, v136, v144
v_mul_f32 v137, v137, v145
v_mul_f32 v138, v138, v146
v_mul_f32 v139, v139, v147
v_mul_f32 v140, v140, v148
v_mul_f32 v141, v141, v149
v_mul_f32 v142, v142, v150
v_mul_f32 v143, v143, v151
v_cvt_pk_bf16_f32 v180, v136, v140
v_cvt_pk_bf16_f32 v181, v137, v141
v_cvt_pk_bf16_f32 v182, v138, v142
v_cvt_pk_bf16_f32 v183, v139, v143
ds_write_b128 v6, v[180:183] offset:0
v_min_f32 v168, s48, v152
v_min_f32 v169, s48, v153
v_min_f32 v170, s48, v154
v_min_f32 v171, s48, v155
v_mfma_f32_16x16x32_bf16 v[136:139], v[8:11], v[216:219], 0
v_min_f32 v172, s48, v156
v_min_f32 v173, s48, v157
v_min_f32 v174, s48, v158
v_min_f32 v175, s48, v159
v_exp_f32 v160, v160
v_exp_f32 v161, v161
v_mfma_f32_16x16x32_bf16 v[140:143], v[12:15], v[216:219], 0
v_exp_f32 v162, v162
v_exp_f32 v163, v163
v_exp_f32 v164, v164
v_exp_f32 v165, v165
v_exp_f32 v166, v166
v_exp_f32 v167, v167
v_mfma_f32_16x16x32_bf16 v[144:147], v[24:27], v[216:219], 0
v_cmp_lt_f32 s[64:65], abs(v152), s52
v_cmp_lt_f32 s[66:67], abs(v153), s52
v_cmp_lt_f32 s[86:87], abs(v154), s52
v_cmp_lt_f32 s[88:89], abs(v155), s52
v_cmp_lt_f32 s[90:91], abs(v156), s52
v_cmp_lt_f32 s[92:93], abs(v157), s52
v_mfma_f32_16x16x32_bf16 v[148:151], v[28:31], v[216:219], 0
v_cmp_lt_f32 s[94:95], abs(v158), s52
v_cmp_lt_f32 s[96:97], abs(v159), s52
v_exp_f32 v168, v168
v_exp_f32 v169, v169
v_exp_f32 v170, v170
v_exp_f32 v171, v171
v_mfma_f32_16x16x32_bf16 v[136:139], v[16:19], v[220:223], v[136:139]
v_exp_f32 v172, v172
v_exp_f32 v173, v173
v_exp_f32 v174, v174
v_exp_f32 v175, v175
v_add_f32 v160, 1.0, v160
v_add_f32 v161, 1.0, v161
v_mfma_f32_16x16x32_bf16 v[140:143], v[20:23], v[220:223], v[140:143]
v_add_f32 v162, 1.0, v162
v_add_f32 v163, 1.0, v163
v_add_f32 v164, 1.0, v164
v_add_f32 v165, 1.0, v165
v_add_f32 v166, 1.0, v166
v_add_f32 v167, 1.0, v167
v_mfma_f32_16x16x32_bf16 v[144:147], v[32:35], v[220:223], v[144:147]
v_mul_f32 v152, s53, v152
v_mul_f32 v153, s53, v153
v_mul_f32 v154, s53, v154
v_mul_f32 v155, s53, v155
v_mul_f32 v156, s53, v156
v_mul_f32 v157, s53, v157
v_mfma_f32_16x16x32_bf16 v[148:151], v[36:39], v[220:223], v[148:151]
v_mul_f32 v158, s53, v158
v_mul_f32 v159, s53, v159
v_fma_f32 v160, v168, v160, v160
v_fma_f32 v161, v169, v161, v161
v_fma_f32 v162, v170, v162, v162
v_fma_f32 v163, v171, v163, v163
v_mfma_f32_16x16x32_bf16 v[188:191], v[228:231], v[16:19], v[188:191]
v_fma_f32 v164, v172, v164, v164
v_fma_f32 v165, v173, v165, v165
v_fma_f32 v166, v174, v166, v166
v_fma_f32 v167, v175, v167, v167
v_sub_f32 v168, 1.0, v168
v_sub_f32 v169, 1.0, v169
v_mfma_f32_16x16x32_bf16 v[192:195], v[228:231], v[32:35], v[192:195]
v_sub_f32 v170, 1.0, v170
v_sub_f32 v171, 1.0, v171
v_sub_f32 v172, 1.0, v172
v_sub_f32 v173, 1.0, v173
v_sub_f32 v174, 1.0, v174
v_sub_f32 v175, 1.0, v175
v_mfma_f32_16x16x32_bf16 v[188:191], v[236:239], v[20:23], v[188:191]
v_rcp_f32 v160, v160
v_rcp_f32 v161, v161
v_rcp_f32 v162, v162
v_rcp_f32 v163, v163
v_rcp_f32 v164, v164
v_rcp_f32 v165, v165
v_mfma_f32_16x16x32_bf16 v[192:195], v[236:239], v[36:39], v[192:195]
v_rcp_f32 v166, v166
v_rcp_f32 v167, v167
v_cndmask_b32 v152, v168, v152, s[64:65]
v_cndmask_b32 v153, v169, v153, s[66:67]
v_cndmask_b32 v154, v170, v154, s[86:87]
v_cndmask_b32 v155, v171, v155, s[88:89]
v_cndmask_b32 v156, v172, v156, s[90:91]
v_cndmask_b32 v157, v173, v157, s[92:93]
v_cndmask_b32 v158, v174, v158, s[94:95]
v_cndmask_b32 v159, v175, v159, s[96:97]
v_mul_f32 v152, v152, v160
v_mul_f32 v153, v153, v161
v_mul_f32 v154, v154, v162
v_mul_f32 v155, v155, v163
v_mul_f32 v156, v156, v164
v_mul_f32 v157, v157, v165
v_mul_f32 v158, v158, v166
v_mul_f32 v159, v159, v167
v_cvt_pk_bf16_f32 v184, v152, v156
v_cvt_pk_bf16_f32 v185, v153, v157
v_cvt_pk_bf16_f32 v186, v154, v158
v_cvt_pk_bf16_f32 v187, v155, v159
ds_write_b128 v6, v[184:187] offset:1024
v_min_f32 v168, s48, v188
v_min_f32 v169, s48, v136
v_min_f32 v170, s48, v137
v_min_f32 v171, s48, v138
v_min_f32 v172, s48, v139
v_min_f32 v173, s48, v140
v_min_f32 v174, s48, v141
v_min_f32 v175, s48, v142
v_min_f32 v176, s48, v143
v_exp_f32 v192, v192
v_exp_f32 v144, v144
v_exp_f32 v145, v145
v_exp_f32 v146, v146
v_exp_f32 v147, v147
v_exp_f32 v148, v148
v_exp_f32 v149, v149
v_exp_f32 v150, v150
v_exp_f32 v151, v151
v_cmp_lt_f32 s[64:65], abs(v188), s52
v_cmp_lt_f32 s[66:67], abs(v136), s52
v_cmp_lt_f32 s[86:87], abs(v137), s52
v_cmp_lt_f32 s[88:89], abs(v138), s52
v_cmp_lt_f32 s[90:91], abs(v139), s52
v_cmp_lt_f32 s[92:93], abs(v140), s52
v_cmp_lt_f32 s[94:95], abs(v141), s52
v_cmp_lt_f32 s[96:97], abs(v142), s52
v_cmp_lt_f32 s[98:99], abs(v143), s52
v_exp_f32 v168, v168
v_exp_f32 v169, v169
v_exp_f32 v170, v170
v_exp_f32 v171, v171
v_exp_f32 v172, v172
v_exp_f32 v173, v173
v_exp_f32 v174, v174
v_exp_f32 v175, v175
v_exp_f32 v176, v176
v_add_f32 v192, 1.0, v192
v_add_f32 v144, 1.0, v144
v_add_f32 v145, 1.0, v145
v_add_f32 v146, 1.0, v146
v_add_f32 v147, 1.0, v147
v_add_f32 v148, 1.0, v148
v_add_f32 v149, 1.0, v149
v_add_f32 v150, 1.0, v150
v_add_f32 v151, 1.0, v151
v_mul_f32 v188, s53, v188
v_mul_f32 v136, s53, v136
v_mul_f32 v137, s53, v137
v_mul_f32 v138, s53, v138
v_mul_f32 v139, s53, v139
v_mul_f32 v140, s53, v140
v_mul_f32 v141, s53, v141
v_mul_f32 v142, s53, v142
v_mul_f32 v143, s53, v143
v_fma_f32 v192, v168, v192, v192
v_fma_f32 v144, v169, v144, v144
v_fma_f32 v145, v170, v145, v145
v_fma_f32 v146, v171, v146, v146
v_fma_f32 v147, v172, v147, v147
v_fma_f32 v148, v173, v148, v148
v_fma_f32 v149, v174, v149, v149
v_fma_f32 v150, v175, v150, v150
v_fma_f32 v151, v176, v151, v151
v_sub_f32 v168, 1.0, v168
v_sub_f32 v169, 1.0, v169
v_sub_f32 v170, 1.0, v170
v_sub_f32 v171, 1.0, v171
v_sub_f32 v172, 1.0, v172
v_sub_f32 v173, 1.0, v173
v_sub_f32 v174, 1.0, v174
v_sub_f32 v175, 1.0, v175
v_sub_f32 v176, 1.0, v176
v_rcp_f32 v192, v192
v_rcp_f32 v144, v144
v_rcp_f32 v145, v145
v_rcp_f32 v146, v146
v_rcp_f32 v147, v147
v_rcp_f32 v148, v148
v_rcp_f32 v149, v149
v_rcp_f32 v150, v150
v_rcp_f32 v151, v151
v_cndmask_b32 v188, v168, v188, s[64:65]
v_cndmask_b32 v136, v169, v136, s[66:67]
v_cndmask_b32 v137, v170, v137, s[86:87]
v_cndmask_b32 v138, v171, v138, s[88:89]
v_cndmask_b32 v139, v172, v139, s[90:91]
v_cndmask_b32 v140, v173, v140, s[92:93]
v_cndmask_b32 v141, v174, v141, s[94:95]
v_cndmask_b32 v142, v175, v142, s[96:97]
v_cndmask_b32 v143, v176, v143, s[98:99]
v_mul_f32 v188, v188, v192
v_mul_f32 v136, v136, v144
v_mul_f32 v137, v137, v145
v_mul_f32 v138, v138, v146
v_mul_f32 v139, v139, v147
v_mul_f32 v140, v140, v148
v_mul_f32 v141, v141, v149
v_mul_f32 v142, v142, v150
v_mul_f32 v143, v143, v151
v_cvt_pk_bf16_f32 v168, v188, v188
ds_write_b16 v7, v168 offset:3072
v_cvt_pk_bf16_f32 v180, v136, v140
v_cvt_pk_bf16_f32 v181, v137, v141
v_cvt_pk_bf16_f32 v182, v138, v142
v_cvt_pk_bf16_f32 v183, v139, v143
ds_write_b128 v6, v[180:183] offset:2048
s_mov_b64 exec, 1
ds_add_u32 v240, v241
s_mov_b64 exec, -1
s_waitcnt vmcnt(0)
ds_read_b64 v[40:41], v242 offset:0
ds_read_b64 v[42:43], v242 offset:512
ds_read_b64 v[44:45], v242 offset:1024
ds_read_b64 v[46:47], v242 offset:1536
ds_read_b64 v[56:57], v242 offset:2048
ds_read_b64 v[58:59], v242 offset:2560
ds_read_b64 v[60:61], v242 offset:3072
ds_read_b64 v[62:63], v242 offset:3584
ds_read_b64 v[48:49], v242 offset:4096
ds_read_b64 v[50:51], v242 offset:4608
ds_read_b64 v[52:53], v242 offset:5120
ds_read_b64 v[54:55], v242 offset:5632
ds_read_b64 v[64:65], v242 offset:6144
ds_read_b64 v[66:67], v242 offset:6656
ds_read_b64 v[68:69], v242 offset:7168
ds_read_b64 v[70:71], v242 offset:7680
s_waitcnt lgkmcnt(12)
v_swap_b32 v41, v44
v_swap_b32 v43, v46
s_waitcnt lgkmcnt(8)
v_swap_b32 v57, v60
v_swap_b32 v59, v62
s_waitcnt lgkmcnt(4)
v_swap_b32 v49, v52
v_swap_b32 v51, v54
s_waitcnt lgkmcnt(0)
v_swap_b32 v65, v68
v_swap_b32 v67, v70
s_nop 1
v_mfma_f32_16x16x32_bf16 v[152:155], v[40:43], v[200:203], 0
v_mfma_f32_16x16x32_bf16 v[156:159], v[44:47], v[200:203], 0
v_mfma_f32_16x16x32_bf16 v[160:163], v[56:59], v[200:203], 0
v_mfma_f32_16x16x32_bf16 v[164:167], v[60:63], v[200:203], 0
v_mfma_f32_16x16x32_bf16 v[152:155], v[48:51], v[204:207], v[152:155]
v_mfma_f32_16x16x32_bf16 v[156:159], v[52:55], v[204:207], v[156:159]
v_mfma_f32_16x16x32_bf16 v[160:163], v[64:67], v[204:207], v[160:163]
v_mfma_f32_16x16x32_bf16 v[164:167], v[68:71], v[204:207], v[164:167]
s_nop 7
v_and_b32 v244, 7, v1
v_mul_u32_u24 v244, 4224, v244
s_mov_b32 s42, 177408
s_mov_b64 exec, 0xff
buffer_load_dword v245, v244, s[24:27], s42 offen sc1
s_mov_b64 exec, -1
v_min_f32 v168, s48, v152
v_min_f32 v169, s48, v153
v_min_f32 v170, s48, v154
v_min_f32 v171, s48, v155
v_mfma_f32_16x16x32_bf16 v[136:139], v[40:43], v[208:211], 0
v_min_f32 v172, s48, v156
v_min_f32 v173, s48, v157
v_min_f32 v174, s48, v158
v_min_f32 v175, s48, v159
v_exp_f32 v160, v160
v_exp_f32 v161, v161
v_mfma_f32_16x16x32_bf16 v[140:143], v[44:47], v[208:211], 0
v_exp_f32 v162, v162
v_exp_f32 v163, v163
v_exp_f32 v164, v164
v_exp_f32 v165, v165
v_exp_f32 v166, v166
v_exp_f32 v167, v167
v_mfma_f32_16x16x32_bf16 v[144:147], v[56:59], v[208:211], 0
v_cmp_lt_f32 s[64:65], abs(v152), s52
v_cmp_lt_f32 s[66:67], abs(v153), s52
v_cmp_lt_f32 s[86:87], abs(v154), s52
v_cmp_lt_f32 s[88:89], abs(v155), s52
v_cmp_lt_f32 s[90:91], abs(v156), s52
v_cmp_lt_f32 s[92:93], abs(v157), s52
v_mfma_f32_16x16x32_bf16 v[148:151], v[60:63], v[208:211], 0
v_cmp_lt_f32 s[94:95], abs(v158), s52
v_cmp_lt_f32 s[96:97], abs(v159), s52
v_exp_f32 v168, v168
v_exp_f32 v169, v169
v_exp_f32 v170, v170
v_exp_f32 v171, v171
v_mfma_f32_16x16x32_bf16 v[136:139], v[48:51], v[212:215], v[136:139]
v_exp_f32 v172, v172
v_exp_f32 v173, v173
v_exp_f32 v174, v174
v_exp_f32 v175, v175
v_add_f32 v160, 1.0, v160
v_add_f32 v161, 1.0, v161
v_mfma_f32_16x16x32_bf16 v[140:143], v[52:55], v[212:215], v[140:143]
v_add_f32 v162, 1.0, v162
v_add_f32 v163, 1.0, v163
v_add_f32 v164, 1.0, v164
v_add_f32 v165, 1.0, v165
v_add_f32 v166, 1.0, v166
v_add_f32 v167, 1.0, v167
v_mfma_f32_16x16x32_bf16 v[144:147], v[64:67], v[212:215], v[144:147]
v_mul_f32 v152, s53, v152
v_mul_f32 v153, s53, v153
v_mul_f32 v154, s53, v154
v_mul_f32 v155, s53, v155
v_mul_f32 v156, s53, v156
v_mul_f32 v157, s53, v157
v_mfma_f32_16x16x32_bf16 v[148:151], v[68:71], v[212:215], v[148:151]
v_mul_f32 v158, s53, v158
v_mul_f32 v159, s53, v159
v_fma_f32 v160, v168, v160, v160
v_fma_f32 v161, v169, v161, v161
v_fma_f32 v162, v170, v162, v162
v_fma_f32 v163, v171, v163, v163
v_mfma_f32_16x16x32_bf16 v[188:191], v[224:227], v[40:43], 0
v_fma_f32 v164, v172, v164, v164
v_fma_f32 v165, v173, v165, v165
v_fma_f32 v166, v174, v166, v166
v_fma_f32 v167, v175, v167, v167
v_sub_f32 v168, 1.0, v168
v_sub_f32 v169, 1.0, v169
v_mfma_f32_16x16x32_bf16 v[192:195], v[224:227], v[56:59], 0
v_sub_f32 v170, 1.0, v170
v_sub_f32 v171, 1.0, v171
v_sub_f32 v172, 1.0, v172
v_sub_f32 v173, 1.0, v173
v_sub_f32 v174, 1.0, v174
v_sub_f32 v175, 1.0, v175
v_mfma_f32_16x16x32_bf16 v[188:191], v[232:235], v[44:47], v[188:191]
v_rcp_f32 v160, v160
v_rcp_f32 v161, v161
v_rcp_f32 v162, v162
v_rcp_f32 v163, v163
v_rcp_f32 v164, v164
v_rcp_f32 v165, v165
v_mfma_f32_16x16x32_bf16 v[192:195], v[232:235], v[60:63], v[192:195]
v_rcp_f32 v166, v166
v_rcp_f32 v167, v167
v_cndmask_b32 v152, v168, v152, s[64:65]
v_cndmask_b32 v153, v169, v153, s[66:67]
v_cndmask_b32 v154, v170, v154, s[86:87]
v_cndmask_b32 v155, v171, v155, s[88:89]
v_cndmask_b32 v156, v172, v156, s[90:91]
v_cndmask_b32 v157, v173, v157, s[92:93]
v_cndmask_b32 v158, v174, v158, s[94:95]
v_cndmask_b32 v159, v175, v159, s[96:97]
v_mul_f32 v152, v152, v160
v_mul_f32 v153, v153, v161
v_mul_f32 v154, v154, v162
v_mul_f32 v155, v155, v163
v_mul_f32 v156, v156, v164
v_mul_f32 v157, v157, v165
v_mul_f32 v158, v158, v166
v_mul_f32 v159, v159, v167
v_cvt_pk_bf16_f32 v184, v152, v156
v_cvt_pk_bf16_f32 v185, v153, v157
v_cvt_pk_bf16_f32 v186, v154, v158
v_cvt_pk_bf16_f32 v187, v155, v159
ds_write_b128 v6, v[184:187] offset:16384
s_waitcnt vmcnt(0)
s_mov_b64 exec, 0xff
v_cmp_ne_u32 vcc, 1, v245
s_mov_b64 exec, -1
s_nop 0
s_and_b32 s54, vcc_lo, 0xaa
s_and_b32 s40, vcc_lo, 0x55
s_cbranch_scc0 L_pd4t
v_and_b32 v244, 7, v1
v_mul_u32_u24 v244, 4224, v244
s_mov_b32 s42, 177408
s_mov_b32 s41, 0
s_mov_b64 exec, 0x55
L_pl4t:
buffer_load_dword v245, v244, s[24:27], s42 offen sc1
s_add_u32 s41, s41, 1
s_cmp_gt_u32 s41, 0x8000
s_cbranch_scc1 L_px4t
s_waitcnt vmcnt(0)
v_cmp_ne_u32 vcc, 1, v245
s_nop 1
s_cbranch_vccz L_px4t
s_sleep 1
s_branch L_pl4t
L_px4t:
s_mov_b64 exec, -1
L_pd4t:
v_min_f32 v168, s48, v136
v_min_f32 v169, s48, v137
s_add_u32 m0, s51, 31232
s_nop 0
buffer_load_dwordx4 v0, s[16:19], s56 offen offset:1536 sc1 lds
v_min_f32 v170, s48, v138
v_min_f32 v171, s48, v139
v_mfma_f32_16x16x32_bf16 v[152:155], v[40:43], v[216:219], 0
v_min_f32 v172, s48, v140
v_min_f32 v173, s48, v141
v_min_f32 v174, s48, v142
v_min_f32 v175, s48, v143
v_exp_f32 v144, v144
v_exp_f32 v145, v145
v_mfma_f32_16x16x32_bf16 v[156:159], v[44:47], v[216:219], 0
v_exp_f32 v146, v146
v_exp_f32 v147, v147
v_exp_f32 v148, v148
v_exp_f32 v149, v149
v_exp_f32 v150, v150
v_exp_f32 v151, v151
v_mfma_f32_16x16x32_bf16 v[160:163], v[56:59], v[216:219], 0
v_cmp_lt_f32 s[64:65], abs(v136), s52
v_cmp_lt_f32 s[66:67], abs(v137), s52
v_cmp_lt_f32 s[86:87], abs(v138), s52
v_cmp_lt_f32 s[88:89], abs(v139), s52
s_add_u32 m0, s51, 32256
s_nop 0
buffer_load_dwordx4 v0, s[16:19], s57 offen offset:1536 sc1 lds
v_cmp_lt_f32 s[90:91], abs(v140), s52
v_cmp_lt_f32 s[92:93], abs(v141), s52
v_mfma_f32_16x16x32_bf16 v[164:167], v[60:63], v[216:219], 0
v_cmp_lt_f32 s[94:95], abs(v142), s52
v_cmp_lt_f32 s[96:97], abs(v143), s52
v_exp_f32 v168, v168
v_exp_f32 v169, v169
v_exp_f32 v170, v170
v_exp_f32 v171, v171
v_mfma_f32_16x16x32_bf16 v[152:155], v[48:51], v[220:223], v[152:155]
v_exp_f32 v172, v172
v_exp_f32 v173, v173
v_exp_f32 v174, v174
v_exp_f32 v175, v175
v_add_f32 v144, 1.0, v144
v_add_f32 v145, 1.0, v145
v_mfma_f32_16x16x32_bf16 v[156:159], v[52:55], v[220:223], v[156:159]
v_add_f32 v146, 1.0, v146
v_add_f32 v147, 1.0, v147
v_add_f32 v148, 1.0, v148
v_add_f32 v149, 1.0, v149
s_add_u32 m0, s51, 31232
s_nop 0
buffer_load_dwordx4 v0, s[16:19], s56 offen offset:3584 sc1 lds
v_add_f32 v150, 1.0, v150
v_add_f32 v151, 1.0, v151
v_mfma_f32_16x16x32_bf16 v[160:163], v[64:67], v[220:223], v[160:163]
v_mul_f32 v136, s53, v136
v_mul_f32 v137, s53, v137
v_mul_f32 v138, s53, v138
v_mul_f32 v139, s53, v139
v_mul_f32 v140, s53, v140
v_mul_f32 v141, s53, v141
v_mfma_f32_16x16x32_bf16 v[164:167], v[68:71], v[220:223], v[164:167]
v_mul_f32 v142, s53, v142
v_mul_f32 v143, s53, v143
v_fma_f32 v144, v168, v144, v144
v_fma_f32 v145, v169, v145, v145
v_fma_f32 v146, v170, v146, v146
v_fma_f32 v147, v171, v147, v147
v_mfma_f32_16x16x32_bf16 v[188:191], v[228:231], v[48:51], v[188:191]
v_fma_f32 v148, v172, v148, v148
v_fma_f32 v149, v173, v149, v149
v_fma_f32 v150, v174, v150, v150
v_fma_f32 v151, v175, v151, v151
s_add_u32 m0, s51, 32256
s_nop 0
buffer_load_dwordx4 v0, s[16:19], s57 offen offset:3584 sc1 lds
v_sub_f32 v168, 1.0, v168
v_sub_f32 v169, 1.0, v169
v_mfma_f32_16x16x32_bf16 v[192:195], v[228:231], v[64:67], v[192:195]
v_sub_f32 v170, 1.0, v170
v_sub_f32 v171, 1.0, v171
v_sub_f32 v172, 1.0, v172
v_sub_f32 v173, 1.0, v173
v_sub_f32 v174, 1.0, v174
v_sub_f32 v175, 1.0, v175
v_mfma_f32_16x16x32_bf16 v[188:191], v[236:239], v[52:55], v[188:191]
v_rcp_f32 v144, v144
v_rcp_f32 v145, v145
v_rcp_f32 v146, v146
v_rcp_f32 v147, v147
v_rcp_f32 v148, v148
v_rcp_f32 v149, v149
v_mfma_f32_16x16x32_bf16 v[192:195], v[236:239], v[68:71], v[192:195]
v_rcp_f32 v150, v150
v_rcp_f32 v151, v151
v_cndmask_b32 v136, v168, v136, s[64:65]
v_cndmask_b32 v137, v169, v137, s[66:67]
s_add_u32 m0, s51, 35328
s_nop 0
buffer_load_dwordx4 v0, s[16:19], s60 offen offset:1536 sc1 lds
v_cndmask_b32 v138, v170, v138, s[86:87]
v_cndmask_b32 v139, v171, v139, s[88:89]
v_cndmask_b32 v140, v172, v140, s[90:91]
v_cndmask_b32 v141, v173, v141, s[92:93]
v_cndmask_b32 v142, v174, v142, s[94:95]
v_cndmask_b32 v143, v175, v143, s[96:97]
v_mul_f32 v136, v136, v144
v_mul_f32 v137, v137, v145
v_mul_f32 v138, v138, v146
v_mul_f32 v139, v139, v147
v_mul_f32 v140, v140, v148
v_mul_f32 v141, v141, v149
v_mul_f32 v142, v142, v150
v_mul_f32 v143, v143, v151
v_cvt_pk_bf16_f32 v180, v136, v140
v_cvt_pk_bf16_f32 v181, v137, v141
v_cvt_pk_bf16_f32 v182, v138, v142
v_cvt_pk_bf16_f32 v183, v139, v143
s_add_u32 m0, s51, 36352
s_nop 0
buffer_load_dwordx4 v0, s[16:19], s61 offen offset:1536 sc1 lds
ds_write_b128 v6, v[180:183] offset:17408
v_min_f32 v168, s48, v188
v_min_f32 v169, s48, v152
s_add_u32 m0, s51, 35328
s_nop 0
buffer_load_dwordx4 v0, s[16:19], s60 offen offset:3584 sc1 lds
v_min_f32 v170, s48, v153
v_min_f32 v171, s48, v154
v_min_f32 v172, s48, v155
v_min_f32 v173, s48, v156
v_min_f32 v174, s48, v157
v_min_f32 v175, s48, v158
v_min_f32 v176, s48, v159
v_exp_f32 v192, v192
v_exp_f32 v160, v160
v_exp_f32 v161, v161
v_exp_f32 v162, v162
v_exp_f32 v163, v163
v_exp_f32 v164, v164
v_exp_f32 v165, v165
v_exp_f32 v166, v166
v_exp_f32 v167, v167
v_cmp_lt_f32 s[64:65], abs(v188), s52
v_cmp_lt_f32 s[66:67], abs(v152), s52
s_add_u32 m0, s51, 36352
s_nop 0
buffer_load_dwordx4 v0, s[16:19], s61 offen offset:3584 sc1 lds
v_cmp_lt_f32 s[86:87], abs(v153), s52
v_cmp_lt_f32 s[88:89], abs(v154), s52
v_cmp_lt_f32 s[90:91], abs(v155), s52
v_cmp_lt_f32 s[92:93], abs(v156), s52
v_cmp_lt_f32 s[94:95], abs(v157), s52
v_cmp_lt_f32 s[96:97], abs(v158), s52
v_cmp_lt_f32 s[98:99], abs(v159), s52
v_exp_f32 v168, v168
v_exp_f32 v169, v169
v_exp_f32 v170, v170
v_exp_f32 v171, v171
v_exp_f32 v172, v172
v_exp_f32 v173, v173
v_exp_f32 v174, v174
v_exp_f32 v175, v175
v_exp_f32 v176, v176
v_add_f32 v192, 1.0, v192
v_add_f32 v160, 1.0, v160
v_add_f32 v161, 1.0, v161
v_add_f32 v162, 1.0, v162
v_add_f32 v163, 1.0, v163
v_add_f32 v164, 1.0, v164
v_add_f32 v165, 1.0, v165
v_add_f32 v166, 1.0, v166
v_add_f32 v167, 1.0, v167
v_mul_f32 v188, s53, v188
v_mul_f32 v152, s53, v152
v_mul_f32 v153, s53, v153
v_mul_f32 v154, s53, v154
v_mul_f32 v155, s53, v155
v_mul_f32 v156, s53, v156
v_mul_f32 v157, s53, v157
v_mul_f32 v158, s53, v158
v_mul_f32 v159, s53, v159
v_fma_f32 v192, v168, v192, v192
v_fma_f32 v160, v169, v160, v160
v_fma_f32 v161, v170, v161, v161
v_fma_f32 v162, v171, v162, v162
v_fma_f32 v163, v172, v163, v163
v_fma_f32 v164, v173, v164, v164
v_fma_f32 v165, v174, v165, v165
v_fma_f32 v166, v175, v166, v166
v_fma_f32 v167, v176, v167, v167
v_sub_f32 v168, 1.0, v168
v_sub_f32 v169, 1.0, v169
v_sub_f32 v170, 1.0, v170
v_sub_f32 v171, 1.0, v171
v_sub_f32 v172, 1.0, v172
v_sub_f32 v173, 1.0, v173
v_sub_f32 v174, 1.0, v174
v_sub_f32 v175, 1.0, v175
v_sub_f32 v176, 1.0, v176
v_rcp_f32 v192, v192
v_rcp_f32 v160, v160
v_rcp_f32 v161, v161
v_rcp_f32 v162, v162
v_rcp_f32 v163, v163
v_rcp_f32 v164, v164
v_rcp_f32 v165, v165
v_rcp_f32 v166, v166
v_rcp_f32 v167, v167
v_cndmask_b32 v188, v168, v188, s[64:65]
v_cndmask_b32 v152, v169, v152, s[66:67]
v_cndmask_b32 v153, v170, v153, s[86:87]
v_cndmask_b32 v154, v171, v154, s[88:89]
v_cndmask_b32 v155, v172, v155, s[90:91]
v_cndmask_b32 v156, v173, v156, s[92:93]
v_cndmask_b32 v157, v174, v157, s[94:95]
v_cndmask_b32 v158, v175, v158, s[96:97]
v_cndmask_b32 v159, v176, v159, s[98:99]
v_mul_f32 v188, v188, v192
v_mul_f32 v152, v152, v160
v_mul_f32 v153, v153, v161
v_mul_f32 v154, v154, v162
v_mul_f32 v155, v155, v163
v_mul_f32 v156, v156, v164
v_mul_f32 v157, v157, v165
v_mul_f32 v158, v158, v166
v_mul_f32 v159, v159, v167
v_cvt_pk_bf16_f32 v168, v188, v188
ds_write_b16 v7, v168 offset:19456
v_cvt_pk_bf16_f32 v184, v152, v156
v_cvt_pk_bf16_f32 v185, v153, v157
v_cvt_pk_bf16_f32 v186, v154, v158
v_cvt_pk_bf16_f32 v187, v155, v159
ds_write_b128 v6, v[184:187] offset:18432
s_mov_b64 exec, 1
ds_add_u32 v240, v241
s_mov_b64 exec, -1
s_waitcnt vmcnt(0)
ds_read_b64 v[72:73], v242 offset:32768
ds_read_b64 v[74:75], v242 offset:33280
ds_read_b64 v[76:77], v242 offset:33792
ds_read_b64 v[78:79], v242 offset:34304
ds_read_b64 v[88:89], v242 offset:34816
ds_read_b64 v[90:91], v242 offset:35328
ds_read_b64 v[92:93], v242 offset:35840
ds_read_b64 v[94:95], v242 offset:36352
ds_read_b64 v[80:81], v242 offset:36864
ds_read_b64 v[82:83], v242 offset:37376
ds_read_b64 v[84:85], v242 offset:37888
ds_read_b64 v[86:87], v242 offset:38400
ds_read_b64 v[96:97], v242 offset:38912
ds_read_b64 v[98:99], v242 offset:39424
ds_read_b64 v[100:101], v242 offset:39936
ds_read_b64 v[102:103], v242 offset:40448
s_waitcnt lgkmcnt(12)
v_swap_b32 v73, v76
v_swap_b32 v75, v78
s_waitcnt lgkmcnt(8)
v_swap_b32 v89, v92
v_swap_b32 v91, v94
s_waitcnt lgkmcnt(4)
v_swap_b32 v81, v84
v_swap_b32 v83, v86
s_waitcnt lgkmcnt(0)
v_swap_b32 v97, v100
v_swap_b32 v99, v102
s_nop 1
v_mfma_f32_16x16x32_bf16 v[136:139], v[72:75], v[200:203], 0
v_mfma_f32_16x16x32_bf16 v[140:143], v[76:79], v[200:203], 0
v_mfma_f32_16x16x32_bf16 v[144:147], v[88:91], v[200:203], 0
v_mfma_f32_16x16x32_bf16 v[148:151], v[92:95], v[200:203], 0
v_mfma_f32_16x16x32_bf16 v[136:139], v[80:83], v[204:207], v[136:139]
v_mfma_f32_16x16x32_bf16 v[140:143], v[84:87], v[204:207], v[140:143]
v_mfma_f32_16x16x32_bf16 v[144:147], v[96:99], v[204:207], v[144:147]
v_mfma_f32_16x16x32_bf16 v[148:151], v[100:103], v[204:207], v[148:151]
s_nop 7
v_min_f32 v168, s48, v136
v_min_f32 v169, s48, v137
s_cmp_eq_u32 s54, 0
s_cbranch_scc1 L_pd9t
v_and_b32 v244, 7, v1
v_mul_u32_u24 v244, 4224, v244
s_mov_b32 s42, 177408
s_mov_b32 s41, 0
s_mov_b64 exec, 0xaa
L_pl9t:
buffer_load_dword v245, v244, s[24:27], s42 offen sc1
s_add_u32 s41, s41, 1
s_cmp_gt_u32 s41, 0x8000
s_cbranch_scc1 L_px9t
s_waitcnt vmcnt(0)
v_cmp_ne_u32 vcc, 1, v245
s_nop 1
s_cbranch_vccz L_px9t
s_sleep 1
s_branch L_pl9t
L_px9t:
s_mov_b64 exec, -1
L_pd9t:
s_add_u32 m0, s51, -512
s_nop 0
buffer_load_dwordx4 v0, s[16:19], s56 offen offset:512 sc1 lds
v_min_f32 v170, s48, v138
v_min_f32 v171, s48, v139
v_mfma_f32_16x16x32_bf16 v[152:155], v[72:75], v[208:211], 0
v_min_f32 v172, s48, v140
v_min_f32 v173, s48, v141
v_min_f32 v174, s48, v142
v_min_f32 v175, s48, v143
v_exp_f32 v144, v144
v_exp_f32 v145, v145
v_mfma_f32_16x16x32_bf16 v[156:159], v[76:79], v[208:211], 0
v_exp_f32 v146, v146
v_exp_f32 v147, v147
v_exp_f32 v148, v148
v_exp_f32 v149, v149
v_exp_f32 v150, v150
v_exp_f32 v151, v151
v_mfma_f32_16x16x32_bf16 v[160:163], v[88:91], v[208:211], 0
v_cmp_lt_f32 s[64:65], abs(v136), s52
v_cmp_lt_f32 s[66:67], abs(v137), s52
v_cmp_lt_f32 s[86:87], abs(v138), s52
v_cmp_lt_f32 s[88:89], abs(v139), s52
v_cmp_lt_f32 s[90:91], abs(v140), s52
v_cmp_lt_f32 s[92:93], abs(v141), s52
v_mfma_f32_16x16x32_bf16 v[164:167], v[92:95], v[208:211], 0
v_cmp_lt_f32 s[94:95], abs(v142), s52
v_cmp_lt_f32 s[96:97], abs(v143), s52
v_exp_f32 v168, v168
v_exp_f32 v169, v169
v_exp_f32 v170, v170
v_exp_f32 v171, v171
v_mfma_f32_16x16x32_bf16 v[152:155], v[80:83], v[212:215], v[152:155]
v_exp_f32 v172, v172
v_exp_f32 v173, v173
v_exp_f32 v174, v174
v_exp_f32 v175, v175
s_add_u32 m0, s51, 512
s_nop 0
buffer_load_dwordx4 v0, s[16:19], s57 offen offset:512 sc1 lds
v_add_f32 v144, 1.0, v144
v_add_f32 v145, 1.0, v145
v_mfma_f32_16x16x32_bf16 v[156:159], v[84:87], v[212:215], v[156:159]
v_add_f32 v146, 1.0, v146
v_add_f32 v147, 1.0, v147
v_add_f32 v148, 1.0, v148
v_add_f32 v149, 1.0, v149
v_add_f32 v150, 1.0, v150
v_add_f32 v151, 1.0, v151
v_mfma_f32_16x16x32_bf16 v[160:163], v[96:99], v[212:215], v[160:163]
v_mul_f32 v136, s53, v136
v_mul_f32 v137, s53, v137
v_mul_f32 v138, s53, v138
v_mul_f32 v139, s53, v139
v_mul_f32 v140, s53, v140
v_mul_f32 v141, s53, v141
v_mfma_f32_16x16x32_bf16 v[164:167], v[100:103], v[212:215], v[164:167]
v_mul_f32 v142, s53, v142
v_mul_f32 v143, s53, v143
v_fma_f32 v144, v168, v144, v144
v_fma_f32 v145, v169, v145, v145
v_fma_f32 v146, v170, v146, v146
v_fma_f32 v147, v171, v147, v147
v_mfma_f32_16x16x32_bf16 v[188:191], v[224:227], v[72:75], 0
v_fma_f32 v148, v172, v148, v148
v_fma_f32 v149, v173, v149, v149
v_fma_f32 v150, v174, v150, v150
v_fma_f32 v151, v175, v151, v151
v_sub_f32 v168, 1.0, v168
v_sub_f32 v169, 1.0, v169
v_mfma_f32_16x16x32_bf16 v[192:195], v[224:227], v[88:91], 0
v_sub_f32 v170, 1.0, v170
v_sub_f32 v171, 1.0, v171
v_sub_f32 v172, 1.0, v172
v_sub_f32 v173, 1.0, v173
s_add_u32 m0, s51, -512
s_nop 0
buffer_load_dwordx4 v0, s[16:19], s56 offen offset:2560 sc1 lds
v_sub_f32 v174, 1.0, v174
v_sub_f32 v175, 1.0, v175
v_mfma_f32_16x16x32_bf16 v[188:191], v[232:235], v[76:79], v[188:191]
v_rcp_f32 v144, v144
v_rcp_f32 v145, v145
v_rcp_f32 v146, v146
v_rcp_f32 v147, v147
v_rcp_f32 v148, v148
v_rcp_f32 v149, v149
v_mfma_f32_16x16x32_bf16 v[192:195], v[232:235], v[92:95], v[192:195]
v_rcp_f32 v150, v150
v_rcp_f32 v151, v151
v_cndmask_b32 v136, v168, v136, s[64:65]
v_cndmask_b32 v137, v169, v137, s[66:67]
v_cndmask_b32 v138, v170, v138, s[86:87]
v_cndmask_b32 v139, v171, v139, s[88:89]
v_cndmask_b32 v140, v172, v140, s[90:91]
v_cndmask_b32 v141, v173, v141, s[92:93]
v_cndmask_b32 v142, v174, v142, s[94:95]
v_cndmask_b32 v143, v175, v143, s[96:97]
v_mul_f32 v136, v136, v144
v_mul_f32 v137, v137, v145
v_mul_f32 v138, v138, v146
v_mul_f32 v139, v139, v147
v_mul_f32 v140, v140, v148
v_mul_f32 v141, v141, v149
v_mul_f32 v142, v142, v150
v_mul_f32 v143, v143, v151
v_cvt_pk_bf16_f32 v180, v136, v140
v_cvt_pk_bf16_f32 v181, v137, v141
v_cvt_pk_bf16_f32 v182, v138, v142
v_cvt_pk_bf16_f32 v183, v139, v143
s_add_u32 m0, s51, 512
s_nop 0
buffer_load_dwordx4 v0, s[16:19], s57 offen offset:2560 sc1 lds
ds_write_b128 v6, v[180:183] offset:32768
v_min_f32 v168, s48, v152
v_min_f32 v169, s48, v153
s_add_u32 m0, s51, 3584
s_nop 0
buffer_load_dwordx4 v0, s[16:19], s60 offen offset:512 sc1 lds
v_min_f32 v170, s48, v154
v_min_f32 v171, s48, v155
v_mfma_f32_16x16x32_bf16 v[136:139], v[72:75], v[216:219], 0
v_min_f32 v172, s48, v156
v_min_f32 v173, s48, v157
v_min_f32 v174, s48, v158
v_min_f32 v175, s48, v159
v_exp_f32 v160, v160
v_exp_f32 v161, v161
v_mfma_f32_16x16x32_bf16 v[140:143], v[76:79], v[216:219], 0
v_exp_f32 v162, v162
v_exp_f32 v163, v163
v_exp_f32 v164, v164
v_exp_f32 v165, v165
v_exp_f32 v166, v166
v_exp_f32 v167, v167
v_mfma_f32_16x16x32_bf16 v[144:147], v[88:91], v[216:219], 0
v_cmp_lt_f32 s[64:65], abs(v152), s52
v_cmp_lt_f32 s[66:67], abs(v153), s52
v_cmp_lt_f32 s[86:87], abs(v154), s52
v_cmp_lt_f32 s[88:89], abs(v155), s52
v_cmp_lt_f32 s[90:91], abs(v156), s52
v_cmp_lt_f32 s[92:93], abs(v157), s52
v_mfma_f32_16x16x32_bf16 v[148:151], v[92:95], v[216:219], 0
v_cmp_lt_f32 s[94:95], abs(v158), s52
v_cmp_lt_f32 s[96:97], abs(v159), s52
v_exp_f32 v168, v168
v_exp_f32 v169, v169
v_exp_f32 v170, v170
v_exp_f32 v171, v171
v_mfma_f32_16x16x32_bf16 v[136:139], v[80:83], v[220:223], v[136:139]
v_exp_f32 v172, v172
v_exp_f32 v173, v173
v_exp_f32 v174, v174
v_exp_f32 v175, v175
s_add_u32 m0, s51, 4608
s_nop 0
buffer_load_dwordx4 v0, s[16:19], s61 offen offset:512 sc1 lds
v_add_f32 v160, 1.0, v160
v_add_f32 v161, 1.0, v161
v_mfma_f32_16x16x32_bf16 v[140:143], v[84:87], v[220:223], v[140:143]
v_add_f32 v162, 1.0, v162
v_add_f32 v163, 1.0, v163
v_add_f32 v164, 1.0, v164
v_add_f32 v165, 1.0, v165
v_add_f32 v166, 1.0, v166
v_add_f32 v167, 1.0, v167
v_mfma_f32_16x16x32_bf16 v[144:147], v[96:99], v[220:223], v[144:147]
v_mul_f32 v152, s53, v152
v_mul_f32 v153, s53, v153
v_mul_f32 v154, s53, v154
v_mul_f32 v155, s53, v155
v_mul_f32 v156, s53, v156
v_mul_f32 v157, s53, v157
v_mfma_f32_16x16x32_bf16 v[148:151], v[100:103], v[220:223], v[148:151]
v_mul_f32 v158, s53, v158
v_mul_f32 v159, s53, v159
v_fma_f32 v160, v168, v160, v160
v_fma_f32 v161, v169, v161, v161
v_fma_f32 v162, v170, v162, v162
v_fma_f32 v163, v171, v163, v163
v_mfma_f32_16x16x32_bf16 v[188:191], v[228:231], v[80:83], v[188:191]
v_fma_f32 v164, v172, v164, v164
v_fma_f32 v165, v173, v165, v165
v_fma_f32 v166, v174, v166, v166
v_fma_f32 v167, v175, v167, v167
v_sub_f32 v168, 1.0, v168
v_sub_f32 v169, 1.0, v169
v_mfma_f32_16x16x32_bf16 v[192:195], v[228:231], v[96:99], v[192:195]
v_sub_f32 v170, 1.0, v170
v_sub_f32 v171, 1.0, v171
v_sub_f32 v172, 1.0, v172
v_sub_f32 v173, 1.0, v173
s_add_u32 m0, s51, 3584
s_nop 0
buffer_load_dwordx4 v0, s[16:19], s60 offen offset:2560 sc1 lds
v_sub_f32 v174, 1.0, v174
v_sub_f32 v175, 1.0, v175
v_mfma_f32_16x16x32_bf16 v[188:191], v[236:239], v[84:87], v[188:191]
v_rcp_f32 v160, v160
v_rcp_f32 v161, v161
v_rcp_f32 v162, v162
v_rcp_f32 v163, v163
v_rcp_f32 v164, v164
v_rcp_f32 v165, v165
v_mfma_f32_16x16x32_bf16 v[192:195], v[236:239], v[100:103], v[192:195]
v_rcp_f32 v166, v166
v_rcp_f32 v167, v167
v_cndmask_b32 v152, v168, v152, s[64:65]
v_cndmask_b32 v153, v169, v153, s[66:67]
v_cndmask_b32 v154, v170, v154, s[86:87]
v_cndmask_b32 v155, v171, v155, s[88:89]
v_cndmask_b32 v156, v172, v156, s[90:91]
v_cndmask_b32 v157, v173, v157, s[92:93]
v_cndmask_b32 v158, v174, v158, s[94:95]
v_cndmask_b32 v159, v175, v159, s[96:97]
v_mul_f32 v152, v152, v160
v_mul_f32 v153, v153, v161
v_mul_f32 v154, v154, v162
v_mul_f32 v155, v155, v163
v_mul_f32 v156, v156, v164
v_mul_f32 v157, v157, v165
v_mul_f32 v158, v158, v166
v_mul_f32 v159, v159, v167
v_cvt_pk_bf16_f32 v184, v152, v156
v_cvt_pk_bf16_f32 v185, v153, v157
v_cvt_pk_bf16_f32 v186, v154, v158
v_cvt_pk_bf16_f32 v187, v155, v159
s_add_u32 m0, s51, 4608
s_nop 0
buffer_load_dwordx4 v0, s[16:19], s61 offen offset:2560 sc1 lds
ds_write_b128 v6, v[184:187] offset:33792
v_min_f32 v168, s48, v188
v_min_f32 v169, s48, v136
v_min_f32 v170, s48, v137
v_min_f32 v171, s48, v138
v_min_f32 v172, s48, v139
v_min_f32 v173, s48, v140
v_min_f32 v174, s48, v141
v_min_f32 v175, s48, v142
v_min_f32 v176, s48, v143
v_exp_f32 v192, v192
v_exp_f32 v144, v144
v_exp_f32 v145, v145
v_exp_f32 v146, v146
v_exp_f32 v147, v147
v_exp_f32 v148, v148
v_exp_f32 v149, v149
v_exp_f32 v150, v150
v_exp_f32 v151, v151
v_cmp_lt_f32 s[64:65], abs(v188), s52
v_cmp_lt_f32 s[66:67], abs(v136), s52
v_cmp_lt_f32 s[86:87], abs(v137), s52
v_cmp_lt_f32 s[88:89], abs(v138), s52
v_cmp_lt_f32 s[90:91], abs(v139), s52
v_cmp_lt_f32 s[92:93], abs(v140), s52
v_cmp_lt_f32 s[94:95], abs(v141), s52
v_cmp_lt_f32 s[96:97], abs(v142), s52
v_cmp_lt_f32 s[98:99], abs(v143), s52
v_exp_f32 v168, v168
v_exp_f32 v169, v169
v_exp_f32 v170, v170
v_exp_f32 v171, v171
v_exp_f32 v172, v172
v_exp_f32 v173, v173
v_exp_f32 v174, v174
v_exp_f32 v175, v175
v_exp_f32 v176, v176
v_add_f32 v192, 1.0, v192
v_add_f32 v144, 1.0, v144
v_add_f32 v145, 1.0, v145
v_add_f32 v146, 1.0, v146
v_add_f32 v147, 1.0, v147
v_add_f32 v148, 1.0, v148
v_add_f32 v149, 1.0, v149
v_add_f32 v150, 1.0, v150
v_add_f32 v151, 1.0, v151
v_mul_f32 v188, s53, v188
v_mul_f32 v136, s53, v136
v_mul_f32 v137, s53, v137
v_mul_f32 v138, s53, v138
v_mul_f32 v139, s53, v139
v_mul_f32 v140, s53, v140
v_mul_f32 v141, s53, v141
v_mul_f32 v142, s53, v142
v_mul_f32 v143, s53, v143
v_fma_f32 v192, v168, v192, v192
v_fma_f32 v144, v169, v144, v144
v_fma_f32 v145, v170, v145, v145
v_fma_f32 v146, v171, v146, v146
v_fma_f32 v147, v172, v147, v147
v_fma_f32 v148, v173, v148, v148
v_fma_f32 v149, v174, v149, v149
v_fma_f32 v150, v175, v150, v150
v_fma_f32 v151, v176, v151, v151
v_sub_f32 v168, 1.0, v168
v_sub_f32 v169, 1.0, v169
v_sub_f32 v170, 1.0, v170
v_sub_f32 v171, 1.0, v171
v_sub_f32 v172, 1.0, v172
v_sub_f32 v173, 1.0, v173
v_sub_f32 v174, 1.0, v174
v_sub_f32 v175, 1.0, v175
v_sub_f32 v176, 1.0, v176
v_rcp_f32 v192, v192
v_rcp_f32 v144, v144
v_rcp_f32 v145, v145
v_rcp_f32 v146, v146
v_rcp_f32 v147, v147
v_rcp_f32 v148, v148
v_rcp_f32 v149, v149
v_rcp_f32 v150, v150
v_rcp_f32 v151, v151
v_cndmask_b32 v188, v168, v188, s[64:65]
v_cndmask_b32 v136, v169, v136, s[66:67]
v_cndmask_b32 v137, v170, v137, s[86:87]
v_cndmask_b32 v138, v171, v138, s[88:89]
v_cndmask_b32 v139, v172, v139, s[90:91]
v_cndmask_b32 v140, v173, v140, s[92:93]
v_cndmask_b32 v141, v174, v141, s[94:95]
v_cndmask_b32 v142, v175, v142, s[96:97]
v_cndmask_b32 v143, v176, v143, s[98:99]
v_mul_f32 v188, v188, v192
v_mul_f32 v136, v136, v144
v_mul_f32 v137, v137, v145
v_mul_f32 v138, v138, v146
v_mul_f32 v139, v139, v147
v_mul_f32 v140, v140, v148
v_mul_f32 v141, v141, v149
v_mul_f32 v142, v142, v150
v_mul_f32 v143, v143, v151
v_cvt_pk_bf16_f32 v168, v188, v188
ds_write_b16 v7, v168 offset:35840
v_cvt_pk_bf16_f32 v180, v136, v140
v_cvt_pk_bf16_f32 v181, v137, v141
v_cvt_pk_bf16_f32 v182, v138, v142
v_cvt_pk_bf16_f32 v183, v139, v143
ds_write_b128 v6, v[180:183] offset:34816
s_mov_b64 exec, 1
ds_add_u32 v240, v241
s_mov_b64 exec, -1
s_waitcnt vmcnt(0)
ds_read_b64 v[104:105], v242 offset:0
ds_read_b64 v[106:107], v242 offset:512
ds_read_b64 v[108:109], v242 offset:1024
ds_read_b64 v[110:111], v242 offset:1536
ds_read_b64 v[120:121], v242 offset:2048
ds_read_b64 v[122:123], v242 offset:2560
ds_read_b64 v[124:125], v242 offset:3072
ds_read_b64 v[126:127], v242 offset:3584
ds_read_b64 v[112:113], v242 offset:4096
ds_read_b64 v[114:115], v242 offset:4608
ds_read_b64 v[116:117], v242 offset:5120
ds_read_b64 v[118:119], v242 offset:5632
ds_read_b64 v[128:129], v242 offset:6144
ds_read_b64 v[130:131], v242 offset:6656
ds_read_b64 v[132:133], v242 offset:7168
ds_read_b64 v[134:135], v242 offset:7680
s_waitcnt lgkmcnt(12)
v_swap_b32 v105, v108
v_swap_b32 v107, v110
s_waitcnt lgkmcnt(8)
v_swap_b32 v121, v124
v_swap_b32 v123, v126
s_waitcnt lgkmcnt(4)
v_swap_b32 v113, v116
v_swap_b32 v115, v118
s_waitcnt lgkmcnt(0)
v_swap_b32 v129, v132
v_swap_b32 v131, v134
s_nop 1
v_mfma_f32_16x16x32_bf16 v[152:155], v[104:107], v[200:203], 0
v_mfma_f32_16x16x32_bf16 v[156:159], v[108:111], v[200:203], 0
v_mfma_f32_16x16x32_bf16 v[160:163], v[120:123], v[200:203], 0
v_mfma_f32_16x16x32_bf16 v[164:167], v[124:127], v[200:203], 0
v_mfma_f32_16x16x32_bf16 v[152:155], v[112:115], v[204:207], v[152:155]
v_mfma_f32_16x16x32_bf16 v[156:159], v[116:119], v[204:207], v[156:159]
v_mfma_f32_16x16x32_bf16 v[160:163], v[128:131], v[204:207], v[160:163]
v_mfma_f32_16x16x32_bf16 v[164:167], v[132:135], v[204:207], v[164:167]
s_nop 7
v_min_f32 v168, s48, v152
v_min_f32 v169, s48, v153
v_min_f32 v170, s48, v154
v_min_f32 v171, s48, v155
v_mfma_f32_16x16x32_bf16 v[136:139], v[104:107], v[208:211], 0
v_min_f32 v172, s48, v156
v_min_f32 v173, s48, v157
v_min_f32 v174, s48, v158
v_min_f32 v175, s48, v159
v_exp_f32 v160, v160
v_exp_f32 v161, v161
v_mfma_f32_16x16x32_bf16 v[140:143], v[108:111], v[208:211], 0
v_exp_f32 v162, v162
v_exp_f32 v163, v163
v_exp_f32 v164, v164
v_exp_f32 v165, v165
v_exp_f32 v166, v166
v_exp_f32 v167, v167
v_mfma_f32_16x16x32_bf16 v[144:147], v[120:123], v[208:211], 0
v_cmp_lt_f32 s[64:65], abs(v152), s52
v_cmp_lt_f32 s[66:67], abs(v153), s52
v_cmp_lt_f32 s[86:87], abs(v154), s52
v_cmp_lt_f32 s[88:89], abs(v155), s52
v_cmp_lt_f32 s[90:91], abs(v156), s52
v_cmp_lt_f32 s[92:93], abs(v157), s52
v_mfma_f32_16x16x32_bf16 v[148:151], v[124:127], v[208:211], 0
v_cmp_lt_f32 s[94:95], abs(v158), s52
v_cmp_lt_f32 s[96:97], abs(v159), s52
v_exp_f32 v168, v168
v_exp_f32 v169, v169
v_exp_f32 v170, v170
v_exp_f32 v171, v171
v_mfma_f32_16x16x32_bf16 v[136:139], v[112:115], v[212:215], v[136:139]
v_exp_f32 v172, v172
v_exp_f32 v173, v173
v_exp_f32 v174, v174
v_exp_f32 v175, v175
v_add_f32 v160, 1.0, v160
v_add_f32 v161, 1.0, v161
v_mfma_f32_16x16x32_bf16 v[140:143], v[116:119], v[212:215], v[140:143]
v_add_f32 v162, 1.0, v162
v_add_f32 v163, 1.0, v163
v_add_f32 v164, 1.0, v164
v_add_f32 v165, 1.0, v165
v_add_f32 v166, 1.0, v166
v_add_f32 v167, 1.0, v167
v_mfma_f32_16x16x32_bf16 v[144:147], v[128:131], v[212:215], v[144:147]
v_mul_f32 v152, s53, v152
v_mul_f32 v153, s53, v153
v_mul_f32 v154, s53, v154
v_mul_f32 v155, s53, v155
v_mul_f32 v156, s53, v156
v_mul_f32 v157, s53, v157
v_mfma_f32_16x16x32_bf16 v[148:151], v[132:135], v[212:215], v[148:151]
v_mul_f32 v158, s53, v158
v_mul_f32 v159, s53, v159
v_fma_f32 v160, v168, v160, v160
v_fma_f32 v161, v169, v161, v161
v_fma_f32 v162, v170, v162, v162
v_fma_f32 v163, v171, v163, v163
v_mfma_f32_16x16x32_bf16 v[188:191], v[224:227], v[104:107], 0
v_fma_f32 v164, v172, v164, v164
v_fma_f32 v165, v173, v165, v165
v_fma_f32 v166, v174, v166, v166
v_fma_f32 v167, v175, v167, v167
v_sub_f32 v168, 1.0, v168
v_sub_f32 v169, 1.0, v169
v_mfma_f32_16x16x32_bf16 v[192:195], v[224:227], v[120:123], 0
v_sub_f32 v170, 1.0, v170
v_sub_f32 v171, 1.0, v171
v_sub_f32 v172, 1.0, v172
v_sub_f32 v173, 1.0, v173
v_sub_f32 v174, 1.0, v174
v_sub_f32 v175, 1.0, v175
v_mfma_f32_16x16x32_bf16 v[188:191], v[232:235], v[108:111], v[188:191]
v_rcp_f32 v160, v160
v_rcp_f32 v161, v161
v_rcp_f32 v162, v162
v_rcp_f32 v163, v163
v_rcp_f32 v164, v164
v_rcp_f32 v165, v165
v_mfma_f32_16x16x32_bf16 v[192:195], v[232:235], v[124:127], v[192:195]
v_rcp_f32 v166, v166
v_rcp_f32 v167, v167
v_cndmask_b32 v152, v168, v152, s[64:65]
v_cndmask_b32 v153, v169, v153, s[66:67]
v_cndmask_b32 v154, v170, v154, s[86:87]
v_cndmask_b32 v155, v171, v155, s[88:89]
v_cndmask_b32 v156, v172, v156, s[90:91]
v_cndmask_b32 v157, v173, v157, s[92:93]
v_cndmask_b32 v158, v174, v158, s[94:95]
v_cndmask_b32 v159, v175, v159, s[96:97]
v_mul_f32 v152, v152, v160
v_mul_f32 v153, v153, v161
v_mul_f32 v154, v154, v162
v_mul_f32 v155, v155, v163
v_mul_f32 v156, v156, v164
v_mul_f32 v157, v157, v165
v_mul_f32 v158, v158, v166
v_mul_f32 v159, v159, v167
v_cvt_pk_bf16_f32 v184, v152, v156
v_cvt_pk_bf16_f32 v185, v153, v157
v_cvt_pk_bf16_f32 v186, v154, v158
v_cvt_pk_bf16_f32 v187, v155, v159
ds_write_b128 v6, v[184:187] offset:49152
v_min_f32 v168, s48, v136
v_min_f32 v169, s48, v137
v_min_f32 v170, s48, v138
v_min_f32 v171, s48, v139
v_mfma_f32_16x16x32_bf16 v[152:155], v[104:107], v[216:219], 0
v_min_f32 v172, s48, v140
v_min_f32 v173, s48, v141
v_min_f32 v174, s48, v142
v_min_f32 v175, s48, v143
v_exp_f32 v144, v144
v_exp_f32 v145, v145
v_mfma_f32_16x16x32_bf16 v[156:159], v[108:111], v[216:219], 0
v_exp_f32 v146, v146
v_exp_f32 v147, v147
v_exp_f32 v148, v148
v_exp_f32 v149, v149
v_exp_f32 v150, v150
v_exp_f32 v151, v151
v_mfma_f32_16x16x32_bf16 v[160:163], v[120:123], v[216:219], 0
v_cmp_lt_f32 s[64:65], abs(v136), s52
v_cmp_lt_f32 s[66:67], abs(v137), s52
v_cmp_lt_f32 s[86:87], abs(v138), s52
v_cmp_lt_f32 s[88:89], abs(v139), s52
v_cmp_lt_f32 s[90:91], abs(v140), s52
v_cmp_lt_f32 s[92:93], abs(v141), s52
v_mfma_f32_16x16x32_bf16 v[164:167], v[124:127], v[216:219], 0
v_cmp_lt_f32 s[94:95], abs(v142), s52
v_cmp_lt_f32 s[96:97], abs(v143), s52
v_exp_f32 v168, v168
v_exp_f32 v169, v169
v_exp_f32 v170, v170
v_exp_f32 v171, v171
v_mfma_f32_16x16x32_bf16 v[152:155], v[112:115], v[220:223], v[152:155]
v_exp_f32 v172, v172
v_exp_f32 v173, v173
v_exp_f32 v174, v174
v_exp_f32 v175, v175
v_add_f32 v144, 1.0, v144
v_add_f32 v145, 1.0, v145
v_mfma_f32_16x16x32_bf16 v[156:159], v[116:119], v[220:223], v[156:159]
v_add_f32 v146, 1.0, v146
v_add_f32 v147, 1.0, v147
v_add_f32 v148, 1.0, v148
v_add_f32 v149, 1.0, v149
v_add_f32 v150, 1.0, v150
v_add_f32 v151, 1.0, v151
v_mfma_f32_16x16x32_bf16 v[160:163], v[128:131], v[220:223], v[160:163]
v_mul_f32 v136, s53, v136
v_mul_f32 v137, s53, v137
v_mul_f32 v138, s53, v138
v_mul_f32 v139, s53, v139
v_mul_f32 v140, s53, v140
v_mul_f32 v141, s53, v141
v_mfma_f32_16x16x32_bf16 v[164:167], v[132:135], v[220:223], v[164:167]
v_mul_f32 v142, s53, v142
v_mul_f32 v143, s53, v143
v_fma_f32 v144, v168, v144, v144
v_fma_f32 v145, v169, v145, v145
v_fma_f32 v146, v170, v146, v146
v_fma_f32 v147, v171, v147, v147
v_mfma_f32_16x16x32_bf16 v[188:191], v[228:231], v[112:115], v[188:191]
v_fma_f32 v148, v172, v148, v148
v_fma_f32 v149, v173, v149, v149
v_fma_f32 v150, v174, v150, v150
v_fma_f32 v151, v175, v151, v151
v_sub_f32 v168, 1.0, v168
v_sub_f32 v169, 1.0, v169
v_mfma_f32_16x16x32_bf16 v[192:195], v[228:231], v[128:131], v[192:195]
v_sub_f32 v170, 1.0, v170
v_sub_f32 v171, 1.0, v171
v_sub_f32 v172, 1.0, v172
v_sub_f32 v173, 1.0, v173
v_sub_f32 v174, 1.0, v174
v_sub_f32 v175, 1.0, v175
v_mfma_f32_16x16x32_bf16 v[188:191], v[236:239], v[116:119], v[188:191]
v_rcp_f32 v144, v144
v_rcp_f32 v145, v145
v_rcp_f32 v146, v146
v_rcp_f32 v147, v147
v_rcp_f32 v148, v148
v_rcp_f32 v149, v149
v_mfma_f32_16x16x32_bf16 v[192:195], v[236:239], v[132:135], v[192:195]
v_rcp_f32 v150, v150
v_rcp_f32 v151, v151
v_cndmask_b32 v136, v168, v136, s[64:65]
v_cndmask_b32 v137, v169, v137, s[66:67]
v_cndmask_b32 v138, v170, v138, s[86:87]
v_cndmask_b32 v139, v171, v139, s[88:89]
v_cndmask_b32 v140, v172, v140, s[90:91]
v_cndmask_b32 v141, v173, v141, s[92:93]
v_cndmask_b32 v142, v174, v142, s[94:95]
v_cndmask_b32 v143, v175, v143, s[96:97]
v_mul_f32 v136, v136, v144
v_mul_f32 v137, v137, v145
v_mul_f32 v138, v138, v146
v_mul_f32 v139, v139, v147
v_mul_f32 v140, v140, v148
v_mul_f32 v141, v141, v149
v_mul_f32 v142, v142, v150
v_mul_f32 v143, v143, v151
v_cvt_pk_bf16_f32 v180, v136, v140
v_cvt_pk_bf16_f32 v181, v137, v141
v_cvt_pk_bf16_f32 v182, v138, v142
v_cvt_pk_bf16_f32 v183, v139, v143
ds_write_b128 v6, v[180:183] offset:50176
v_min_f32 v168, s48, v188
v_min_f32 v169, s48, v152
v_min_f32 v170, s48, v153
v_min_f32 v171, s48, v154
v_min_f32 v172, s48, v155
v_min_f32 v173, s48, v156
v_min_f32 v174, s48, v157
v_min_f32 v175, s48, v158
v_min_f32 v176, s48, v159
v_exp_f32 v192, v192
v_exp_f32 v160, v160
v_exp_f32 v161, v161
v_exp_f32 v162, v162
v_exp_f32 v163, v163
v_exp_f32 v164, v164
v_exp_f32 v165, v165
v_exp_f32 v166, v166
v_exp_f32 v167, v167
v_cmp_lt_f32 s[64:65], abs(v188), s52
v_cmp_lt_f32 s[66:67], abs(v152), s52
v_cmp_lt_f32 s[86:87], abs(v153), s52
v_cmp_lt_f32 s[88:89], abs(v154), s52
v_cmp_lt_f32 s[90:91], abs(v155), s52
v_cmp_lt_f32 s[92:93], abs(v156), s52
v_cmp_lt_f32 s[94:95], abs(v157), s52
v_cmp_lt_f32 s[96:97], abs(v158), s52
v_cmp_lt_f32 s[98:99], abs(v159), s52
v_exp_f32 v168, v168
v_exp_f32 v169, v169
v_exp_f32 v170, v170
v_exp_f32 v171, v171
v_exp_f32 v172, v172
v_exp_f32 v173, v173
v_exp_f32 v174, v174
v_exp_f32 v175, v175
v_exp_f32 v176, v176
v_add_f32 v192, 1.0, v192
v_add_f32 v160, 1.0, v160
v_add_f32 v161, 1.0, v161
v_add_f32 v162, 1.0, v162
v_add_f32 v163, 1.0, v163
v_add_f32 v164, 1.0, v164
v_add_f32 v165, 1.0, v165
v_add_f32 v166, 1.0, v166
v_add_f32 v167, 1.0, v167
v_mul_f32 v188, s53, v188
v_mul_f32 v152, s53, v152
v_mul_f32 v153, s53, v153
v_mul_f32 v154, s53, v154
v_mul_f32 v155, s53, v155
v_mul_f32 v156, s53, v156
v_mul_f32 v157, s53, v157
v_mul_f32 v158, s53, v158
v_mul_f32 v159, s53, v159
v_fma_f32 v192, v168, v192, v192
v_fma_f32 v160, v169, v160, v160
v_fma_f32 v161, v170, v161, v161
v_fma_f32 v162, v171, v162, v162
v_fma_f32 v163, v172, v163, v163
v_fma_f32 v164, v173, v164, v164
v_fma_f32 v165, v174, v165, v165
v_fma_f32 v166, v175, v166, v166
v_fma_f32 v167, v176, v167, v167
v_sub_f32 v168, 1.0, v168
v_sub_f32 v169, 1.0, v169
v_sub_f32 v170, 1.0, v170
v_sub_f32 v171, 1.0, v171
v_sub_f32 v172, 1.0, v172
v_sub_f32 v173, 1.0, v173
v_sub_f32 v174, 1.0, v174
v_sub_f32 v175, 1.0, v175
v_sub_f32 v176, 1.0, v176
v_rcp_f32 v192, v192
v_rcp_f32 v160, v160
v_rcp_f32 v161, v161
v_rcp_f32 v162, v162
v_rcp_f32 v163, v163
v_rcp_f32 v164, v164
v_rcp_f32 v165, v165
v_rcp_f32 v166, v166
v_rcp_f32 v167, v167
v_cndmask_b32 v188, v168, v188, s[64:65]
v_cndmask_b32 v152, v169, v152, s[66:67]
v_cndmask_b32 v153, v170, v153, s[86:87]
v_cndmask_b32 v154, v171, v154, s[88:89]
v_cndmask_b32 v155, v172, v155, s[90:91]
v_cndmask_b32 v156, v173, v156, s[92:93]
v_cndmask_b32 v157, v174, v157, s[94:95]
v_cndmask_b32 v158, v175, v158, s[96:97]
v_cndmask_b32 v159, v176, v159, s[98:99]
v_mul_f32 v188, v188, v192
v_mul_f32 v152, v152, v160
v_mul_f32 v153, v153, v161
v_mul_f32 v154, v154, v162
v_mul_f32 v155, v155, v163
v_mul_f32 v156, v156, v164
v_mul_f32 v157, v157, v165
v_mul_f32 v158, v158, v166
v_mul_f32 v159, v159, v167
v_cvt_pk_bf16_f32 v168, v188, v188
ds_write_b16 v7, v168 offset:52224
v_cvt_pk_bf16_f32 v184, v152, v156
v_cvt_pk_bf16_f32 v185, v153, v157
v_cvt_pk_bf16_f32 v186, v154, v158
v_cvt_pk_bf16_f32 v187, v155, v159
ds_write_b128 v6, v[184:187] offset:51200
s_mov_b64 exec, 1
ds_add_u32 v240, v241
s_mov_b64 exec, -1
s_branch L_fin

.section .rodata,"a"
.p2align 6
.amdhsa_kernel standalone__autoregressive_conv_wavenet__speech_kernel
  .amdhsa_next_free_vgpr 256
  .amdhsa_next_free_sgpr 102
  .amdhsa_accum_offset 256
  .amdhsa_group_segment_fixed_size 0
  .amdhsa_kernarg_size 48
  .amdhsa_user_sgpr_count 2
  .amdhsa_user_sgpr_kernarg_segment_ptr 1
  .amdhsa_system_sgpr_workgroup_id_x 1
.end_amdhsa_kernel
```
